```python
import torch

def _softmax(x, axis=-1):
    return torch.softmax(x, dim=axis)
def _gelu(x):
    return torch.nn.functional.gelu(x, approximate="tanh")
def _silu(x):
    return torch.nn.functional.silu(x)
def _sigmoid(x):
    return torch.sigmoid(x)
def _layernorm(x, axis=-1, eps=1e-5):
    m = x.mean(dim=axis, keepdim=True)
    v = x.var(dim=axis, keepdim=True, unbiased=False)
    return (x - m) / torch.sqrt(v + eps)
def _scatter_add(tgt, idx, src, axis=0):
    return tgt.clone().index_add_(axis, idx, src)
def _segment_sum(src, seg, n):
    out = torch.zeros((n,) + src.shape[1:], dtype=src.dtype)
    return out.index_add_(0, seg, src)
def _pad(x, pw):
    flat = tuple(v for pair in reversed(pw) for v in pair)
    return torch.nn.functional.pad(x, flat)

kernel_name = 'standalone__gqa_softmax__near_ridge'

def setup_inputs():

    _w = (lambda a: (lambda t: t.to(torch.bfloat16) if t.is_floating_point() else t)(torch.as_tensor(a)))
    B, Hq, Hkv, Sq, Sk, D = 32, 32, 8, 384, 384, 128
    return {
        "q": _w((lambda *s: torch.randn(*s, dtype=torch.bfloat16) * 0.8)(B, Hq, Sq, D)),
        "k": _w((lambda *s: torch.randn(*s, dtype=torch.bfloat16) * 0.8)(B, Hkv, Sk, D)),
        "v": _w((lambda *s: torch.randn(*s, dtype=torch.bfloat16) * 0.05)(B, Hkv, Sk, D)),
    }

def reference(q, k, v):
    B, Hq, Sq, D = q.shape
    Hkv = k.shape[1]
    rep = Hq // Hkv
    k = (lambda x, n, axis: torch.repeat_interleave(x, n, dim=axis))(k, rep, axis=1)
    v = (lambda x, n, axis: torch.repeat_interleave(x, n, dim=axis))(v, rep, axis=1)
    scale = D ** -0.5
    scores = torch.einsum("bhqd,bhkd->bhqk", q, k) * scale
    p = _softmax(scores, axis=-1)
    return torch.einsum("bhqk,bhkd->bhqd", p, v)
```

```asm
; @launch grid=(256,1,1) block=(256,1,1) lds=163840
.amdgcn_target "amdgcn-amd-amdhsa--gfx950"
.text
.globl standalone__gqa_softmax__near_ridge_kernel
.p2align 8
.type standalone__gqa_softmax__near_ridge_kernel,@function
standalone__gqa_softmax__near_ridge_kernel:
  s_cmp_ge_u32 s2, 256
  s_cbranch_scc1 L_end
  s_load_dwordx4 s[4:7], s[0:1], 0
  s_load_dwordx4 s[8:11], s[0:1], 16
  s_getpc_b64 s[52:53]
L_pc:
  v_lshlrev_b32 v32, 7, v0
  v_add_u32 v33, 32768, v32
  v_min_u32 v32, L_fin-L_pc, v32
  v_min_u32 v33, L_fin-L_pc, v33
  v_mov_b32 v39, s53
  v_mov_b32 v41, s53
  v_add_co_u32 v38, vcc, s52, v32
  s_nop 1
  v_addc_co_u32 v39, vcc, 0, v39, vcc
  v_add_co_u32 v40, vcc, s52, v33
  s_nop 1
  v_addc_co_u32 v41, vcc, 0, v41, vcc
  global_load_dword v35, v[38:39], off
  global_load_dword v36, v[40:41], off
  v_lshrrev_b32 v31, 6, v0
  v_and_b32 v30, 63, v0
  v_readfirstlane_b32 s32, v31
  v_and_b32 v32, 3, v30
  v_lshrrev_b32 v33, 2, v30
  v_lshlrev_b32 v12, 11, v31
  v_lshl_add_u32 v13, v30, 4, v12
  v_lshl_add_u32 v12, v32, 8, v12
  v_and_b32 v31, 1, v31
  v_lshlrev_b32 v31, 1, v31
  v_xor_b32 v33, v33, v31
  v_lshl_add_u32 v12, v33, 4, v12
  s_mul_i32 s45, s2, 98304
  s_lshl_b32 s44, s32, 11
  s_add_u32 s46, s44, 98304
  s_mul_i32 s34, s2, 393216
  s_mul_i32 s42, s32, 98304
  s_add_u32 s34, s34, s42
  s_mov_b32 s35, s34
  s_mov_b32 s47, s34
  s_add_u32 s36, s34, 98304
  v_and_b32 v31, 15, v30
  v_lshrrev_b32 v33, 4, v30
  v_lshlrev_b32 v4, 8, v31
  v_lshl_add_u32 v4, v33, 4, v4
  s_waitcnt lgkmcnt(0)
  s_mov_b32 s20, s6
  s_and_b32 s21, s7, 0xffff
  s_mov_b32 s22, 25165824
  s_mov_b32 s23, 0x20000
  s_add_u32 m0, s44, 0
  s_add_u32 s43, s45, 0
  buffer_load_dwordx4 v12, s[20:23], s43 offen offset:0 nt lds
  buffer_load_dwordx4 v12, s[20:23], s43 offen offset:1024 nt lds
  s_mov_b32 s16, s4
  s_and_b32 s17, s5, 0xffff
  s_mov_b32 s18, 100663296
  s_mov_b32 s19, 0x20000
  buffer_load_dwordx4 a[128:131], v4, s[16:19], s34 offen offset:0 nt
  buffer_load_dwordx4 a[132:135], v4, s[16:19], s34 offen offset:64 nt
  buffer_load_dwordx4 a[136:139], v4, s[16:19], s34 offen offset:128 nt
  buffer_load_dwordx4 a[140:143], v4, s[16:19], s34 offen offset:192 nt
  s_add_u32 s34, s34, 4096
  s_mov_b32 s24, s8
  s_and_b32 s25, s9, 0xffff
  s_mov_b32 s26, 25165824
  s_mov_b32 s27, 0x20000
  s_add_u32 m0, s46, 0
  s_add_u32 s43, s45, 0
  buffer_load_dwordx4 v13, s[24:27], s43 offen offset:0 nt lds
  buffer_load_dwordx4 v13, s[24:27], s43 offen offset:1024 nt lds
  s_add_u32 m0, s44, 8192
  s_add_u32 s43, s45, 8192
  buffer_load_dwordx4 v12, s[20:23], s43 offen offset:0 nt lds
  buffer_load_dwordx4 v12, s[20:23], s43 offen offset:1024 nt lds
  s_mov_b32 s28, s10
  s_and_b32 s29, s11, 0xffff
  s_mov_b32 s30, 100663296
  s_mov_b32 s31, 0x20000
  s_mov_b32 s33, 0x3e0293ee
  s_mov_b32 s38, 0x05040100
  s_mov_b32 s39, 0x07060302
  s_mov_b32 s40, 0x21800000
  s_mov_b32 s41, 0x5d800000
  s_mov_b32 s37, 1
  v_lshrrev_b32 v34, 2, v31
  v_lshlrev_b32 v1, 11, v34
  v_and_b32 v34, 1, v34
  v_lshlrev_b32 v34, 1, v34
  v_xor_b32 v34, v34, v33
  v_lshl_add_u32 v1, v34, 6, v1
  v_lshl_add_u32 v1, v32, 4, v1
  v_add_u32 v2, 0x10000, v1
  v_lshlrev_b32 v3, 4, v31
  v_lshl_add_u32 v3, v33, 11, v3
  v_add_u32 v3, 98304, v3
  v_add_u32 v5, 0x10000, v13
  v_lshlrev_b32 v7, 4, v31
  v_add_u32 v7, s46, v7
  v_lshl_add_u32 v6, v33, 9, v7
  v_lshl_add_u32 v7, v33, 2, v7
  v_mov_b32 v8, 0x3f803f80
  v_cmp_eq_u32 s[50:51], 0, v31
  s_nop 1
  v_cndmask_b32 v8, 0, v8, s[50:51]
  v_mov_b32 v9, v8
  v_mov_b32 v10, v8
  v_mov_b32 v11, v8
  s_add_u32 m0, s46, 8192
  s_add_u32 s43, s45, 8192
  buffer_load_dwordx4 v13, s[24:27], s43 offen offset:0 nt lds
  buffer_load_dwordx4 v13, s[24:27], s43 offen offset:1024 nt lds
  buffer_load_dwordx4 a[160:163], v4, s[16:19], s34 offen offset:0 nt
  buffer_load_dwordx4 a[164:167], v4, s[16:19], s34 offen offset:64 nt
  buffer_load_dwordx4 a[168:171], v4, s[16:19], s34 offen offset:128 nt
  buffer_load_dwordx4 a[172:175], v4, s[16:19], s34 offen offset:192 nt
  s_add_u32 s34, s34, 4096
  s_add_u32 m0, s44, 16384
  s_add_u32 s43, s45, 16384
  buffer_load_dwordx4 v12, s[20:23], s43 offen offset:0 nt lds
  buffer_load_dwordx4 v12, s[20:23], s43 offen offset:1024 nt lds
  s_waitcnt vmcnt(16)
  ds_read_b128 v[16:19], v13 offset:0
  ds_read_b128 v[20:23], v13 offset:1024
  s_waitcnt lgkmcnt(0)
  v_lshlrev_b32 v14, 16, v16
  v_and_b32 v15, 0xffff0000, v16
  v_mul_f32 v14, s33, v14
  v_mul_f32 v15, s33, v15
  v_cvt_pk_bf16_f32 v16, v14, v15
  v_lshlrev_b32 v14, 16, v17
  v_and_b32 v15, 0xffff0000, v17
  v_mul_f32 v14, s33, v14
  v_mul_f32 v15, s33, v15
  v_cvt_pk_bf16_f32 v17, v14, v15
  v_lshlrev_b32 v14, 16, v18
  v_and_b32 v15, 0xffff0000, v18
  v_mul_f32 v14, s33, v14
  v_mul_f32 v15, s33, v15
  v_cvt_pk_bf16_f32 v18, v14, v15
  v_lshlrev_b32 v14, 16, v19
  v_and_b32 v15, 0xffff0000, v19
  v_mul_f32 v14, s33, v14
  v_mul_f32 v15, s33, v15
  v_cvt_pk_bf16_f32 v19, v14, v15
  ds_write_b128 v13, v[16:19] offset:0
  v_lshlrev_b32 v14, 16, v20
  v_and_b32 v15, 0xffff0000, v20
  v_mul_f32 v14, s33, v14
  v_mul_f32 v15, s33, v15
  v_cvt_pk_bf16_f32 v20, v14, v15
  v_lshlrev_b32 v14, 16, v21
  v_and_b32 v15, 0xffff0000, v21
  v_mul_f32 v14, s33, v14
  v_mul_f32 v15, s33, v15
  v_cvt_pk_bf16_f32 v21, v14, v15
  v_lshlrev_b32 v14, 16, v22
  v_and_b32 v15, 0xffff0000, v22
  v_mul_f32 v14, s33, v14
  v_mul_f32 v15, s33, v15
  v_cvt_pk_bf16_f32 v22, v14, v15
  v_lshlrev_b32 v14, 16, v23
  v_and_b32 v15, 0xffff0000, v23
  v_mul_f32 v14, s33, v14
  v_mul_f32 v15, s33, v15
  v_cvt_pk_bf16_f32 v23, v14, v15
  ds_write_b128 v13, v[20:23] offset:1024
  s_waitcnt lgkmcnt(0)
  s_barrier
  ds_read_b128 a[192:195], v1 offset:0
  ds_read_b128 a[196:199], v1 offset:256
  ds_read_b128 a[200:203], v1 offset:512
  ds_read_b128 a[204:207], v1 offset:768
  ds_read_b128 a[208:211], v1 offset:1024
  ds_read_b128 a[212:215], v1 offset:1280
  ds_read_b128 a[216:219], v1 offset:1536
  ds_read_b128 a[220:223], v1 offset:1792
  s_add_u32 m0, s46, 16384
  s_add_u32 s43, s45, 16384
  s_waitcnt lgkmcnt(7) vmcnt(15)
  v_mfma_f32_16x16x32_bf16 v[24:27], a[192:195], a[128:131], -4.0
  s_waitcnt lgkmcnt(6) vmcnt(14)
  v_mfma_f32_16x16x32_bf16 v[24:27], a[196:199], a[132:135], v[24:27]
  s_waitcnt lgkmcnt(5) vmcnt(13)
  v_mfma_f32_16x16x32_bf16 v[24:27], a[200:203], a[136:139], v[24:27]
  s_waitcnt lgkmcnt(4) vmcnt(12)
  v_mfma_f32_16x16x32_bf16 v[24:27], a[204:207], a[140:143], v[24:27]
  s_waitcnt lgkmcnt(3)
  v_mfma_f32_16x16x32_bf16 v[40:43], a[208:211], a[128:131], -4.0
  s_waitcnt lgkmcnt(2)
  v_mfma_f32_16x16x32_bf16 v[40:43], a[212:215], a[132:135], v[40:43]
  s_waitcnt lgkmcnt(1)
  v_mfma_f32_16x16x32_bf16 v[40:43], a[216:219], a[136:139], v[40:43]
  s_waitcnt lgkmcnt(0)
  v_exp_f32 v24, v24
  v_mfma_f32_16x16x32_bf16 v[40:43], a[220:223], a[140:143], v[40:43]
  v_exp_f32 v25, v25
  v_exp_f32 v26, v26
  v_exp_f32 v27, v27
  v_cvt_pk_bf16_f32 v24, v24, v25
  v_cvt_pk_bf16_f32 v25, v26, v27
  s_nop 2
  v_exp_f32 v40, v40
  v_exp_f32 v41, v41
  v_exp_f32 v42, v42
  v_exp_f32 v43, v43
  v_cvt_pk_bf16_f32 v26, v40, v41
  v_cvt_pk_bf16_f32 v27, v42, v43
  s_nop 1
  v_mfma_f32_16x16x32_bf16 v[48:51], v[24:27], v[8:11], 0
  s_waitcnt vmcnt(10)
  ds_read2st64_b32 v[16:17], v7 offset0:0 offset1:2
  ds_read2st64_b32 v[20:21], v7 offset0:1 offset1:3
  ds_read2st64_b32 v[18:19], v7 offset0:4 offset1:6
  ds_read2st64_b32 v[22:23], v7 offset0:5 offset1:7
  s_waitcnt lgkmcnt(2)
  v_perm_b32 v14, v20, v16, s38
  v_perm_b32 v15, v21, v17, s38
  v_perm_b32 v20, v20, v16, s39
  v_perm_b32 v21, v21, v17, s39
  s_waitcnt lgkmcnt(0)
  v_perm_b32 v16, v22, v18, s38
  v_perm_b32 v17, v23, v19, s38
  v_perm_b32 v22, v22, v18, s39
  v_perm_b32 v23, v23, v19, s39
  ds_write_b128 v6, v[14:17] offset:0
  ds_write_b128 v6, v[20:23] offset:256
  s_waitcnt vmcnt(8)
  ds_read_b128 v[16:19], v13 offset:8192
  ds_read_b128 v[20:23], v13 offset:9216
  s_waitcnt lgkmcnt(1)
  v_lshlrev_b32 v14, 16, v16
  v_and_b32 v15, 0xffff0000, v16
  v_mul_f32 v14, s33, v14
  v_mul_f32 v15, s33, v15
  v_cvt_pk_bf16_f32 v16, v14, v15
  v_lshlrev_b32 v14, 16, v17
  v_and_b32 v15, 0xffff0000, v17
  v_mul_f32 v14, s33, v14
  v_mul_f32 v15, s33, v15
  v_cvt_pk_bf16_f32 v17, v14, v15
  v_lshlrev_b32 v14, 16, v18
  v_and_b32 v15, 0xffff0000, v18
  v_mul_f32 v14, s33, v14
  v_mul_f32 v15, s33, v15
  v_cvt_pk_bf16_f32 v18, v14, v15
  v_lshlrev_b32 v14, 16, v19
  v_and_b32 v15, 0xffff0000, v19
  v_mul_f32 v14, s33, v14
  v_mul_f32 v15, s33, v15
  v_cvt_pk_bf16_f32 v19, v14, v15
  s_waitcnt lgkmcnt(0)
  v_lshlrev_b32 v14, 16, v20
  v_and_b32 v15, 0xffff0000, v20
  v_mul_f32 v14, s33, v14
  v_mul_f32 v15, s33, v15
  v_cvt_pk_bf16_f32 v20, v14, v15
  v_lshlrev_b32 v14, 16, v21
  v_and_b32 v15, 0xffff0000, v21
  v_mul_f32 v14, s33, v14
  v_mul_f32 v15, s33, v15
  v_cvt_pk_bf16_f32 v21, v14, v15
  v_lshlrev_b32 v14, 16, v22
  v_and_b32 v15, 0xffff0000, v22
  v_mul_f32 v14, s33, v14
  v_mul_f32 v15, s33, v15
  v_cvt_pk_bf16_f32 v22, v14, v15
  v_lshlrev_b32 v14, 16, v23
  v_and_b32 v15, 0xffff0000, v23
  v_mul_f32 v14, s33, v14
  v_mul_f32 v15, s33, v15
  v_cvt_pk_bf16_f32 v23, v14, v15
  ds_write_b128 v13, v[16:19] offset:8192
  ds_write_b128 v13, v[20:23] offset:9216
  s_waitcnt lgkmcnt(0)
  s_barrier
  ds_read_b128 a[0:3], v3 offset:0
  ds_read_b128 a[4:7], v3 offset:256
  ds_read_b128 a[8:11], v3 offset:512
  ds_read_b128 a[12:15], v3 offset:768
  ds_read_b128 a[16:19], v3 offset:1024
  ds_read_b128 a[20:23], v3 offset:1280
  ds_read_b128 a[24:27], v3 offset:1536
  ds_read_b128 a[28:31], v3 offset:1792
  ds_read_b128 a[192:195], v1 offset:8192
  ds_read_b128 a[196:199], v1 offset:8448
  ds_read_b128 a[200:203], v1 offset:8704
  ds_read_b128 a[204:207], v1 offset:8960
  ds_read_b128 a[208:211], v1 offset:9216
  ds_read_b128 a[212:215], v1 offset:9472
  ds_read_b128 a[216:219], v1 offset:9728
  s_waitcnt lgkmcnt(13)
  ds_read_b128 a[220:223], v1 offset:9984
  s_waitcnt vmcnt(6)
  ds_read2st64_b32 v[16:17], v7 offset0:32 offset1:34
  s_waitcnt lgkmcnt(12)
  ds_read2st64_b32 v[20:21], v7 offset0:33 offset1:35
  ds_read2st64_b32 v[18:19], v7 offset0:36 offset1:38
  ds_read2st64_b32 v[22:23], v7 offset0:37 offset1:39
  v_mfma_f32_16x16x32_bf16 v[64:67], v[24:27], a[0:3], 0
  v_mfma_f32_16x16x32_bf16 v[68:71], v[24:27], a[4:7], 0
  v_mfma_f32_16x16x32_bf16 v[72:75], v[24:27], a[8:11], 0
  v_mfma_f32_16x16x32_bf16 v[76:79], v[24:27], a[12:15], 0
  v_mfma_f32_16x16x32_bf16 v[80:83], v[24:27], a[16:19], 0
  s_waitcnt lgkmcnt(4)
  v_mfma_f32_16x16x32_bf16 v[84:87], v[24:27], a[20:23], 0
  v_mfma_f32_16x16x32_bf16 v[88:91], v[24:27], a[24:27], 0
  s_waitcnt lgkmcnt(1)
  v_perm_b32 v14, v20, v16, s38
  v_perm_b32 v15, v21, v17, s38
  v_perm_b32 v20, v20, v16, s39
  v_perm_b32 v21, v21, v17, s39
  s_waitcnt lgkmcnt(0)
  v_perm_b32 v16, v22, v18, s38
  v_perm_b32 v17, v23, v19, s38
  v_perm_b32 v22, v22, v18, s39
  v_perm_b32 v23, v23, v19, s39
  ds_write_b128 v6, v[14:17] offset:8192
  ds_write_b128 v6, v[20:23] offset:8448
  v_mfma_f32_16x16x32_bf16 v[92:95], v[24:27], a[28:31], 0
  v_mfma_f32_16x16x32_bf16 v[24:27], a[192:195], a[128:131], -4.0
  v_mfma_f32_16x16x32_bf16 v[24:27], a[196:199], a[132:135], v[24:27]
  v_mfma_f32_16x16x32_bf16 v[24:27], a[200:203], a[136:139], v[24:27]
  v_mfma_f32_16x16x32_bf16 v[24:27], a[204:207], a[140:143], v[24:27]
  buffer_load_dwordx4 v13, s[24:27], s43 offen offset:0 nt lds
  v_mfma_f32_16x16x32_bf16 v[40:43], a[208:211], a[128:131], -4.0
  v_mfma_f32_16x16x32_bf16 v[40:43], a[212:215], a[132:135], v[40:43]
  s_nop 0
  v_exp_f32 v24, v24
  v_mfma_f32_16x16x32_bf16 v[40:43], a[216:219], a[136:139], v[40:43]
  v_exp_f32 v25, v25
  v_mfma_f32_16x16x32_bf16 v[40:43], a[220:223], a[140:143], v[40:43]
  v_exp_f32 v26, v26
  v_exp_f32 v27, v27
  v_cvt_pk_bf16_f32 v24, v24, v25
  v_cvt_pk_bf16_f32 v25, v26, v27
  s_nop 3
  v_exp_f32 v40, v40
  v_exp_f32 v41, v41
  v_exp_f32 v42, v42
  v_exp_f32 v43, v43
  v_cvt_pk_bf16_f32 v26, v40, v41
  v_cvt_pk_bf16_f32 v27, v42, v43
  s_nop 1
  v_mfma_f32_16x16x32_bf16 v[48:51], v[24:27], v[8:11], v[48:51]
  buffer_load_dwordx4 v13, s[24:27], s43 offen offset:1024 nt lds
  s_add_u32 m0, s44, 24576
  s_add_u32 s43, s45, 24576
  buffer_load_dwordx4 v12, s[20:23], s43 offen offset:0 nt lds
  buffer_load_dwordx4 v12, s[20:23], s43 offen offset:1024 nt lds
  s_add_u32 m0, s46, 24576
  s_add_u32 s43, s45, 24576
  buffer_load_dwordx4 v13, s[24:27], s43 offen offset:0 nt lds
  buffer_load_dwordx4 v13, s[24:27], s43 offen offset:1024 nt lds
  s_add_u32 m0, s44, 32768
  s_add_u32 s43, s45, 32768
  s_waitcnt vmcnt(6)
  ds_read_b128 v[16:19], v13 offset:16384
  ds_read_b128 v[20:23], v13 offset:17408
  s_waitcnt lgkmcnt(1)
  v_lshlrev_b32 v14, 16, v16
  v_and_b32 v15, 0xffff0000, v16
  v_mul_f32 v14, s33, v14
  v_mul_f32 v15, s33, v15
  v_cvt_pk_bf16_f32 v16, v14, v15
  v_lshlrev_b32 v14, 16, v17
  v_and_b32 v15, 0xffff0000, v17
  v_mul_f32 v14, s33, v14
  v_mul_f32 v15, s33, v15
  v_cvt_pk_bf16_f32 v17, v14, v15
  v_lshlrev_b32 v14, 16, v18
  v_and_b32 v15, 0xffff0000, v18
  v_mul_f32 v14, s33, v14
  v_mul_f32 v15, s33, v15
  v_cvt_pk_bf16_f32 v18, v14, v15
  v_lshlrev_b32 v14, 16, v19
  v_and_b32 v15, 0xffff0000, v19
  v_mul_f32 v14, s33, v14
  v_mul_f32 v15, s33, v15
  v_cvt_pk_bf16_f32 v19, v14, v15
  s_waitcnt lgkmcnt(0)
  v_lshlrev_b32 v14, 16, v20
  v_and_b32 v15, 0xffff0000, v20
  v_mul_f32 v14, s33, v14
  v_mul_f32 v15, s33, v15
  v_cvt_pk_bf16_f32 v20, v14, v15
  v_lshlrev_b32 v14, 16, v21
  v_and_b32 v15, 0xffff0000, v21
  v_mul_f32 v14, s33, v14
  v_mul_f32 v15, s33, v15
  v_cvt_pk_bf16_f32 v21, v14, v15
  v_lshlrev_b32 v14, 16, v22
  v_and_b32 v15, 0xffff0000, v22
  v_mul_f32 v14, s33, v14
  buffer_load_dwordx4 v12, s[20:23], s43 offen offset:0 nt lds
  v_mul_f32 v15, s33, v15
  v_cvt_pk_bf16_f32 v22, v14, v15
  v_lshlrev_b32 v14, 16, v23
  v_and_b32 v15, 0xffff0000, v23
  v_mul_f32 v14, s33, v14
  v_mul_f32 v15, s33, v15
  v_cvt_pk_bf16_f32 v23, v14, v15
  ds_write_b128 v13, v[16:19] offset:16384
  ds_write_b128 v13, v[20:23] offset:17408
  s_waitcnt lgkmcnt(0)
  s_barrier
  ds_read_b128 a[32:35], v3 offset:8192
  ds_read_b128 a[36:39], v3 offset:8448
  ds_read_b128 a[40:43], v3 offset:8704
  ds_read_b128 a[44:47], v3 offset:8960
  ds_read_b128 a[48:51], v3 offset:9216
  ds_read_b128 a[52:55], v3 offset:9472
  ds_read_b128 a[56:59], v3 offset:9728
  ds_read_b128 a[60:63], v3 offset:9984
  ds_read_b128 a[192:195], v1 offset:16384
  ds_read_b128 a[196:199], v1 offset:16640
  buffer_load_dwordx4 v12, s[20:23], s43 offen offset:1024 nt lds
  s_add_u32 m0, s46, 32768
  s_add_u32 s43, s45, 32768
  s_waitcnt vmcnt(6)
  ds_read2st64_b32 v[16:17], v7 offset0:64 offset1:66
  ds_read2st64_b32 v[20:21], v7 offset0:65 offset1:67
  ds_read2st64_b32 v[18:19], v7 offset0:68 offset1:70
  ds_read2st64_b32 v[22:23], v7 offset0:69 offset1:71
  s_waitcnt lgkmcnt(9)
  v_mfma_f32_16x16x32_bf16 v[64:67], v[24:27], a[32:35], v[64:67]
  ds_read_b128 a[200:203], v1 offset:16896
  v_mfma_f32_16x16x32_bf16 v[68:71], v[24:27], a[36:39], v[68:71]
  ds_read_b128 a[204:207], v1 offset:17152
  v_mfma_f32_16x16x32_bf16 v[72:75], v[24:27], a[40:43], v[72:75]
  ds_read_b128 a[208:211], v1 offset:17408
  v_mfma_f32_16x16x32_bf16 v[76:79], v[24:27], a[44:47], v[76:79]
  ds_read_b128 a[212:215], v1 offset:17664
  v_mfma_f32_16x16x32_bf16 v[80:83], v[24:27], a[48:51], v[80:83]
  ds_read_b128 a[216:219], v1 offset:17920
  s_waitcnt lgkmcnt(8)
  v_mfma_f32_16x16x32_bf16 v[84:87], v[24:27], a[52:55], v[84:87]
  ds_read_b128 a[220:223], v1 offset:18176
  v_mfma_f32_16x16x32_bf16 v[88:91], v[24:27], a[56:59], v[88:91]
  s_waitcnt lgkmcnt(6)
  v_perm_b32 v14, v20, v16, s38
  v_perm_b32 v15, v21, v17, s38
  v_perm_b32 v20, v20, v16, s39
  v_perm_b32 v21, v21, v17, s39
  v_perm_b32 v16, v22, v18, s38
  v_perm_b32 v17, v23, v19, s38
  v_perm_b32 v22, v22, v18, s39
  v_perm_b32 v23, v23, v19, s39
  ds_write_b128 v6, v[14:17] offset:16384
  ds_write_b128 v6, v[20:23] offset:16640
  v_mfma_f32_16x16x32_bf16 v[92:95], v[24:27], a[60:63], v[92:95]
  v_mfma_f32_16x16x32_bf16 v[24:27], a[192:195], a[128:131], -4.0
  v_mfma_f32_16x16x32_bf16 v[24:27], a[196:199], a[132:135], v[24:27]
  buffer_load_dwordx4 v13, s[24:27], s43 offen offset:0 nt lds
  s_waitcnt lgkmcnt(2)
  v_mfma_f32_16x16x32_bf16 v[24:27], a[200:203], a[136:139], v[24:27]
  v_mfma_f32_16x16x32_bf16 v[24:27], a[204:207], a[140:143], v[24:27]
  v_mfma_f32_16x16x32_bf16 v[40:43], a[208:211], a[128:131], -4.0
  v_mfma_f32_16x16x32_bf16 v[40:43], a[212:215], a[132:135], v[40:43]
  v_mfma_f32_16x16x32_bf16 v[40:43], a[216:219], a[136:139], v[40:43]
  v_exp_f32 v24, v24
  v_mfma_f32_16x16x32_bf16 v[40:43], a[220:223], a[140:143], v[40:43]
  v_exp_f32 v25, v25
  v_mfma_f32_16x16x32_bf16 v[32:35], a[192:195], a[160:163], -4.0
  v_exp_f32 v26, v26
  v_mfma_f32_16x16x32_bf16 v[32:35], a[196:199], a[164:167], v[32:35]
  v_exp_f32 v27, v27
  v_mfma_f32_16x16x32_bf16 v[32:35], a[200:203], a[168:171], v[32:35]
  v_exp_f32 v40, v40
  v_mfma_f32_16x16x32_bf16 v[32:35], a[204:207], a[172:175], v[32:35]
  v_exp_f32 v41, v41
  v_exp_f32 v42, v42
  v_exp_f32 v43, v43
  v_cvt_pk_bf16_f32 v24, v24, v25
  v_cvt_pk_bf16_f32 v25, v26, v27
  v_cvt_pk_bf16_f32 v26, v40, v41
  v_cvt_pk_bf16_f32 v27, v42, v43
  v_mfma_f32_16x16x32_bf16 v[40:43], a[208:211], a[160:163], -4.0
  v_exp_f32 v32, v32
  v_mfma_f32_16x16x32_bf16 v[40:43], a[212:215], a[164:167], v[40:43]
  v_exp_f32 v33, v33
  v_mfma_f32_16x16x32_bf16 v[40:43], a[216:219], a[168:171], v[40:43]
  v_exp_f32 v34, v34
  v_mfma_f32_16x16x32_bf16 v[40:43], a[220:223], a[172:175], v[40:43]
  v_exp_f32 v35, v35
  v_mfma_f32_16x16x32_bf16 v[48:51], v[24:27], v[8:11], v[48:51]
  v_cvt_pk_bf16_f32 v32, v32, v33
  v_cvt_pk_bf16_f32 v33, v34, v35
  buffer_load_dwordx4 v13, s[24:27], s43 offen offset:1024 nt lds
  s_waitcnt vmcnt(6)
  ds_read_b128 v[16:19], v13 offset:24576
  ds_read_b128 v[20:23], v13 offset:25600
  v_exp_f32 v40, v40
  v_exp_f32 v41, v41
  v_exp_f32 v42, v42
  v_exp_f32 v43, v43
  v_cvt_pk_bf16_f32 v34, v40, v41
  v_cvt_pk_bf16_f32 v35, v42, v43
  s_waitcnt lgkmcnt(1)
  v_lshlrev_b32 v14, 16, v16
  v_and_b32 v15, 0xffff0000, v16
  v_mul_f32 v14, s33, v14
  v_mul_f32 v15, s33, v15
  v_cvt_pk_bf16_f32 v16, v14, v15
  v_lshlrev_b32 v14, 16, v17
  v_and_b32 v15, 0xffff0000, v17
  v_mul_f32 v14, s33, v14
  v_mul_f32 v15, s33, v15
  v_cvt_pk_bf16_f32 v17, v14, v15
  v_lshlrev_b32 v14, 16, v18
  v_and_b32 v15, 0xffff0000, v18
  v_mul_f32 v14, s33, v14
  v_mul_f32 v15, s33, v15
  v_cvt_pk_bf16_f32 v18, v14, v15
  v_lshlrev_b32 v14, 16, v19
  v_and_b32 v15, 0xffff0000, v19
  v_mul_f32 v14, s33, v14
  v_mul_f32 v15, s33, v15
  v_cvt_pk_bf16_f32 v19, v14, v15
  s_waitcnt lgkmcnt(0)
  v_lshlrev_b32 v14, 16, v20
  v_and_b32 v15, 0xffff0000, v20
  v_mul_f32 v14, s33, v14
  v_mul_f32 v15, s33, v15
  v_cvt_pk_bf16_f32 v20, v14, v15
  v_lshlrev_b32 v14, 16, v21
  v_and_b32 v15, 0xffff0000, v21
  v_mul_f32 v14, s33, v14
  v_mul_f32 v15, s33, v15
  v_cvt_pk_bf16_f32 v21, v14, v15
  v_lshlrev_b32 v14, 16, v22
  v_and_b32 v15, 0xffff0000, v22
  v_mul_f32 v14, s33, v14
  v_mul_f32 v15, s33, v15
  v_cvt_pk_bf16_f32 v22, v14, v15
  buffer_load_dwordx4 a[144:147], v4, s[16:19], s34 offen offset:0 nt
  v_lshlrev_b32 v14, 16, v23
  v_and_b32 v15, 0xffff0000, v23
  v_mul_f32 v14, s33, v14
  v_mul_f32 v15, s33, v15
  v_cvt_pk_bf16_f32 v23, v14, v15
  ds_write_b128 v13, v[16:19] offset:24576
  ds_write_b128 v13, v[20:23] offset:25600
  s_waitcnt lgkmcnt(0)
  s_barrier
  ds_read_b128 a[64:67], v3 offset:16384
  ds_read_b128 a[68:71], v3 offset:16640
  ds_read_b128 a[72:75], v3 offset:16896
  ds_read_b128 a[76:79], v3 offset:17152
  ds_read_b128 a[80:83], v3 offset:17408
  ds_read_b128 a[84:87], v3 offset:17664
  ds_read_b128 a[88:91], v3 offset:17920
  ds_read_b128 a[92:95], v3 offset:18176
  ds_read_b128 a[192:195], v1 offset:24576
  ds_read_b128 a[196:199], v1 offset:24832
  ds_read_b128 a[200:203], v1 offset:25088
  buffer_load_dwordx4 a[148:151], v4, s[16:19], s34 offen offset:64 nt
  s_waitcnt vmcnt(6)
  ds_read2st64_b32 v[16:17], v7 offset0:96 offset1:98
  ds_read2st64_b32 v[20:21], v7 offset0:97 offset1:99
  ds_read2st64_b32 v[18:19], v7 offset0:100 offset1:102
  ds_read2st64_b32 v[22:23], v7 offset0:101 offset1:103
  s_waitcnt lgkmcnt(10)
  v_mfma_f32_16x16x32_bf16 v[64:67], v[24:27], a[64:67], v[64:67]
  ds_read_b128 a[204:207], v1 offset:25344
  v_mfma_f32_16x16x32_bf16 v[68:71], v[24:27], a[68:71], v[68:71]
  ds_read_b128 a[208:211], v1 offset:25600
  v_mfma_f32_16x16x32_bf16 v[72:75], v[24:27], a[72:75], v[72:75]
  ds_read_b128 a[212:215], v1 offset:25856
  v_mfma_f32_16x16x32_bf16 v[76:79], v[24:27], a[76:79], v[76:79]
  ds_read_b128 a[216:219], v1 offset:26112
  v_mfma_f32_16x16x32_bf16 v[80:83], v[24:27], a[80:83], v[80:83]
  ds_read_b128 a[220:223], v1 offset:26368
  s_waitcnt lgkmcnt(8)
  v_mfma_f32_16x16x32_bf16 v[84:87], v[24:27], a[84:87], v[84:87]
  v_mfma_f32_16x16x32_bf16 v[88:91], v[24:27], a[88:91], v[88:91]
  s_waitcnt lgkmcnt(5)
  v_perm_b32 v14, v20, v16, s38
  v_perm_b32 v15, v21, v17, s38
  v_perm_b32 v20, v20, v16, s39
  v_perm_b32 v21, v21, v17, s39
  v_perm_b32 v16, v22, v18, s38
  v_perm_b32 v17, v23, v19, s38
  v_perm_b32 v22, v22, v18, s39
  v_perm_b32 v23, v23, v19, s39
  ds_write_b128 v6, v[14:17] offset:24576
  v_mfma_f32_16x16x32_bf16 v[92:95], v[24:27], a[92:95], v[92:95]
  ds_write_b128 v6, v[20:23] offset:24832
  v_mfma_f32_16x16x32_bf16 v[24:27], a[192:195], a[128:131], -4.0
  v_mfma_f32_16x16x32_bf16 v[24:27], a[196:199], a[132:135], v[24:27]
  v_mfma_f32_16x16x32_bf16 v[24:27], a[200:203], a[136:139], v[24:27]
  buffer_load_dwordx4 a[152:155], v4, s[16:19], s34 offen offset:128 nt
  s_waitcnt lgkmcnt(2)
  v_mfma_f32_16x16x32_bf16 v[24:27], a[204:207], a[140:143], v[24:27]
  v_mfma_f32_16x16x32_bf16 v[40:43], a[208:211], a[128:131], -4.0
  v_mfma_f32_16x16x32_bf16 v[40:43], a[212:215], a[132:135], v[40:43]
  v_mfma_f32_16x16x32_bf16 v[40:43], a[216:219], a[136:139], v[40:43]
  v_exp_f32 v24, v24
  v_mfma_f32_16x16x32_bf16 v[40:43], a[220:223], a[140:143], v[40:43]
  v_exp_f32 v25, v25
  v_mfma_f32_16x16x32_bf16 v[56:59], v[32:35], v[8:11], 0
  v_exp_f32 v26, v26
  v_mfma_f32_16x16x32_bf16 v[128:131], v[32:35], a[64:67], 0
  v_exp_f32 v27, v27
  v_mfma_f32_16x16x32_bf16 v[132:135], v[32:35], a[68:71], 0
  v_exp_f32 v40, v40
  v_mfma_f32_16x16x32_bf16 v[136:139], v[32:35], a[72:75], 0
  v_exp_f32 v41, v41
  v_mfma_f32_16x16x32_bf16 v[140:143], v[32:35], a[76:79], 0
  v_exp_f32 v42, v42
  v_mfma_f32_16x16x32_bf16 v[144:147], v[32:35], a[80:83], 0
  v_exp_f32 v43, v43
  v_mfma_f32_16x16x32_bf16 v[148:151], v[32:35], a[84:87], 0
  v_cvt_pk_bf16_f32 v24, v24, v25
  v_cvt_pk_bf16_f32 v25, v26, v27
  v_mfma_f32_16x16x32_bf16 v[152:155], v[32:35], a[88:91], 0
  v_cvt_pk_bf16_f32 v26, v40, v41
  v_cvt_pk_bf16_f32 v27, v42, v43
  v_mfma_f32_16x16x32_bf16 v[156:159], v[32:35], a[92:95], 0
  v_mfma_f32_16x16x32_bf16 v[32:35], a[192:195], a[160:163], -4.0
  v_mfma_f32_16x16x32_bf16 v[32:35], a[196:199], a[164:167], v[32:35]
  v_mfma_f32_16x16x32_bf16 v[32:35], a[200:203], a[168:171], v[32:35]
  buffer_load_dwordx4 a[156:159], v4, s[16:19], s34 offen offset:192 nt
  s_add_u32 s34, s34, 4096
  s_add_u32 m0, s44, 40960
  s_add_u32 s43, s45, 40960
  s_waitcnt vmcnt(6)
  ds_read_b128 v[16:19], v13 offset:32768
  ds_read_b128 v[20:23], v13 offset:33792
  v_mfma_f32_16x16x32_bf16 v[32:35], a[204:207], a[172:175], v[32:35]
  v_mfma_f32_16x16x32_bf16 v[40:43], a[208:211], a[160:163], -4.0
  v_mfma_f32_16x16x32_bf16 v[40:43], a[212:215], a[164:167], v[40:43]
  v_mfma_f32_16x16x32_bf16 v[40:43], a[216:219], a[168:171], v[40:43]
  v_exp_f32 v32, v32
  v_mfma_f32_16x16x32_bf16 v[40:43], a[220:223], a[172:175], v[40:43]
  v_exp_f32 v33, v33
  v_mfma_f32_16x16x32_bf16 v[48:51], v[24:27], v[8:11], v[48:51]
  v_exp_f32 v34, v34
  v_exp_f32 v35, v35
  v_cvt_pk_bf16_f32 v32, v32, v33
  s_nop 1
  v_exp_f32 v40, v40
  s_waitcnt lgkmcnt(0)
  v_lshlrev_b32 v14, 16, v16
  v_and_b32 v15, 0xffff0000, v16
  v_mul_f32 v14, s33, v14
  v_mul_f32 v15, s33, v15
  v_cvt_pk_bf16_f32 v16, v14, v15
  v_lshlrev_b32 v14, 16, v17
  v_and_b32 v15, 0xffff0000, v17
  v_mul_f32 v14, s33, v14
  v_mul_f32 v15, s33, v15
  v_cvt_pk_bf16_f32 v17, v14, v15
  v_lshlrev_b32 v14, 16, v18
  v_and_b32 v15, 0xffff0000, v18
  v_mul_f32 v14, s33, v14
  v_mul_f32 v15, s33, v15
  v_cvt_pk_bf16_f32 v18, v14, v15
  v_lshlrev_b32 v14, 16, v19
  v_and_b32 v15, 0xffff0000, v19
  v_mul_f32 v14, s33, v14
  v_mul_f32 v15, s33, v15
  v_cvt_pk_bf16_f32 v19, v14, v15
  v_lshlrev_b32 v14, 16, v20
  v_and_b32 v15, 0xffff0000, v20
  v_mul_f32 v14, s33, v14
  v_mul_f32 v15, s33, v15
  v_cvt_pk_bf16_f32 v20, v14, v15
  v_lshlrev_b32 v14, 16, v21
  v_and_b32 v15, 0xffff0000, v21
  v_mul_f32 v14, s33, v14
  v_mul_f32 v15, s33, v15
  v_cvt_pk_bf16_f32 v21, v14, v15
  v_lshlrev_b32 v14, 16, v22
  v_and_b32 v15, 0xffff0000, v22
  buffer_load_dwordx4 v12, s[20:23], s43 offen offset:0 nt lds
  v_mul_f32 v14, s33, v14
  v_mul_f32 v15, s33, v15
  v_cvt_pk_bf16_f32 v22, v14, v15
  v_lshlrev_b32 v14, 16, v23
  v_and_b32 v15, 0xffff0000, v23
  v_mul_f32 v14, s33, v14
  v_mul_f32 v15, s33, v15
  v_cvt_pk_bf16_f32 v23, v14, v15
  ds_write_b128 v13, v[16:19] offset:32768
  ds_write_b128 v13, v[20:23] offset:33792
  v_exp_f32 v41, v41
  v_exp_f32 v42, v42
  v_exp_f32 v43, v43
  v_cvt_pk_bf16_f32 v33, v34, v35
  v_cvt_pk_bf16_f32 v34, v40, v41
  v_cvt_pk_bf16_f32 v35, v42, v43
  s_waitcnt lgkmcnt(0)
  s_barrier
  ds_read_b128 a[96:99], v3 offset:24576
  ds_read_b128 a[100:103], v3 offset:24832
  ds_read_b128 a[104:107], v3 offset:25088
  ds_read_b128 a[108:111], v3 offset:25344
  ds_read_b128 a[112:115], v3 offset:25600
  ds_read_b128 a[116:119], v3 offset:25856
  ds_read_b128 a[120:123], v3 offset:26112
  ds_read_b128 a[124:127], v3 offset:26368
  ds_read_b128 a[192:195], v1 offset:32768
  buffer_load_dwordx4 v12, s[20:23], s43 offen offset:1024 nt lds
  s_add_u32 m0, s46, 40960
  s_add_u32 s43, s45, 40960
  s_waitcnt vmcnt(6)
  ds_read2st64_b32 v[16:17], v7 offset0:128 offset1:130
  ds_read2st64_b32 v[20:21], v7 offset0:129 offset1:131
  ds_read2st64_b32 v[18:19], v7 offset0:132 offset1:134
  ds_read2st64_b32 v[22:23], v7 offset0:133 offset1:135
  s_waitcnt lgkmcnt(9)
  v_mfma_f32_16x16x32_bf16 v[64:67], v[24:27], a[96:99], v[64:67]
  ds_read_b128 a[196:199], v1 offset:33024
  v_mfma_f32_16x16x32_bf16 v[68:71], v[24:27], a[100:103], v[68:71]
  ds_read_b128 a[200:203], v1 offset:33280
  v_mfma_f32_16x16x32_bf16 v[72:75], v[24:27], a[104:107], v[72:75]
  ds_read_b128 a[204:207], v1 offset:33536
  v_mfma_f32_16x16x32_bf16 v[76:79], v[24:27], a[108:111], v[76:79]
  ds_read_b128 a[208:211], v1 offset:33792
  s_waitcnt lgkmcnt(8)
  v_mfma_f32_16x16x32_bf16 v[80:83], v[24:27], a[112:115], v[80:83]
  ds_read_b128 a[212:215], v1 offset:34048
  v_mfma_f32_16x16x32_bf16 v[84:87], v[24:27], a[116:119], v[84:87]
  ds_read_b128 a[216:219], v1 offset:34304
  v_mfma_f32_16x16x32_bf16 v[88:91], v[24:27], a[120:123], v[88:91]
  ds_read_b128 a[220:223], v1 offset:34560
  s_waitcnt lgkmcnt(7)
  v_perm_b32 v14, v20, v16, s38
  v_perm_b32 v15, v21, v17, s38
  v_perm_b32 v20, v20, v16, s39
  v_perm_b32 v21, v21, v17, s39
  v_perm_b32 v16, v22, v18, s38
  v_perm_b32 v17, v23, v19, s38
  v_perm_b32 v22, v22, v18, s39
  v_perm_b32 v23, v23, v19, s39
  ds_write_b128 v6, v[14:17] offset:32768
  v_mfma_f32_16x16x32_bf16 v[92:95], v[24:27], a[124:127], v[92:95]
  ds_write_b128 v6, v[20:23] offset:33024
  v_mfma_f32_16x16x32_bf16 v[24:27], a[192:195], a[128:131], -4.0
  s_waitcnt lgkmcnt(3)
  v_mfma_f32_16x16x32_bf16 v[24:27], a[196:199], a[132:135], v[24:27]
  v_mfma_f32_16x16x32_bf16 v[24:27], a[200:203], a[136:139], v[24:27]
  buffer_load_dwordx4 v13, s[24:27], s43 offen offset:0 nt lds
  v_mfma_f32_16x16x32_bf16 v[24:27], a[204:207], a[140:143], v[24:27]
  v_mfma_f32_16x16x32_bf16 v[40:43], a[208:211], a[128:131], -4.0
  v_mfma_f32_16x16x32_bf16 v[40:43], a[212:215], a[132:135], v[40:43]
  v_mfma_f32_16x16x32_bf16 v[40:43], a[216:219], a[136:139], v[40:43]
  s_waitcnt lgkmcnt(0)
  v_exp_f32 v24, v24
  v_mfma_f32_16x16x32_bf16 v[40:43], a[220:223], a[140:143], v[40:43]
  v_exp_f32 v25, v25
  v_mfma_f32_16x16x32_bf16 v[56:59], v[32:35], v[8:11], v[56:59]
  v_exp_f32 v26, v26
  v_mfma_f32_16x16x32_bf16 v[128:131], v[32:35], a[96:99], v[128:131]
  v_exp_f32 v27, v27
  v_mfma_f32_16x16x32_bf16 v[132:135], v[32:35], a[100:103], v[132:135]
  v_exp_f32 v40, v40
  v_mfma_f32_16x16x32_bf16 v[136:139], v[32:35], a[104:107], v[136:139]
  v_exp_f32 v41, v41
  v_mfma_f32_16x16x32_bf16 v[140:143], v[32:35], a[108:111], v[140:143]
  v_exp_f32 v42, v42
  v_mfma_f32_16x16x32_bf16 v[144:147], v[32:35], a[112:115], v[144:147]
  v_exp_f32 v43, v43
  v_mfma_f32_16x16x32_bf16 v[148:151], v[32:35], a[116:119], v[148:151]
  v_cvt_pk_bf16_f32 v24, v24, v25
  v_cvt_pk_bf16_f32 v25, v26, v27
  v_mfma_f32_16x16x32_bf16 v[152:155], v[32:35], a[120:123], v[152:155]
  v_cvt_pk_bf16_f32 v26, v40, v41
  v_cvt_pk_bf16_f32 v27, v42, v43
  v_mfma_f32_16x16x32_bf16 v[156:159], v[32:35], a[124:127], v[156:159]
  v_mfma_f32_16x16x32_bf16 v[32:35], a[192:195], a[160:163], -4.0
  v_mfma_f32_16x16x32_bf16 v[32:35], a[196:199], a[164:167], v[32:35]
  v_mfma_f32_16x16x32_bf16 v[32:35], a[200:203], a[168:171], v[32:35]
  buffer_load_dwordx4 v13, s[24:27], s43 offen offset:1024 nt lds
  s_add_u32 m0, s44, 49152
  s_add_u32 s43, s45, 49152
  v_mfma_f32_16x16x32_bf16 v[32:35], a[204:207], a[172:175], v[32:35]
  v_mfma_f32_16x16x32_bf16 v[40:43], a[208:211], a[160:163], -4.0
  v_mfma_f32_16x16x32_bf16 v[40:43], a[212:215], a[164:167], v[40:43]
  v_mfma_f32_16x16x32_bf16 v[40:43], a[216:219], a[168:171], v[40:43]
  v_exp_f32 v32, v32
  v_mfma_f32_16x16x32_bf16 v[40:43], a[220:223], a[172:175], v[40:43]
  v_exp_f32 v33, v33
  v_mfma_f32_16x16x32_bf16 v[48:51], v[24:27], v[8:11], v[48:51]
  v_exp_f32 v34, v34
  v_exp_f32 v35, v35
  v_cvt_pk_bf16_f32 v32, v32, v33
  s_nop 1
  v_exp_f32 v40, v40
  v_exp_f32 v41, v41
  v_exp_f32 v42, v42
  v_exp_f32 v43, v43
  v_cvt_pk_bf16_f32 v33, v34, v35
  v_cvt_pk_bf16_f32 v34, v40, v41
  v_cvt_pk_bf16_f32 v35, v42, v43
  buffer_load_dwordx4 v12, s[20:23], s43 offen offset:0 nt lds
  buffer_load_dwordx4 v12, s[20:23], s43 offen offset:1024 nt lds
  s_add_u32 m0, s46, 49152
  s_add_u32 s43, s45, 49152
  buffer_load_dwordx4 v13, s[24:27], s43 offen offset:0 nt lds
  buffer_load_dwordx4 v13, s[24:27], s43 offen offset:1024 nt lds
  s_add_u32 m0, s44, 57344
  s_add_u32 s43, s45, 57344
  s_waitcnt vmcnt(6)
  ds_read_b128 v[16:19], v13 offset:40960
  ds_read_b128 v[20:23], v13 offset:41984
  s_waitcnt lgkmcnt(1)
  v_lshlrev_b32 v14, 16, v16
  v_and_b32 v15, 0xffff0000, v16
  v_mul_f32 v14, s33, v14
  v_mul_f32 v15, s33, v15
  v_cvt_pk_bf16_f32 v16, v14, v15
  v_lshlrev_b32 v14, 16, v17
  v_and_b32 v15, 0xffff0000, v17
  v_mul_f32 v14, s33, v14
  v_mul_f32 v15, s33, v15
  v_cvt_pk_bf16_f32 v17, v14, v15
  v_lshlrev_b32 v14, 16, v18
  v_and_b32 v15, 0xffff0000, v18
  v_mul_f32 v14, s33, v14
  v_mul_f32 v15, s33, v15
  v_cvt_pk_bf16_f32 v18, v14, v15
  v_lshlrev_b32 v14, 16, v19
  v_and_b32 v15, 0xffff0000, v19
  v_mul_f32 v14, s33, v14
  v_mul_f32 v15, s33, v15
  v_cvt_pk_bf16_f32 v19, v14, v15
  s_waitcnt lgkmcnt(0)
  v_lshlrev_b32 v14, 16, v20
  v_and_b32 v15, 0xffff0000, v20
  v_mul_f32 v14, s33, v14
  v_mul_f32 v15, s33, v15
  v_cvt_pk_bf16_f32 v20, v14, v15
  v_lshlrev_b32 v14, 16, v21
  v_and_b32 v15, 0xffff0000, v21
  v_mul_f32 v14, s33, v14
  v_mul_f32 v15, s33, v15
  v_cvt_pk_bf16_f32 v21, v14, v15
  v_lshlrev_b32 v14, 16, v22
  v_and_b32 v15, 0xffff0000, v22
  v_mul_f32 v14, s33, v14
  buffer_load_dwordx4 v12, s[20:23], s43 offen offset:0 nt lds
  v_mul_f32 v15, s33, v15
  v_cvt_pk_bf16_f32 v22, v14, v15
  v_lshlrev_b32 v14, 16, v23
  v_and_b32 v15, 0xffff0000, v23
  v_mul_f32 v14, s33, v14
  v_mul_f32 v15, s33, v15
  v_cvt_pk_bf16_f32 v23, v14, v15
  ds_write_b128 v13, v[16:19] offset:40960
  ds_write_b128 v13, v[20:23] offset:41984
  s_waitcnt lgkmcnt(0)
  s_barrier
  ds_read_b128 a[224:227], v3 offset:32768
  ds_read_b128 a[228:231], v3 offset:33024
  ds_read_b128 a[232:235], v3 offset:33280
  ds_read_b128 a[236:239], v3 offset:33536
  ds_read_b128 a[240:243], v3 offset:33792
  ds_read_b128 a[244:247], v3 offset:34048
  ds_read_b128 a[248:251], v3 offset:34304
  ds_read_b128 a[252:255], v3 offset:34560
  ds_read_b128 a[192:195], v1 offset:40960
  ds_read_b128 a[196:199], v1 offset:41216
  buffer_load_dwordx4 v12, s[20:23], s43 offen offset:1024 nt lds
  s_add_u32 m0, s46, 57344
  s_add_u32 s43, s45, 57344
  s_waitcnt vmcnt(6)
  ds_read2st64_b32 v[16:17], v7 offset0:160 offset1:162
  ds_read2st64_b32 v[20:21], v7 offset0:161 offset1:163
  s_waitcnt lgkmcnt(9)
  v_mfma_f32_16x16x32_bf16 v[64:67], v[24:27], a[224:227], v[64:67]
  ds_read_b128 a[200:203], v1 offset:41472
  v_mfma_f32_16x16x32_bf16 v[68:71], v[24:27], a[228:231], v[68:71]
  ds_read2st64_b32 v[18:19], v7 offset0:164 offset1:166
  v_mfma_f32_16x16x32_bf16 v[72:75], v[24:27], a[232:235], v[72:75]
  ds_read2st64_b32 v[22:23], v7 offset0:165 offset1:167
  s_waitcnt lgkmcnt(6)
  v_mfma_f32_16x16x32_bf16 v[76:79], v[24:27], a[236:239], v[76:79]
  ds_read_b128 a[204:207], v1 offset:41728
  v_mfma_f32_16x16x32_bf16 v[80:83], v[24:27], a[240:243], v[80:83]
  ds_read_b128 a[208:211], v1 offset:41984
  v_mfma_f32_16x16x32_bf16 v[84:87], v[24:27], a[244:247], v[84:87]
  ds_read_b128 a[212:215], v1 offset:42240
  v_mfma_f32_16x16x32_bf16 v[88:91], v[24:27], a[248:251], v[88:91]
  ds_read_b128 a[216:219], v1 offset:42496
  v_mfma_f32_16x16x32_bf16 v[92:95], v[24:27], a[252:255], v[92:95]
  ds_read_b128 a[220:223], v1 offset:42752
  s_waitcnt lgkmcnt(7)
  v_perm_b32 v14, v20, v16, s38
  v_mfma_f32_16x16x32_bf16 v[24:27], a[192:195], a[128:131], -4.0
  v_perm_b32 v15, v21, v17, s38
  v_perm_b32 v20, v20, v16, s39
  v_mfma_f32_16x16x32_bf16 v[24:27], a[196:199], a[132:135], v[24:27]
  v_perm_b32 v21, v21, v17, s39
  v_mfma_f32_16x16x32_bf16 v[24:27], a[200:203], a[136:139], v[24:27]
  s_waitcnt lgkmcnt(4)
  v_perm_b32 v16, v22, v18, s38
  v_perm_b32 v17, v23, v19, s38
  v_perm_b32 v22, v22, v18, s39
  v_mfma_f32_16x16x32_bf16 v[24:27], a[204:207], a[140:143], v[24:27]
  s_waitcnt lgkmcnt(2)
  v_perm_b32 v23, v23, v19, s39
  v_mfma_f32_16x16x32_bf16 v[40:43], a[208:211], a[128:131], -4.0
  ds_write_b128 v6, v[14:17] offset:40960
  v_mfma_f32_16x16x32_bf16 v[40:43], a[212:215], a[132:135], v[40:43]
  ds_write_b128 v6, v[20:23] offset:41216
  buffer_load_dwordx4 v13, s[24:27], s43 offen offset:0 nt lds
  s_waitcnt lgkmcnt(2)
  v_mfma_f32_16x16x32_bf16 v[40:43], a[216:219], a[136:139], v[40:43]
  v_exp_f32 v24, v24
  v_mfma_f32_16x16x32_bf16 v[40:43], a[220:223], a[140:143], v[40:43]
  v_exp_f32 v25, v25
  v_mfma_f32_16x16x32_bf16 v[28:31], a[192:195], a[144:147], -4.0
  v_exp_f32 v26, v26
  v_mfma_f32_16x16x32_bf16 v[28:31], a[196:199], a[148:151], v[28:31]
  v_exp_f32 v27, v27
  v_mfma_f32_16x16x32_bf16 v[28:31], a[200:203], a[152:155], v[28:31]
  v_exp_f32 v40, v40
  v_mfma_f32_16x16x32_bf16 v[28:31], a[204:207], a[156:159], v[28:31]
  v_exp_f32 v41, v41
  v_mfma_f32_16x16x32_bf16 v[44:47], a[208:211], a[144:147], -4.0
  v_exp_f32 v42, v42
  v_mfma_f32_16x16x32_bf16 v[44:47], a[212:215], a[148:151], v[44:47]
  v_exp_f32 v43, v43
  v_mfma_f32_16x16x32_bf16 v[44:47], a[216:219], a[152:155], v[44:47]
  v_cvt_pk_bf16_f32 v24, v24, v25
  v_cvt_pk_bf16_f32 v25, v26, v27
  v_mfma_f32_16x16x32_bf16 v[44:47], a[220:223], a[156:159], v[44:47]
  v_cvt_pk_bf16_f32 v26, v40, v41
  v_cvt_pk_bf16_f32 v27, v42, v43
  v_mfma_f32_16x16x32_bf16 v[56:59], v[32:35], v[8:11], v[56:59]
  v_exp_f32 v28, v28
  v_mfma_f32_16x16x32_bf16 v[128:131], v[32:35], a[224:227], v[128:131]
  v_exp_f32 v29, v29
  v_mfma_f32_16x16x32_bf16 v[132:135], v[32:35], a[228:231], v[132:135]
  v_exp_f32 v30, v30
  v_mfma_f32_16x16x32_bf16 v[136:139], v[32:35], a[232:235], v[136:139]
  v_exp_f32 v31, v31
  v_mfma_f32_16x16x32_bf16 v[140:143], v[32:35], a[236:239], v[140:143]
  v_exp_f32 v44, v44
  v_mfma_f32_16x16x32_bf16 v[144:147], v[32:35], a[240:243], v[144:147]
  v_exp_f32 v45, v45
  buffer_load_dwordx4 v13, s[24:27], s43 offen offset:1024 nt lds
  s_waitcnt vmcnt(6)
  ds_read_b128 v[16:19], v13 offset:49152
  ds_read_b128 v[20:23], v13 offset:50176
  v_mfma_f32_16x16x32_bf16 v[148:151], v[32:35], a[244:247], v[148:151]
  v_exp_f32 v46, v46
  v_mfma_f32_16x16x32_bf16 v[152:155], v[32:35], a[248:251], v[152:155]
  v_exp_f32 v47, v47
  v_mfma_f32_16x16x32_bf16 v[156:159], v[32:35], a[252:255], v[156:159]
  v_cvt_pk_bf16_f32 v28, v28, v29
  v_cvt_pk_bf16_f32 v29, v30, v31
  v_mfma_f32_16x16x32_bf16 v[32:35], a[192:195], a[160:163], -4.0
  v_cvt_pk_bf16_f32 v30, v44, v45
  v_cvt_pk_bf16_f32 v31, v46, v47
  v_mfma_f32_16x16x32_bf16 v[32:35], a[196:199], a[164:167], v[32:35]
  v_mfma_f32_16x16x32_bf16 v[32:35], a[200:203], a[168:171], v[32:35]
  v_mfma_f32_16x16x32_bf16 v[32:35], a[204:207], a[172:175], v[32:35]
  v_mfma_f32_16x16x32_bf16 v[40:43], a[208:211], a[160:163], -4.0
  s_waitcnt lgkmcnt(0)
  v_lshlrev_b32 v14, 16, v16
  v_and_b32 v15, 0xffff0000, v16
  v_mul_f32 v14, s33, v14
  v_mul_f32 v15, s33, v15
  v_cvt_pk_bf16_f32 v16, v14, v15
  v_lshlrev_b32 v14, 16, v17
  v_and_b32 v15, 0xffff0000, v17
  v_mul_f32 v14, s33, v14
  v_mul_f32 v15, s33, v15
  v_cvt_pk_bf16_f32 v17, v14, v15
  v_lshlrev_b32 v14, 16, v18
  v_and_b32 v15, 0xffff0000, v18
  v_mul_f32 v14, s33, v14
  v_mul_f32 v15, s33, v15
  v_cvt_pk_bf16_f32 v18, v14, v15
  v_lshlrev_b32 v14, 16, v19
  v_and_b32 v15, 0xffff0000, v19
  v_mul_f32 v14, s33, v14
  v_mul_f32 v15, s33, v15
  v_cvt_pk_bf16_f32 v19, v14, v15
  v_lshlrev_b32 v14, 16, v20
  v_and_b32 v15, 0xffff0000, v20
  v_mul_f32 v14, s33, v14
  v_mul_f32 v15, s33, v15
  v_cvt_pk_bf16_f32 v20, v14, v15
  v_lshlrev_b32 v14, 16, v21
  v_and_b32 v15, 0xffff0000, v21
  v_mul_f32 v14, s33, v14
  v_mul_f32 v15, s33, v15
  v_cvt_pk_bf16_f32 v21, v14, v15
  v_lshlrev_b32 v14, 16, v22
  v_and_b32 v15, 0xffff0000, v22
  v_mul_f32 v14, s33, v14
  buffer_load_dwordx4 a[176:179], v4, s[16:19], s34 offen offset:0 nt
  v_mul_f32 v15, s33, v15
  v_cvt_pk_bf16_f32 v22, v14, v15
  v_lshlrev_b32 v14, 16, v23
  v_and_b32 v15, 0xffff0000, v23
  v_mul_f32 v14, s33, v14
  v_mul_f32 v15, s33, v15
  v_cvt_pk_bf16_f32 v23, v14, v15
  ds_write_b128 v13, v[16:19] offset:49152
  ds_write_b128 v13, v[20:23] offset:50176
  v_mfma_f32_16x16x32_bf16 v[40:43], a[212:215], a[164:167], v[40:43]
  v_exp_f32 v32, v32
  v_mfma_f32_16x16x32_bf16 v[40:43], a[216:219], a[168:171], v[40:43]
  v_exp_f32 v33, v33
  v_mfma_f32_16x16x32_bf16 v[40:43], a[220:223], a[172:175], v[40:43]
  v_exp_f32 v34, v34
  v_mfma_f32_16x16x32_bf16 v[48:51], v[24:27], v[8:11], v[48:51]
  v_exp_f32 v35, v35
  v_cvt_pk_bf16_f32 v32, v32, v33
  v_cvt_pk_bf16_f32 v33, v34, v35
  s_waitcnt lgkmcnt(0)
  s_barrier
  ds_read_b128 a[224:227], v3 offset:40960
  ds_read_b128 a[228:231], v3 offset:41216
  ds_read_b128 a[232:235], v3 offset:41472
  ds_read_b128 a[236:239], v3 offset:41728
  ds_read_b128 a[240:243], v3 offset:41984
  ds_read_b128 a[244:247], v3 offset:42240
  ds_read_b128 a[248:251], v3 offset:42496
  ds_read_b128 a[252:255], v3 offset:42752
  ds_read_b128 a[192:195], v1 offset:49152
  ds_read_b128 a[196:199], v1 offset:49408
  buffer_load_dwordx4 a[180:183], v4, s[16:19], s34 offen offset:64 nt
  s_waitcnt vmcnt(6)
  ds_read2st64_b32 v[16:17], v7 offset0:192 offset1:194
  ds_read2st64_b32 v[20:21], v7 offset0:193 offset1:195
  ds_read_b128 a[200:203], v1 offset:49664
  s_waitcnt lgkmcnt(10)
  v_mfma_f32_16x16x32_bf16 v[64:67], v[24:27], a[224:227], v[64:67]
  ds_read2st64_b32 v[18:19], v7 offset0:196 offset1:198
  v_mfma_f32_16x16x32_bf16 v[68:71], v[24:27], a[228:231], v[68:71]
  ds_read2st64_b32 v[22:23], v7 offset0:197 offset1:199
  v_mfma_f32_16x16x32_bf16 v[72:75], v[24:27], a[232:235], v[72:75]
  ds_read_b128 a[204:207], v1 offset:49920
  s_waitcnt lgkmcnt(7)
  v_mfma_f32_16x16x32_bf16 v[76:79], v[24:27], a[236:239], v[76:79]
  ds_read_b128 a[208:211], v1 offset:50176
  v_mfma_f32_16x16x32_bf16 v[80:83], v[24:27], a[240:243], v[80:83]
  ds_read_b128 a[212:215], v1 offset:50432
  v_mfma_f32_16x16x32_bf16 v[84:87], v[24:27], a[244:247], v[84:87]
  ds_read_b128 a[216:219], v1 offset:50688
  v_mfma_f32_16x16x32_bf16 v[88:91], v[24:27], a[248:251], v[88:91]
  ds_read_b128 a[220:223], v1 offset:50944
  s_waitcnt lgkmcnt(7)
  v_perm_b32 v14, v20, v16, s38
  v_mfma_f32_16x16x32_bf16 v[92:95], v[24:27], a[252:255], v[92:95]
  v_perm_b32 v15, v21, v17, s38
  v_perm_b32 v20, v20, v16, s39
  v_mfma_f32_16x16x32_bf16 v[52:55], v[28:31], v[8:11], 0
  v_perm_b32 v21, v21, v17, s39
  v_mfma_f32_16x16x32_bf16 v[96:99], v[28:31], a[224:227], 0
  s_waitcnt lgkmcnt(4)
  v_perm_b32 v16, v22, v18, s38
  v_perm_b32 v17, v23, v19, s38
  v_mfma_f32_16x16x32_bf16 v[100:103], v[28:31], a[228:231], 0
  v_perm_b32 v22, v22, v18, s39
  v_perm_b32 v23, v23, v19, s39
  v_mfma_f32_16x16x32_bf16 v[104:107], v[28:31], a[232:235], 0
  ds_write_b128 v6, v[14:17] offset:49152
  v_mfma_f32_16x16x32_bf16 v[108:111], v[28:31], a[236:239], 0
  v_exp_f32 v40, v40
  v_mfma_f32_16x16x32_bf16 v[112:115], v[28:31], a[240:243], 0
  v_exp_f32 v41, v41
  v_mfma_f32_16x16x32_bf16 v[116:119], v[28:31], a[244:247], 0
  buffer_load_dwordx4 a[184:187], v4, s[16:19], s34 offen offset:128 nt
  v_mfma_f32_16x16x32_bf16 v[120:123], v[28:31], a[248:251], 0
  v_exp_f32 v42, v42
  v_mfma_f32_16x16x32_bf16 v[124:127], v[28:31], a[252:255], 0
  v_exp_f32 v43, v43
  v_mfma_f32_16x16x32_bf16 v[24:27], a[192:195], a[128:131], -4.0
  v_cvt_pk_bf16_f32 v34, v40, v41
  v_cvt_pk_bf16_f32 v35, v42, v43
  v_mfma_f32_16x16x32_bf16 v[24:27], a[196:199], a[132:135], v[24:27]
  ds_write_b128 v6, v[20:23] offset:49408
  v_mfma_f32_16x16x32_bf16 v[24:27], a[200:203], a[136:139], v[24:27]
  v_mfma_f32_16x16x32_bf16 v[24:27], a[204:207], a[140:143], v[24:27]
  s_waitcnt lgkmcnt(1)
  v_mfma_f32_16x16x32_bf16 v[40:43], a[208:211], a[128:131], -4.0
  v_mfma_f32_16x16x32_bf16 v[40:43], a[212:215], a[132:135], v[40:43]
  v_mfma_f32_16x16x32_bf16 v[40:43], a[216:219], a[136:139], v[40:43]
  v_exp_f32 v24, v24
  v_mfma_f32_16x16x32_bf16 v[40:43], a[220:223], a[140:143], v[40:43]
  v_exp_f32 v25, v25
  v_mfma_f32_16x16x32_bf16 v[28:31], a[192:195], a[144:147], -4.0
  v_exp_f32 v26, v26
  v_mfma_f32_16x16x32_bf16 v[28:31], a[196:199], a[148:151], v[28:31]
  v_exp_f32 v27, v27
  v_mfma_f32_16x16x32_bf16 v[28:31], a[200:203], a[152:155], v[28:31]
  v_exp_f32 v40, v40
  v_mfma_f32_16x16x32_bf16 v[28:31], a[204:207], a[156:159], v[28:31]
  v_exp_f32 v41, v41
  v_mfma_f32_16x16x32_bf16 v[44:47], a[208:211], a[144:147], -4.0
  v_exp_f32 v42, v42
  v_mfma_f32_16x16x32_bf16 v[44:47], a[212:215], a[148:151], v[44:47]
  v_exp_f32 v43, v43
  buffer_load_dwordx4 a[188:191], v4, s[16:19], s34 offen offset:192 nt
  s_add_u32 s34, s34, 4096
  s_add_u32 m0, s44, 65536
  s_add_u32 s43, s45, 65536
  s_waitcnt vmcnt(6)
  ds_read_b128 v[16:19], v13 offset:57344
  ds_read_b128 v[20:23], v13 offset:58368
  v_mfma_f32_16x16x32_bf16 v[44:47], a[216:219], a[152:155], v[44:47]
  v_cvt_pk_bf16_f32 v24, v24, v25
  v_cvt_pk_bf16_f32 v25, v26, v27
  v_mfma_f32_16x16x32_bf16 v[44:47], a[220:223], a[156:159], v[44:47]
  v_cvt_pk_bf16_f32 v26, v40, v41
  v_cvt_pk_bf16_f32 v27, v42, v43
  v_mfma_f32_16x16x32_bf16 v[56:59], v[32:35], v[8:11], v[56:59]
  v_exp_f32 v28, v28
  v_mfma_f32_16x16x32_bf16 v[128:131], v[32:35], a[224:227], v[128:131]
  v_exp_f32 v29, v29
  v_mfma_f32_16x16x32_bf16 v[132:135], v[32:35], a[228:231], v[132:135]
  v_exp_f32 v30, v30
  v_mfma_f32_16x16x32_bf16 v[136:139], v[32:35], a[232:235], v[136:139]
  v_exp_f32 v31, v31
  v_mfma_f32_16x16x32_bf16 v[140:143], v[32:35], a[236:239], v[140:143]
  v_exp_f32 v44, v44
  v_mfma_f32_16x16x32_bf16 v[144:147], v[32:35], a[240:243], v[144:147]
  s_waitcnt lgkmcnt(0)
  v_lshlrev_b32 v14, 16, v16
  v_and_b32 v15, 0xffff0000, v16
  v_mul_f32 v14, s33, v14
  v_mul_f32 v15, s33, v15
  v_cvt_pk_bf16_f32 v16, v14, v15
  v_lshlrev_b32 v14, 16, v17
  v_and_b32 v15, 0xffff0000, v17
  v_mul_f32 v14, s33, v14
  v_mul_f32 v15, s33, v15
  v_cvt_pk_bf16_f32 v17, v14, v15
  v_lshlrev_b32 v14, 16, v18
  v_and_b32 v15, 0xffff0000, v18
  v_mul_f32 v14, s33, v14
  v_mul_f32 v15, s33, v15
  v_cvt_pk_bf16_f32 v18, v14, v15
  v_lshlrev_b32 v14, 16, v19
  v_and_b32 v15, 0xffff0000, v19
  v_mul_f32 v14, s33, v14
  v_mul_f32 v15, s33, v15
  v_cvt_pk_bf16_f32 v19, v14, v15
  v_lshlrev_b32 v14, 16, v20
  v_and_b32 v15, 0xffff0000, v20
  v_mul_f32 v14, s33, v14
  v_mul_f32 v15, s33, v15
  v_cvt_pk_bf16_f32 v20, v14, v15
  v_lshlrev_b32 v14, 16, v21
  v_and_b32 v15, 0xffff0000, v21
  v_mul_f32 v14, s33, v14
  v_mul_f32 v15, s33, v15
  v_cvt_pk_bf16_f32 v21, v14, v15
  v_lshlrev_b32 v14, 16, v22
  buffer_load_dwordx4 v12, s[20:23], s43 offen offset:0 nt lds
  v_and_b32 v15, 0xffff0000, v22
  v_mul_f32 v14, s33, v14
  v_mul_f32 v15, s33, v15
  v_cvt_pk_bf16_f32 v22, v14, v15
  v_lshlrev_b32 v14, 16, v23
  v_and_b32 v15, 0xffff0000, v23
  v_mul_f32 v14, s33, v14
  v_mul_f32 v15, s33, v15
  v_cvt_pk_bf16_f32 v23, v14, v15
  ds_write_b128 v13, v[16:19] offset:57344
  ds_write_b128 v13, v[20:23] offset:58368
  v_mfma_f32_16x16x32_bf16 v[148:151], v[32:35], a[244:247], v[148:151]
  v_exp_f32 v45, v45
  v_mfma_f32_16x16x32_bf16 v[152:155], v[32:35], a[248:251], v[152:155]
  v_exp_f32 v46, v46
  v_mfma_f32_16x16x32_bf16 v[156:159], v[32:35], a[252:255], v[156:159]
  v_exp_f32 v47, v47
  v_mfma_f32_16x16x32_bf16 v[32:35], a[192:195], a[160:163], -4.0
  v_cvt_pk_bf16_f32 v28, v28, v29
  v_cvt_pk_bf16_f32 v29, v30, v31
  v_mfma_f32_16x16x32_bf16 v[32:35], a[196:199], a[164:167], v[32:35]
  v_cvt_pk_bf16_f32 v30, v44, v45
  v_cvt_pk_bf16_f32 v31, v46, v47
  v_mfma_f32_16x16x32_bf16 v[32:35], a[200:203], a[168:171], v[32:35]
  s_waitcnt lgkmcnt(0)
  s_barrier
  v_mfma_f32_16x16x32_bf16 v[32:35], a[204:207], a[172:175], v[32:35]
  ds_read_b128 a[224:227], v3 offset:49152
  v_mfma_f32_16x16x32_bf16 v[40:43], a[208:211], a[160:163], -4.0
  ds_read_b128 a[228:231], v3 offset:49408
  v_mfma_f32_16x16x32_bf16 v[40:43], a[212:215], a[164:167], v[40:43]
  ds_read_b128 a[232:235], v3 offset:49664
  v_mfma_f32_16x16x32_bf16 v[40:43], a[216:219], a[168:171], v[40:43]
  ds_read_b128 a[236:239], v3 offset:49920
  buffer_load_dwordx4 v12, s[20:23], s43 offen offset:1024 nt lds
  s_add_u32 m0, s46, 0
  s_add_u32 s43, s45, 65536
  v_mfma_f32_16x16x32_bf16 v[40:43], a[220:223], a[172:175], v[40:43]
  ds_read_b128 a[240:243], v3 offset:50176
  v_mfma_f32_16x16x32_bf16 v[48:51], v[24:27], v[8:11], v[48:51]
  ds_read_b128 a[244:247], v3 offset:50432
  ds_read_b128 a[248:251], v3 offset:50688
  ds_read_b128 a[252:255], v3 offset:50944
  s_waitcnt lgkmcnt(6)
  v_mfma_f32_16x16x32_bf16 v[64:67], v[24:27], a[224:227], v[64:67]
  ds_read_b128 a[192:195], v1 offset:57344
  v_mfma_f32_16x16x32_bf16 v[68:71], v[24:27], a[228:231], v[68:71]
  ds_read_b128 a[196:199], v1 offset:57600
  s_waitcnt lgkmcnt(6)
  v_mfma_f32_16x16x32_bf16 v[72:75], v[24:27], a[232:235], v[72:75]
  s_waitcnt vmcnt(6)
  ds_read2st64_b32 v[16:17], v7 offset0:224 offset1:226
  v_mfma_f32_16x16x32_bf16 v[76:79], v[24:27], a[236:239], v[76:79]
  ds_read2st64_b32 v[20:21], v7 offset0:225 offset1:227
  ds_read_b128 a[200:203], v1 offset:57856
  ds_read2st64_b32 v[18:19], v7 offset0:228 offset1:230
  ds_read2st64_b32 v[22:23], v7 offset0:229 offset1:231
  s_waitcnt lgkmcnt(9)
  v_mfma_f32_16x16x32_bf16 v[80:83], v[24:27], a[240:243], v[80:83]
  ds_read_b128 a[204:207], v1 offset:58112
  v_mfma_f32_16x16x32_bf16 v[84:87], v[24:27], a[244:247], v[84:87]
  ds_read_b128 a[208:211], v1 offset:58368
  s_waitcnt lgkmcnt(8)
  v_mfma_f32_16x16x32_bf16 v[88:91], v[24:27], a[248:251], v[88:91]
  ds_read_b128 a[212:215], v1 offset:58624
  v_mfma_f32_16x16x32_bf16 v[92:95], v[24:27], a[252:255], v[92:95]
  ds_read_b128 a[216:219], v1 offset:58880
  v_mfma_f32_16x16x32_bf16 v[52:55], v[28:31], v[8:11], v[52:55]
  ds_read_b128 a[220:223], v1 offset:59136
  v_mfma_f32_16x16x32_bf16 v[96:99], v[28:31], a[224:227], v[96:99]
  v_exp_f32 v32, v32
  v_mfma_f32_16x16x32_bf16 v[100:103], v[28:31], a[228:231], v[100:103]
  s_waitcnt lgkmcnt(5)
  v_perm_b32 v14, v20, v16, s38
  v_perm_b32 v15, v21, v17, s38
  v_mfma_f32_16x16x32_bf16 v[104:107], v[28:31], a[232:235], v[104:107]
  v_perm_b32 v20, v20, v16, s39
  v_perm_b32 v21, v21, v17, s39
  buffer_load_dwordx4 v13, s[24:27], s43 offen offset:0 nt lds
  v_mfma_f32_16x16x32_bf16 v[108:111], v[28:31], a[236:239], v[108:111]
  v_exp_f32 v33, v33
  v_mfma_f32_16x16x32_bf16 v[112:115], v[28:31], a[240:243], v[112:115]
  v_perm_b32 v16, v22, v18, s38
  v_perm_b32 v17, v23, v19, s38
  v_mfma_f32_16x16x32_bf16 v[116:119], v[28:31], a[244:247], v[116:119]
  v_exp_f32 v34, v34
  v_mfma_f32_16x16x32_bf16 v[120:123], v[28:31], a[248:251], v[120:123]
  v_exp_f32 v35, v35
  v_mfma_f32_16x16x32_bf16 v[124:127], v[28:31], a[252:255], v[124:127]
  v_perm_b32 v22, v22, v18, s39
  v_perm_b32 v23, v23, v19, s39
  v_mfma_f32_16x16x32_bf16 v[24:27], a[192:195], a[128:131], -4.0
  ds_write_b128 v6, v[14:17] offset:57344
  v_mfma_f32_16x16x32_bf16 v[24:27], a[196:199], a[132:135], v[24:27]
  v_exp_f32 v40, v40
  v_mfma_f32_16x16x32_bf16 v[24:27], a[200:203], a[136:139], v[24:27]
  s_waitcnt lgkmcnt(1)
  v_exp_f32 v41, v41
  v_mfma_f32_16x16x32_bf16 v[24:27], a[204:207], a[140:143], v[24:27]
  ds_write_b128 v6, v[20:23] offset:57600
  v_exp_f32 v42, v42
  v_exp_f32 v43, v43
  v_cvt_pk_bf16_f32 v32, v32, v33
  v_cvt_pk_bf16_f32 v33, v34, v35
  v_cvt_pk_bf16_f32 v34, v40, v41
  v_cvt_pk_bf16_f32 v35, v42, v43
  v_mfma_f32_16x16x32_bf16 v[40:43], a[208:211], a[128:131], -4.0
  v_exp_f32 v24, v24
  v_mfma_f32_16x16x32_bf16 v[40:43], a[212:215], a[132:135], v[40:43]
  v_exp_f32 v25, v25
  v_mfma_f32_16x16x32_bf16 v[40:43], a[216:219], a[136:139], v[40:43]
  v_exp_f32 v26, v26
  v_mfma_f32_16x16x32_bf16 v[40:43], a[220:223], a[140:143], v[40:43]
  v_exp_f32 v27, v27
  v_mfma_f32_16x16x32_bf16 v[28:31], a[192:195], a[144:147], -4.0
  v_cvt_pk_bf16_f32 v24, v24, v25
  v_cvt_pk_bf16_f32 v25, v26, v27
  buffer_load_dwordx4 v13, s[24:27], s43 offen offset:1024 nt lds
  s_add_u32 m0, s44, 73728
  s_add_u32 s43, s45, 73728
  v_mfma_f32_16x16x32_bf16 v[28:31], a[196:199], a[148:151], v[28:31]
  v_exp_f32 v40, v40
  v_mfma_f32_16x16x32_bf16 v[28:31], a[200:203], a[152:155], v[28:31]
  v_exp_f32 v41, v41
  v_mfma_f32_16x16x32_bf16 v[28:31], a[204:207], a[156:159], v[28:31]
  v_exp_f32 v42, v42
  v_mfma_f32_16x16x32_bf16 v[44:47], a[208:211], a[144:147], -4.0
  v_exp_f32 v43, v43
  v_mfma_f32_16x16x32_bf16 v[44:47], a[212:215], a[148:151], v[44:47]
  v_cvt_pk_bf16_f32 v26, v40, v41
  v_cvt_pk_bf16_f32 v27, v42, v43
  v_mfma_f32_16x16x32_bf16 v[44:47], a[216:219], a[152:155], v[44:47]
  v_exp_f32 v28, v28
  v_mfma_f32_16x16x32_bf16 v[44:47], a[220:223], a[156:159], v[44:47]
  v_exp_f32 v29, v29
  v_mfma_f32_16x16x32_bf16 v[56:59], v[32:35], v[8:11], v[56:59]
  v_exp_f32 v30, v30
  v_mfma_f32_16x16x32_bf16 v[128:131], v[32:35], a[224:227], v[128:131]
  v_exp_f32 v31, v31
  v_mfma_f32_16x16x32_bf16 v[132:135], v[32:35], a[228:231], v[132:135]
  v_exp_f32 v44, v44
  v_mfma_f32_16x16x32_bf16 v[136:139], v[32:35], a[232:235], v[136:139]
  v_exp_f32 v45, v45
  v_mfma_f32_16x16x32_bf16 v[140:143], v[32:35], a[236:239], v[140:143]
  v_exp_f32 v46, v46
  v_mfma_f32_16x16x32_bf16 v[144:147], v[32:35], a[240:243], v[144:147]
  v_exp_f32 v47, v47
  v_mfma_f32_16x16x32_bf16 v[148:151], v[32:35], a[244:247], v[148:151]
  v_cvt_pk_bf16_f32 v28, v28, v29
  v_cvt_pk_bf16_f32 v29, v30, v31
  v_mfma_f32_16x16x32_bf16 v[152:155], v[32:35], a[248:251], v[152:155]
  v_cvt_pk_bf16_f32 v30, v44, v45
  v_cvt_pk_bf16_f32 v31, v46, v47
  v_mfma_f32_16x16x32_bf16 v[156:159], v[32:35], a[252:255], v[156:159]
  buffer_load_dwordx4 v12, s[20:23], s43 offen offset:0 nt lds
  v_mfma_f32_16x16x32_bf16 v[32:35], a[192:195], a[160:163], -4.0
  v_mfma_f32_16x16x32_bf16 v[32:35], a[196:199], a[164:167], v[32:35]
  v_mfma_f32_16x16x32_bf16 v[32:35], a[200:203], a[168:171], v[32:35]
  v_mfma_f32_16x16x32_bf16 v[32:35], a[204:207], a[172:175], v[32:35]
  v_mfma_f32_16x16x32_bf16 v[40:43], a[208:211], a[160:163], -4.0
  v_mfma_f32_16x16x32_bf16 v[40:43], a[212:215], a[164:167], v[40:43]
  v_mfma_f32_16x16x32_bf16 v[40:43], a[216:219], a[168:171], v[40:43]
  v_exp_f32 v32, v32
  v_mfma_f32_16x16x32_bf16 v[40:43], a[220:223], a[172:175], v[40:43]
  v_exp_f32 v33, v33
  v_mfma_f32_16x16x32_bf16 v[48:51], v[24:27], v[8:11], v[48:51]
  v_exp_f32 v34, v34
  v_exp_f32 v35, v35
  v_cvt_pk_bf16_f32 v32, v32, v33
  s_nop 1
  v_exp_f32 v40, v40
  v_exp_f32 v41, v41
  v_exp_f32 v42, v42
  v_exp_f32 v43, v43
  v_cvt_pk_bf16_f32 v33, v34, v35
  v_cvt_pk_bf16_f32 v34, v40, v41
  v_cvt_pk_bf16_f32 v35, v42, v43
  buffer_load_dwordx4 v12, s[20:23], s43 offen offset:1024 nt lds
  s_add_u32 m0, s46, 8192
  s_add_u32 s43, s45, 73728
  buffer_load_dwordx4 v13, s[24:27], s43 offen offset:0 nt lds
  buffer_load_dwordx4 v13, s[24:27], s43 offen offset:1024 nt lds
  s_add_u32 m0, s44, 81920
  s_add_u32 s43, s45, 81920
  s_waitcnt vmcnt(6)
  ds_read_b128 v[16:19], v5 offset:0
  ds_read_b128 v[20:23], v5 offset:1024
  s_waitcnt lgkmcnt(1)
  v_lshlrev_b32 v14, 16, v16
  v_and_b32 v15, 0xffff0000, v16
  v_mul_f32 v14, s33, v14
  v_mul_f32 v15, s33, v15
  v_cvt_pk_bf16_f32 v16, v14, v15
  v_lshlrev_b32 v14, 16, v17
  v_and_b32 v15, 0xffff0000, v17
  v_mul_f32 v14, s33, v14
  v_mul_f32 v15, s33, v15
  v_cvt_pk_bf16_f32 v17, v14, v15
  v_lshlrev_b32 v14, 16, v18
  v_and_b32 v15, 0xffff0000, v18
  v_mul_f32 v14, s33, v14
  v_mul_f32 v15, s33, v15
  v_cvt_pk_bf16_f32 v18, v14, v15
  v_lshlrev_b32 v14, 16, v19
  v_and_b32 v15, 0xffff0000, v19
  v_mul_f32 v14, s33, v14
  v_mul_f32 v15, s33, v15
  v_cvt_pk_bf16_f32 v19, v14, v15
  s_waitcnt lgkmcnt(0)
  v_lshlrev_b32 v14, 16, v20
  v_and_b32 v15, 0xffff0000, v20
  v_mul_f32 v14, s33, v14
  v_mul_f32 v15, s33, v15
  v_cvt_pk_bf16_f32 v20, v14, v15
  v_lshlrev_b32 v14, 16, v21
  v_and_b32 v15, 0xffff0000, v21
  v_mul_f32 v14, s33, v14
  v_mul_f32 v15, s33, v15
  v_cvt_pk_bf16_f32 v21, v14, v15
  v_lshlrev_b32 v14, 16, v22
  v_and_b32 v15, 0xffff0000, v22
  v_mul_f32 v14, s33, v14
  buffer_load_dwordx4 v12, s[20:23], s43 offen offset:0 nt lds
  v_mul_f32 v15, s33, v15
  v_cvt_pk_bf16_f32 v22, v14, v15
  v_lshlrev_b32 v14, 16, v23
  v_and_b32 v15, 0xffff0000, v23
  v_mul_f32 v14, s33, v14
  v_mul_f32 v15, s33, v15
  v_cvt_pk_bf16_f32 v23, v14, v15
  ds_write_b128 v5, v[16:19] offset:0
  ds_write_b128 v5, v[20:23] offset:1024
  s_waitcnt lgkmcnt(0)
  s_barrier
  ds_read_b128 a[224:227], v3 offset:57344
  ds_read_b128 a[228:231], v3 offset:57600
  ds_read_b128 a[232:235], v3 offset:57856
  ds_read_b128 a[236:239], v3 offset:58112
  ds_read_b128 a[240:243], v3 offset:58368
  ds_read_b128 a[244:247], v3 offset:58624
  ds_read_b128 a[248:251], v3 offset:58880
  ds_read_b128 a[252:255], v3 offset:59136
  ds_read_b128 a[192:195], v2 offset:0
  ds_read_b128 a[196:199], v2 offset:256
  buffer_load_dwordx4 v12, s[20:23], s43 offen offset:1024 nt lds
  s_add_u32 m0, s46, 16384
  s_add_u32 s43, s45, 81920
  ds_read_b128 a[200:203], v2 offset:512
  ds_read_b128 a[204:207], v2 offset:768
  s_waitcnt lgkmcnt(10)
  v_mfma_f32_16x16x32_bf16 v[64:67], v[24:27], a[224:227], v[64:67]
  ds_read_b128 a[208:211], v2 offset:1024
  v_mfma_f32_16x16x32_bf16 v[68:71], v[24:27], a[228:231], v[68:71]
  ds_read_b128 a[212:215], v2 offset:1280
  s_waitcnt lgkmcnt(8)
  v_mfma_f32_16x16x32_bf16 v[72:75], v[24:27], a[232:235], v[72:75]
  ds_read_b128 a[216:219], v2 offset:1536
  v_mfma_f32_16x16x32_bf16 v[76:79], v[24:27], a[236:239], v[76:79]
  ds_read_b128 a[220:223], v2 offset:1792
  v_mfma_f32_16x16x32_bf16 v[80:83], v[24:27], a[240:243], v[80:83]
  s_waitcnt vmcnt(6)
  ds_read2st64_b32 v[16:17], v7 offset0:0 offset1:2
  v_mfma_f32_16x16x32_bf16 v[84:87], v[24:27], a[244:247], v[84:87]
  ds_read2st64_b32 v[20:21], v7 offset0:1 offset1:3
  s_waitcnt lgkmcnt(7)
  v_mfma_f32_16x16x32_bf16 v[88:91], v[24:27], a[248:251], v[88:91]
  ds_read2st64_b32 v[18:19], v7 offset0:4 offset1:6
  v_mfma_f32_16x16x32_bf16 v[92:95], v[24:27], a[252:255], v[92:95]
  ds_read2st64_b32 v[22:23], v7 offset0:5 offset1:7
  v_mfma_f32_16x16x32_bf16 v[52:55], v[28:31], v[8:11], v[52:55]
  v_mfma_f32_16x16x32_bf16 v[96:99], v[28:31], a[224:227], v[96:99]
  v_mfma_f32_16x16x32_bf16 v[100:103], v[28:31], a[228:231], v[100:103]
  v_mfma_f32_16x16x32_bf16 v[104:107], v[28:31], a[232:235], v[104:107]
  v_mfma_f32_16x16x32_bf16 v[108:111], v[28:31], a[236:239], v[108:111]
  v_mfma_f32_16x16x32_bf16 v[112:115], v[28:31], a[240:243], v[112:115]
  s_waitcnt lgkmcnt(1)
  v_perm_b32 v14, v20, v16, s38
  v_perm_b32 v15, v21, v17, s38
  v_mfma_f32_16x16x32_bf16 v[116:119], v[28:31], a[244:247], v[116:119]
  v_perm_b32 v20, v20, v16, s39
  v_perm_b32 v21, v21, v17, s39
  buffer_load_dwordx4 v13, s[24:27], s43 offen offset:0 nt lds
  v_mfma_f32_16x16x32_bf16 v[120:123], v[28:31], a[248:251], v[120:123]
  s_waitcnt lgkmcnt(0)
  v_perm_b32 v16, v22, v18, s38
  v_perm_b32 v17, v23, v19, s38
  v_mfma_f32_16x16x32_bf16 v[124:127], v[28:31], a[252:255], v[124:127]
  v_perm_b32 v22, v22, v18, s39
  v_perm_b32 v23, v23, v19, s39
  v_mfma_f32_16x16x32_bf16 v[24:27], a[192:195], a[128:131], -4.0
  ds_write_b128 v6, v[14:17] offset:0
  v_mfma_f32_16x16x32_bf16 v[24:27], a[196:199], a[132:135], v[24:27]
  ds_write_b128 v6, v[20:23] offset:256
  v_mfma_f32_16x16x32_bf16 v[24:27], a[200:203], a[136:139], v[24:27]
  v_mfma_f32_16x16x32_bf16 v[24:27], a[204:207], a[140:143], v[24:27]
  v_mfma_f32_16x16x32_bf16 v[40:43], a[208:211], a[128:131], -4.0
  v_mfma_f32_16x16x32_bf16 v[40:43], a[212:215], a[132:135], v[40:43]
  v_mfma_f32_16x16x32_bf16 v[40:43], a[216:219], a[136:139], v[40:43]
  v_exp_f32 v24, v24
  v_mfma_f32_16x16x32_bf16 v[40:43], a[220:223], a[140:143], v[40:43]
  v_exp_f32 v25, v25
  v_mfma_f32_16x16x32_bf16 v[28:31], a[192:195], a[144:147], -4.0
  v_exp_f32 v26, v26
  v_mfma_f32_16x16x32_bf16 v[28:31], a[196:199], a[148:151], v[28:31]
  v_exp_f32 v27, v27
  v_mfma_f32_16x16x32_bf16 v[28:31], a[200:203], a[152:155], v[28:31]
  v_exp_f32 v40, v40
  v_mfma_f32_16x16x32_bf16 v[28:31], a[204:207], a[156:159], v[28:31]
  v_exp_f32 v41, v41
  v_mfma_f32_16x16x32_bf16 v[44:47], a[208:211], a[144:147], -4.0
  v_exp_f32 v42, v42
  v_mfma_f32_16x16x32_bf16 v[44:47], a[212:215], a[148:151], v[44:47]
  buffer_load_dwordx4 v13, s[24:27], s43 offen offset:1024 nt lds
  s_add_u32 m0, s44, 90112
  s_add_u32 s43, s45, 90112
  v_mfma_f32_16x16x32_bf16 v[44:47], a[216:219], a[152:155], v[44:47]
  s_waitcnt vmcnt(6)
  ds_read_b128 v[16:19], v5 offset:8192
  v_cvt_pk_bf16_f32 v24, v24, v25
  v_mfma_f32_16x16x32_bf16 v[44:47], a[220:223], a[156:159], v[44:47]
  ds_read_b128 v[20:23], v5 offset:9216
  v_cvt_pk_bf16_f32 v25, v26, v27
  v_mfma_f32_16x16x32_bf16 v[56:59], v[32:35], v[8:11], v[56:59]
  v_exp_f32 v43, v43
  v_mfma_f32_16x16x32_bf16 v[128:131], v[32:35], a[224:227], v[128:131]
  v_cvt_pk_bf16_f32 v26, v40, v41
  v_cvt_pk_bf16_f32 v27, v42, v43
  v_mfma_f32_16x16x32_bf16 v[132:135], v[32:35], a[228:231], v[132:135]
  v_exp_f32 v28, v28
  v_mfma_f32_16x16x32_bf16 v[136:139], v[32:35], a[232:235], v[136:139]
  v_exp_f32 v29, v29
  v_mfma_f32_16x16x32_bf16 v[140:143], v[32:35], a[236:239], v[140:143]
  v_exp_f32 v30, v30
  v_mfma_f32_16x16x32_bf16 v[144:147], v[32:35], a[240:243], v[144:147]
  v_exp_f32 v31, v31
  v_mfma_f32_16x16x32_bf16 v[148:151], v[32:35], a[244:247], v[148:151]
  s_waitcnt lgkmcnt(0)
  v_lshlrev_b32 v14, 16, v16
  v_and_b32 v15, 0xffff0000, v16
  v_mfma_f32_16x16x32_bf16 v[152:155], v[32:35], a[248:251], v[152:155]
  v_mul_f32 v14, s33, v14
  v_mul_f32 v15, s33, v15
  v_cvt_pk_bf16_f32 v16, v14, v15
  v_lshlrev_b32 v14, 16, v17
  v_and_b32 v15, 0xffff0000, v17
  v_mfma_f32_16x16x32_bf16 v[156:159], v[32:35], a[252:255], v[156:159]
  v_mul_f32 v14, s33, v14
  v_mul_f32 v15, s33, v15
  v_cvt_pk_bf16_f32 v17, v14, v15
  v_lshlrev_b32 v14, 16, v18
  v_and_b32 v15, 0xffff0000, v18
  v_mul_f32 v14, s33, v14
  v_mul_f32 v15, s33, v15
  v_mfma_f32_16x16x32_bf16 v[32:35], a[192:195], a[160:163], -4.0
  v_cvt_pk_bf16_f32 v18, v14, v15
  v_lshlrev_b32 v14, 16, v19
  v_and_b32 v15, 0xffff0000, v19
  v_mul_f32 v14, s33, v14
  v_mul_f32 v15, s33, v15
  v_cvt_pk_bf16_f32 v19, v14, v15
  v_mfma_f32_16x16x32_bf16 v[32:35], a[196:199], a[164:167], v[32:35]
  v_lshlrev_b32 v14, 16, v20
  v_and_b32 v15, 0xffff0000, v20
  v_mul_f32 v14, s33, v14
  v_mul_f32 v15, s33, v15
  buffer_load_dwordx4 v12, s[20:23], s43 offen offset:0 nt lds
  v_cvt_pk_bf16_f32 v20, v14, v15
  v_lshlrev_b32 v14, 16, v21
  v_and_b32 v15, 0xffff0000, v21
  v_mfma_f32_16x16x32_bf16 v[32:35], a[200:203], a[168:171], v[32:35]
  v_mul_f32 v14, s33, v14
  v_mul_f32 v15, s33, v15
  v_cvt_pk_bf16_f32 v21, v14, v15
  v_lshlrev_b32 v14, 16, v22
  v_and_b32 v15, 0xffff0000, v22
  v_mul_f32 v14, s33, v14
  v_mul_f32 v15, s33, v15
  v_mfma_f32_16x16x32_bf16 v[32:35], a[204:207], a[172:175], v[32:35]
  v_cvt_pk_bf16_f32 v22, v14, v15
  v_lshlrev_b32 v14, 16, v23
  v_and_b32 v15, 0xffff0000, v23
  v_mul_f32 v14, s33, v14
  v_mul_f32 v15, s33, v15
  v_cvt_pk_bf16_f32 v23, v14, v15
  v_mfma_f32_16x16x32_bf16 v[40:43], a[208:211], a[160:163], -4.0
  ds_write_b128 v5, v[16:19] offset:8192
  ds_write_b128 v5, v[20:23] offset:9216
  v_mfma_f32_16x16x32_bf16 v[40:43], a[212:215], a[164:167], v[40:43]
  v_exp_f32 v44, v44
  v_mfma_f32_16x16x32_bf16 v[40:43], a[216:219], a[168:171], v[40:43]
  v_exp_f32 v45, v45
  v_mfma_f32_16x16x32_bf16 v[40:43], a[220:223], a[172:175], v[40:43]
  v_exp_f32 v46, v46
  v_mfma_f32_16x16x32_bf16 v[36:39], a[192:195], a[176:179], -4.0
  v_exp_f32 v47, v47
  v_mfma_f32_16x16x32_bf16 v[36:39], a[196:199], a[180:183], v[36:39]
  v_cvt_pk_bf16_f32 v28, v28, v29
  v_cvt_pk_bf16_f32 v29, v30, v31
  v_mfma_f32_16x16x32_bf16 v[36:39], a[200:203], a[184:187], v[36:39]
  s_waitcnt lgkmcnt(0)
  s_barrier
  v_mfma_f32_16x16x32_bf16 v[36:39], a[204:207], a[188:191], v[36:39]
  ds_read_b128 a[224:227], v3 offset:0
  buffer_load_dwordx4 v12, s[20:23], s43 offen offset:1024 nt lds
  s_add_u32 m0, s46, 24576
  s_add_u32 s43, s45, 90112
  ds_read_b128 a[228:231], v3 offset:256
  ds_read_b128 a[232:235], v3 offset:512
  v_cvt_pk_bf16_f32 v30, v44, v45
  v_cvt_pk_bf16_f32 v31, v46, v47
  v_mfma_f32_16x16x32_bf16 v[44:47], a[208:211], a[176:179], -4.0
  ds_read_b128 a[236:239], v3 offset:768
  s_cmp_ge_u32 s34, s36
  v_mfma_f32_16x16x32_bf16 v[44:47], a[212:215], a[180:183], v[44:47]
  ds_read_b128 a[240:243], v3 offset:1024
  s_cselect_b32 s18, 0, s18
  v_mfma_f32_16x16x32_bf16 v[44:47], a[216:219], a[184:187], v[44:47]
  ds_read_b128 a[244:247], v3 offset:1280
  v_mfma_f32_16x16x32_bf16 v[44:47], a[220:223], a[188:191], v[44:47]
  ds_read_b128 a[248:251], v3 offset:1536
  v_mfma_f32_16x16x32_bf16 v[48:51], v[24:27], v[8:11], v[48:51]
  ds_read_b128 a[252:255], v3 offset:1792
  s_waitcnt lgkmcnt(7)
  v_mfma_f32_16x16x32_bf16 v[64:67], v[24:27], a[224:227], v[64:67]
  ds_read_b128 a[192:195], v2 offset:8192
  ds_read_b128 a[196:199], v2 offset:8448
  s_waitcnt lgkmcnt(7)
  v_mfma_f32_16x16x32_bf16 v[68:71], v[24:27], a[228:231], v[68:71]
  ds_read_b128 a[200:203], v2 offset:8704
  v_mfma_f32_16x16x32_bf16 v[72:75], v[24:27], a[232:235], v[72:75]
  ds_read_b128 a[204:207], v2 offset:8960
  s_waitcnt lgkmcnt(7)
  v_mfma_f32_16x16x32_bf16 v[76:79], v[24:27], a[236:239], v[76:79]
  ds_read_b128 a[208:211], v2 offset:9216
  v_mfma_f32_16x16x32_bf16 v[80:83], v[24:27], a[240:243], v[80:83]
  ds_read_b128 a[212:215], v2 offset:9472
  s_waitcnt lgkmcnt(7)
  v_mfma_f32_16x16x32_bf16 v[84:87], v[24:27], a[244:247], v[84:87]
  ds_read_b128 a[216:219], v2 offset:9728
  v_mfma_f32_16x16x32_bf16 v[88:91], v[24:27], a[248:251], v[88:91]
  ds_read_b128 a[220:223], v2 offset:9984
  s_waitcnt lgkmcnt(7)
  v_mfma_f32_16x16x32_bf16 v[92:95], v[24:27], a[252:255], v[92:95]
  v_exp_f32 v32, v32
  v_mfma_f32_16x16x32_bf16 v[52:55], v[28:31], v[8:11], v[52:55]
  v_exp_f32 v33, v33
  v_mfma_f32_16x16x32_bf16 v[96:99], v[28:31], a[224:227], v[96:99]
  buffer_load_dwordx4 v13, s[24:27], s43 offen offset:0 nt lds
  v_mfma_f32_16x16x32_bf16 v[100:103], v[28:31], a[228:231], v[100:103]
  v_exp_f32 v34, v34
  v_mfma_f32_16x16x32_bf16 v[104:107], v[28:31], a[232:235], v[104:107]
  v_exp_f32 v35, v35
  v_mfma_f32_16x16x32_bf16 v[108:111], v[28:31], a[236:239], v[108:111]
  v_exp_f32 v40, v40
  v_mfma_f32_16x16x32_bf16 v[112:115], v[28:31], a[240:243], v[112:115]
  v_exp_f32 v41, v41
  v_mfma_f32_16x16x32_bf16 v[116:119], v[28:31], a[244:247], v[116:119]
  v_exp_f32 v42, v42
  v_mfma_f32_16x16x32_bf16 v[120:123], v[28:31], a[248:251], v[120:123]
  v_exp_f32 v43, v43
  v_mfma_f32_16x16x32_bf16 v[124:127], v[28:31], a[252:255], v[124:127]
  v_cvt_pk_bf16_f32 v32, v32, v33
  v_cvt_pk_bf16_f32 v33, v34, v35
  v_mfma_f32_16x16x32_bf16 v[24:27], a[192:195], a[128:131], -4.0
  s_waitcnt lgkmcnt(0)
  v_cvt_pk_bf16_f32 v34, v40, v41
  v_cvt_pk_bf16_f32 v35, v42, v43
  v_mfma_f32_16x16x32_bf16 v[24:27], a[196:199], a[132:135], v[24:27]
  v_exp_f32 v36, v36
  v_mfma_f32_16x16x32_bf16 v[24:27], a[200:203], a[136:139], v[24:27]
  v_exp_f32 v37, v37
  v_mfma_f32_16x16x32_bf16 v[24:27], a[204:207], a[140:143], v[24:27]
  v_exp_f32 v38, v38
  v_mfma_f32_16x16x32_bf16 v[40:43], a[208:211], a[128:131], -4.0
  v_exp_f32 v39, v39
  v_mfma_f32_16x16x32_bf16 v[40:43], a[212:215], a[132:135], v[40:43]
  s_waitcnt vmcnt(7)
  ds_read2st64_b32 v[16:17], v7 offset0:32 offset1:34
  v_cvt_pk_bf16_f32 v36, v36, v37
  v_mfma_f32_16x16x32_bf16 v[40:43], a[216:219], a[136:139], v[40:43]
  ds_read2st64_b32 v[20:21], v7 offset0:33 offset1:35
  v_cvt_pk_bf16_f32 v37, v38, v39
  v_mfma_f32_16x16x32_bf16 v[40:43], a[220:223], a[140:143], v[40:43]
  v_exp_f32 v44, v44
  v_mfma_f32_16x16x32_bf16 v[28:31], a[192:195], a[144:147], -4.0
  v_exp_f32 v45, v45
  v_mfma_f32_16x16x32_bf16 v[28:31], a[196:199], a[148:151], v[28:31]
  v_exp_f32 v46, v46
  buffer_load_dwordx4 v13, s[24:27], s43 offen offset:1024 nt lds
  v_mfma_f32_16x16x32_bf16 v[28:31], a[200:203], a[152:155], v[28:31]
  v_exp_f32 v47, v47
  v_mfma_f32_16x16x32_bf16 v[28:31], a[204:207], a[156:159], v[28:31]
  ds_read2st64_b32 v[18:19], v7 offset0:36 offset1:38
  ds_read2st64_b32 v[22:23], v7 offset0:37 offset1:39
  v_cvt_pk_bf16_f32 v38, v44, v45
  v_cvt_pk_bf16_f32 v39, v46, v47
  v_mfma_f32_16x16x32_bf16 v[44:47], a[208:211], a[144:147], -4.0
  s_waitcnt lgkmcnt(2)
  v_perm_b32 v14, v20, v16, s38
  v_perm_b32 v15, v21, v17, s38
  v_mfma_f32_16x16x32_bf16 v[44:47], a[212:215], a[148:151], v[44:47]
  v_perm_b32 v20, v20, v16, s39
  v_perm_b32 v21, v21, v17, s39
  v_mfma_f32_16x16x32_bf16 v[44:47], a[216:219], a[152:155], v[44:47]
  v_exp_f32 v24, v24
  v_mfma_f32_16x16x32_bf16 v[44:47], a[220:223], a[156:159], v[44:47]
  v_exp_f32 v25, v25
  v_mfma_f32_16x16x32_bf16 v[56:59], v[32:35], v[8:11], v[56:59]
  v_exp_f32 v26, v26
  v_mfma_f32_16x16x32_bf16 v[128:131], v[32:35], a[224:227], v[128:131]
  v_exp_f32 v27, v27
  v_mfma_f32_16x16x32_bf16 v[132:135], v[32:35], a[228:231], v[132:135]
  v_exp_f32 v40, v40
  v_mfma_f32_16x16x32_bf16 v[136:139], v[32:35], a[232:235], v[136:139]
  s_waitcnt lgkmcnt(0)
  v_perm_b32 v16, v22, v18, s38
  v_perm_b32 v17, v23, v19, s38
  v_mfma_f32_16x16x32_bf16 v[140:143], v[32:35], a[236:239], v[140:143]
  v_perm_b32 v22, v22, v18, s39
  v_perm_b32 v23, v23, v19, s39
  v_mfma_f32_16x16x32_bf16 v[144:147], v[32:35], a[240:243], v[144:147]
  ds_write_b128 v6, v[14:17] offset:8192
  v_mfma_f32_16x16x32_bf16 v[148:151], v[32:35], a[244:247], v[148:151]
  s_waitcnt vmcnt(6)
  ds_read_b128 v[16:19], v5 offset:16384
  v_cvt_pk_bf16_f32 v24, v24, v25
  v_mfma_f32_16x16x32_bf16 v[152:155], v[32:35], a[248:251], v[152:155]
  ds_write_b128 v6, v[20:23] offset:8448
  v_mfma_f32_16x16x32_bf16 v[156:159], v[32:35], a[252:255], v[156:159]
  ds_read_b128 v[20:23], v5 offset:17408
  v_cvt_pk_bf16_f32 v25, v26, v27
  buffer_load_dwordx4 v[192:195], v4, s[16:19], s34 offen offset:0
  v_mfma_f32_16x16x32_bf16 v[60:63], v[36:39], v[8:11], 0
  v_exp_f32 v41, v41
  v_mfma_f32_16x16x32_bf16 v[160:163], v[36:39], a[224:227], 0
  v_exp_f32 v42, v42
  v_mfma_f32_16x16x32_bf16 v[164:167], v[36:39], a[228:231], 0
  v_exp_f32 v43, v43
  v_mfma_f32_16x16x32_bf16 v[168:171], v[36:39], a[232:235], 0
  s_waitcnt lgkmcnt(1)
  v_lshlrev_b32 v14, 16, v16
  v_and_b32 v15, 0xffff0000, v16
  v_mfma_f32_16x16x32_bf16 v[172:175], v[36:39], a[236:239], 0
  v_mul_f32 v14, s33, v14
  v_mul_f32 v15, s33, v15
  v_mfma_f32_16x16x32_bf16 v[176:179], v[36:39], a[240:243], 0
  v_cvt_pk_bf16_f32 v16, v14, v15
  v_lshlrev_b32 v14, 16, v17
  v_mfma_f32_16x16x32_bf16 v[180:183], v[36:39], a[244:247], 0
  v_and_b32 v15, 0xffff0000, v17
  v_mul_f32 v14, s33, v14
  v_mfma_f32_16x16x32_bf16 v[184:187], v[36:39], a[248:251], 0
  v_mul_f32 v15, s33, v15
  v_cvt_pk_bf16_f32 v17, v14, v15
  v_mfma_f32_16x16x32_bf16 v[188:191], v[36:39], a[252:255], 0
  v_lshlrev_b32 v14, 16, v18
  v_and_b32 v15, 0xffff0000, v18
  v_mul_f32 v14, s33, v14
  v_mul_f32 v15, s33, v15
  v_mfma_f32_16x16x32_bf16 v[32:35], a[192:195], a[160:163], -4.0
  v_cvt_pk_bf16_f32 v18, v14, v15
  v_lshlrev_b32 v14, 16, v19
  v_and_b32 v15, 0xffff0000, v19
  v_mul_f32 v14, s33, v14
  v_mul_f32 v15, s33, v15
  v_cvt_pk_bf16_f32 v19, v14, v15
  v_mfma_f32_16x16x32_bf16 v[32:35], a[196:199], a[164:167], v[32:35]
  s_waitcnt lgkmcnt(0)
  v_lshlrev_b32 v14, 16, v20
  v_and_b32 v15, 0xffff0000, v20
  v_mul_f32 v14, s33, v14
  v_mul_f32 v15, s33, v15
  v_cvt_pk_bf16_f32 v20, v14, v15
  v_lshlrev_b32 v14, 16, v21
  v_and_b32 v15, 0xffff0000, v21
  v_mfma_f32_16x16x32_bf16 v[32:35], a[200:203], a[168:171], v[32:35]
  v_mul_f32 v14, s33, v14
  v_mul_f32 v15, s33, v15
  v_cvt_pk_bf16_f32 v21, v14, v15
  v_lshlrev_b32 v14, 16, v22
  v_and_b32 v15, 0xffff0000, v22
  v_mul_f32 v14, s33, v14
  v_mul_f32 v15, s33, v15
  v_mfma_f32_16x16x32_bf16 v[32:35], a[204:207], a[172:175], v[32:35]
  ds_write_b128 v5, v[16:19] offset:16384
  buffer_load_dwordx4 v[196:199], v4, s[16:19], s34 offen offset:64
  v_cvt_pk_bf16_f32 v22, v14, v15
  v_lshlrev_b32 v14, 16, v23
  v_and_b32 v15, 0xffff0000, v23
  v_mul_f32 v14, s33, v14
  v_mul_f32 v15, s33, v15
  v_cvt_pk_bf16_f32 v23, v14, v15
  ds_write_b128 v5, v[20:23] offset:17408
  v_cvt_pk_bf16_f32 v26, v40, v41
  v_cvt_pk_bf16_f32 v27, v42, v43
  v_mfma_f32_16x16x32_bf16 v[40:43], a[208:211], a[160:163], -4.0
  v_exp_f32 v28, v28
  v_mfma_f32_16x16x32_bf16 v[40:43], a[212:215], a[164:167], v[40:43]
  v_exp_f32 v29, v29
  v_mfma_f32_16x16x32_bf16 v[40:43], a[216:219], a[168:171], v[40:43]
  v_exp_f32 v30, v30
  v_mfma_f32_16x16x32_bf16 v[40:43], a[220:223], a[172:175], v[40:43]
  v_exp_f32 v31, v31
  v_mfma_f32_16x16x32_bf16 v[36:39], a[192:195], a[176:179], -4.0
  s_waitcnt lgkmcnt(0)
  s_barrier
  v_mfma_f32_16x16x32_bf16 v[36:39], a[196:199], a[180:183], v[36:39]
  ds_read_b128 a[224:227], v3 offset:8192
  v_cvt_pk_bf16_f32 v28, v28, v29
  v_mfma_f32_16x16x32_bf16 v[36:39], a[200:203], a[184:187], v[36:39]
  ds_read_b128 a[228:231], v3 offset:8448
  v_cvt_pk_bf16_f32 v29, v30, v31
  v_mfma_f32_16x16x32_bf16 v[36:39], a[204:207], a[188:191], v[36:39]
  ds_read_b128 a[232:235], v3 offset:8704
  v_exp_f32 v44, v44
  v_exp_f32 v45, v45
  v_exp_f32 v46, v46
  v_exp_f32 v47, v47
  v_cvt_pk_bf16_f32 v30, v44, v45
  v_cvt_pk_bf16_f32 v31, v46, v47
  buffer_load_dwordx4 v[200:203], v4, s[16:19], s34 offen offset:128
  v_mfma_f32_16x16x32_bf16 v[44:47], a[208:211], a[176:179], -4.0
  ds_read_b128 a[236:239], v3 offset:8960
  v_mfma_f32_16x16x32_bf16 v[44:47], a[212:215], a[180:183], v[44:47]
  ds_read_b128 a[240:243], v3 offset:9216
  v_mfma_f32_16x16x32_bf16 v[44:47], a[216:219], a[184:187], v[44:47]
  ds_read_b128 a[244:247], v3 offset:9472
  v_mfma_f32_16x16x32_bf16 v[44:47], a[220:223], a[188:191], v[44:47]
  ds_read_b128 a[248:251], v3 offset:9728
  v_mfma_f32_16x16x32_bf16 v[48:51], v[24:27], v[8:11], v[48:51]
  ds_read_b128 a[252:255], v3 offset:9984
  s_waitcnt lgkmcnt(5)
  v_mfma_f32_16x16x32_bf16 v[64:67], v[24:27], a[224:227], v[64:67]
  ds_read_b128 a[192:195], v2 offset:16384
  v_mfma_f32_16x16x32_bf16 v[68:71], v[24:27], a[228:231], v[68:71]
  ds_read_b128 a[196:199], v2 offset:16640
  v_mfma_f32_16x16x32_bf16 v[72:75], v[24:27], a[232:235], v[72:75]
  ds_read_b128 a[200:203], v2 offset:16896
  ds_read_b128 a[204:207], v2 offset:17152
  s_waitcnt lgkmcnt(7)
  v_mfma_f32_16x16x32_bf16 v[76:79], v[24:27], a[236:239], v[76:79]
  ds_read_b128 a[208:211], v2 offset:17408
  v_mfma_f32_16x16x32_bf16 v[80:83], v[24:27], a[240:243], v[80:83]
  ds_read_b128 a[212:215], v2 offset:17664
  s_waitcnt lgkmcnt(7)
  v_mfma_f32_16x16x32_bf16 v[84:87], v[24:27], a[244:247], v[84:87]
  ds_read_b128 a[216:219], v2 offset:17920
  v_mfma_f32_16x16x32_bf16 v[88:91], v[24:27], a[248:251], v[88:91]
  ds_read_b128 a[220:223], v2 offset:18176
  s_waitcnt lgkmcnt(7)
  v_mfma_f32_16x16x32_bf16 v[92:95], v[24:27], a[252:255], v[92:95]
  v_exp_f32 v32, v32
  v_mfma_f32_16x16x32_bf16 v[52:55], v[28:31], v[8:11], v[52:55]
  v_exp_f32 v33, v33
  v_mfma_f32_16x16x32_bf16 v[96:99], v[28:31], a[224:227], v[96:99]
  v_exp_f32 v34, v34
  v_mfma_f32_16x16x32_bf16 v[100:103], v[28:31], a[228:231], v[100:103]
  v_exp_f32 v35, v35
  v_mfma_f32_16x16x32_bf16 v[104:107], v[28:31], a[232:235], v[104:107]
  v_exp_f32 v40, v40
  buffer_load_dwordx4 v[204:207], v4, s[16:19], s34 offen offset:192
  v_mfma_f32_16x16x32_bf16 v[108:111], v[28:31], a[236:239], v[108:111]
  s_add_u32 s34, s34, 4096
  v_exp_f32 v41, v41
  v_mfma_f32_16x16x32_bf16 v[112:115], v[28:31], a[240:243], v[112:115]
  s_cmp_ge_u32 s34, s36
  v_exp_f32 v42, v42
  v_mfma_f32_16x16x32_bf16 v[116:119], v[28:31], a[244:247], v[116:119]
  s_cselect_b32 s18, 0, s18
  v_exp_f32 v43, v43
  v_mfma_f32_16x16x32_bf16 v[120:123], v[28:31], a[248:251], v[120:123]
  v_cvt_pk_bf16_f32 v32, v32, v33
  v_cvt_pk_bf16_f32 v33, v34, v35
  v_mfma_f32_16x16x32_bf16 v[124:127], v[28:31], a[252:255], v[124:127]
  v_cvt_pk_bf16_f32 v34, v40, v41
  v_cvt_pk_bf16_f32 v35, v42, v43
  v_mfma_f32_16x16x32_bf16 v[24:27], a[192:195], a[128:131], -4.0
  s_waitcnt lgkmcnt(0)
  v_exp_f32 v36, v36
  v_mfma_f32_16x16x32_bf16 v[24:27], a[196:199], a[132:135], v[24:27]
  v_exp_f32 v37, v37
  v_mfma_f32_16x16x32_bf16 v[24:27], a[200:203], a[136:139], v[24:27]
  v_exp_f32 v38, v38
  v_mfma_f32_16x16x32_bf16 v[24:27], a[204:207], a[140:143], v[24:27]
  v_exp_f32 v39, v39
  v_mfma_f32_16x16x32_bf16 v[40:43], a[208:211], a[128:131], -4.0
  s_waitcnt vmcnt(8)
  ds_read2st64_b32 v[16:17], v7 offset0:64 offset1:66
  v_cvt_pk_bf16_f32 v36, v36, v37
  v_mfma_f32_16x16x32_bf16 v[40:43], a[212:215], a[132:135], v[40:43]
  ds_read2st64_b32 v[20:21], v7 offset0:65 offset1:67
  v_cvt_pk_bf16_f32 v37, v38, v39
  v_mfma_f32_16x16x32_bf16 v[40:43], a[216:219], a[136:139], v[40:43]
  v_exp_f32 v44, v44
  v_mfma_f32_16x16x32_bf16 v[40:43], a[220:223], a[140:143], v[40:43]
  v_exp_f32 v45, v45
  v_mfma_f32_16x16x32_bf16 v[28:31], a[192:195], a[144:147], -4.0
  v_exp_f32 v46, v46
  v_mfma_f32_16x16x32_bf16 v[28:31], a[196:199], a[148:151], v[28:31]
  v_exp_f32 v47, v47
  v_mfma_f32_16x16x32_bf16 v[28:31], a[200:203], a[152:155], v[28:31]
  ds_read2st64_b32 v[18:19], v7 offset0:68 offset1:70
  v_cvt_pk_bf16_f32 v38, v44, v45
  v_mfma_f32_16x16x32_bf16 v[28:31], a[204:207], a[156:159], v[28:31]
  ds_read2st64_b32 v[22:23], v7 offset0:69 offset1:71
  buffer_load_dwordx4 v[208:211], v4, s[16:19], s34 offen offset:0
  v_cvt_pk_bf16_f32 v39, v46, v47
  v_mfma_f32_16x16x32_bf16 v[44:47], a[208:211], a[144:147], -4.0
  s_waitcnt lgkmcnt(2)
  v_perm_b32 v14, v20, v16, s38
  v_perm_b32 v15, v21, v17, s38
  v_mfma_f32_16x16x32_bf16 v[44:47], a[212:215], a[148:151], v[44:47]
  v_perm_b32 v20, v20, v16, s39
  v_perm_b32 v21, v21, v17, s39
  v_mfma_f32_16x16x32_bf16 v[44:47], a[216:219], a[152:155], v[44:47]
  v_exp_f32 v24, v24
  v_mfma_f32_16x16x32_bf16 v[44:47], a[220:223], a[156:159], v[44:47]
  v_exp_f32 v25, v25
  v_mfma_f32_16x16x32_bf16 v[56:59], v[32:35], v[8:11], v[56:59]
  v_exp_f32 v26, v26
  v_mfma_f32_16x16x32_bf16 v[128:131], v[32:35], a[224:227], v[128:131]
  v_exp_f32 v27, v27
  v_mfma_f32_16x16x32_bf16 v[132:135], v[32:35], a[228:231], v[132:135]
  s_waitcnt lgkmcnt(0)
  v_perm_b32 v16, v22, v18, s38
  v_perm_b32 v17, v23, v19, s38
  v_mfma_f32_16x16x32_bf16 v[136:139], v[32:35], a[232:235], v[136:139]
  v_perm_b32 v22, v22, v18, s39
  v_perm_b32 v23, v23, v19, s39
  v_mfma_f32_16x16x32_bf16 v[140:143], v[32:35], a[236:239], v[140:143]
  ds_write_b128 v6, v[14:17] offset:16384
  v_mfma_f32_16x16x32_bf16 v[144:147], v[32:35], a[240:243], v[144:147]
  s_waitcnt vmcnt(7)
  ds_read_b128 v[16:19], v5 offset:24576
  v_cvt_pk_bf16_f32 v24, v24, v25
  v_mfma_f32_16x16x32_bf16 v[148:151], v[32:35], a[244:247], v[148:151]
  ds_write_b128 v6, v[20:23] offset:16640
  v_mfma_f32_16x16x32_bf16 v[152:155], v[32:35], a[248:251], v[152:155]
  ds_read_b128 v[20:23], v5 offset:25600
  v_cvt_pk_bf16_f32 v25, v26, v27
  v_mfma_f32_16x16x32_bf16 v[156:159], v[32:35], a[252:255], v[156:159]
  v_exp_f32 v40, v40
  v_mfma_f32_16x16x32_bf16 v[60:63], v[36:39], v[8:11], v[60:63]
  v_exp_f32 v41, v41
  v_mfma_f32_16x16x32_bf16 v[160:163], v[36:39], a[224:227], v[160:163]
  v_exp_f32 v42, v42
  buffer_load_dwordx4 v[212:215], v4, s[16:19], s34 offen offset:64
  v_mfma_f32_16x16x32_bf16 v[164:167], v[36:39], a[228:231], v[164:167]
  s_waitcnt lgkmcnt(1)
  v_lshlrev_b32 v14, 16, v16
  v_and_b32 v15, 0xffff0000, v16
  v_mfma_f32_16x16x32_bf16 v[168:171], v[36:39], a[232:235], v[168:171]
  v_mul_f32 v14, s33, v14
  v_mul_f32 v15, s33, v15
  v_mfma_f32_16x16x32_bf16 v[172:175], v[36:39], a[236:239], v[172:175]
  v_cvt_pk_bf16_f32 v16, v14, v15
  v_lshlrev_b32 v14, 16, v17
  v_mfma_f32_16x16x32_bf16 v[176:179], v[36:39], a[240:243], v[176:179]
  v_and_b32 v15, 0xffff0000, v17
  v_mul_f32 v14, s33, v14
  v_mfma_f32_16x16x32_bf16 v[180:183], v[36:39], a[244:247], v[180:183]
  v_mul_f32 v15, s33, v15
  v_cvt_pk_bf16_f32 v17, v14, v15
  v_mfma_f32_16x16x32_bf16 v[184:187], v[36:39], a[248:251], v[184:187]
  v_lshlrev_b32 v14, 16, v18
  v_and_b32 v15, 0xffff0000, v18
  v_mfma_f32_16x16x32_bf16 v[188:191], v[36:39], a[252:255], v[188:191]
  v_mul_f32 v14, s33, v14
  v_mul_f32 v15, s33, v15
  v_mfma_f32_16x16x32_bf16 v[32:35], a[192:195], a[160:163], -4.0
  v_cvt_pk_bf16_f32 v18, v14, v15
  v_lshlrev_b32 v14, 16, v19
  v_and_b32 v15, 0xffff0000, v19
  v_mul_f32 v14, s33, v14
  v_mul_f32 v15, s33, v15
  v_cvt_pk_bf16_f32 v19, v14, v15
  v_mfma_f32_16x16x32_bf16 v[32:35], a[196:199], a[164:167], v[32:35]
  s_waitcnt lgkmcnt(0)
  v_lshlrev_b32 v14, 16, v20
  v_and_b32 v15, 0xffff0000, v20
  v_mul_f32 v14, s33, v14
  v_mul_f32 v15, s33, v15
  v_cvt_pk_bf16_f32 v20, v14, v15
  v_lshlrev_b32 v14, 16, v21
  v_and_b32 v15, 0xffff0000, v21
  v_mfma_f32_16x16x32_bf16 v[32:35], a[200:203], a[168:171], v[32:35]
  v_mul_f32 v14, s33, v14
  v_mul_f32 v15, s33, v15
  v_cvt_pk_bf16_f32 v21, v14, v15
  v_lshlrev_b32 v14, 16, v22
  v_and_b32 v15, 0xffff0000, v22
  v_mul_f32 v14, s33, v14
  v_mul_f32 v15, s33, v15
  v_mfma_f32_16x16x32_bf16 v[32:35], a[204:207], a[172:175], v[32:35]
  ds_write_b128 v5, v[16:19] offset:24576
  v_cvt_pk_bf16_f32 v22, v14, v15
  v_lshlrev_b32 v14, 16, v23
  v_and_b32 v15, 0xffff0000, v23
  v_mul_f32 v14, s33, v14
  v_mul_f32 v15, s33, v15
  v_cvt_pk_bf16_f32 v23, v14, v15
  buffer_load_dwordx4 v[216:219], v4, s[16:19], s34 offen offset:128
  ds_write_b128 v5, v[20:23] offset:25600
  v_exp_f32 v43, v43
  v_cvt_pk_bf16_f32 v26, v40, v41
  v_cvt_pk_bf16_f32 v27, v42, v43
  v_mfma_f32_16x16x32_bf16 v[40:43], a[208:211], a[160:163], -4.0
  v_exp_f32 v28, v28
  v_mfma_f32_16x16x32_bf16 v[40:43], a[212:215], a[164:167], v[40:43]
  v_exp_f32 v29, v29
  v_mfma_f32_16x16x32_bf16 v[40:43], a[216:219], a[168:171], v[40:43]
  v_exp_f32 v30, v30
  v_mfma_f32_16x16x32_bf16 v[40:43], a[220:223], a[172:175], v[40:43]
  v_exp_f32 v31, v31
  v_mfma_f32_16x16x32_bf16 v[36:39], a[192:195], a[176:179], -4.0
  s_waitcnt lgkmcnt(0)
  s_barrier
  v_mfma_f32_16x16x32_bf16 v[36:39], a[196:199], a[180:183], v[36:39]
  ds_read_b128 a[224:227], v3 offset:16384
  v_cvt_pk_bf16_f32 v28, v28, v29
  v_mfma_f32_16x16x32_bf16 v[36:39], a[200:203], a[184:187], v[36:39]
  ds_read_b128 a[228:231], v3 offset:16640
  v_cvt_pk_bf16_f32 v29, v30, v31
  v_mfma_f32_16x16x32_bf16 v[36:39], a[204:207], a[188:191], v[36:39]
  ds_read_b128 a[232:235], v3 offset:16896
  v_exp_f32 v44, v44
  v_exp_f32 v45, v45
  v_exp_f32 v46, v46
  v_exp_f32 v47, v47
  v_cvt_pk_bf16_f32 v30, v44, v45
  v_cvt_pk_bf16_f32 v31, v46, v47
  v_mfma_f32_16x16x32_bf16 v[44:47], a[208:211], a[176:179], -4.0
  ds_read_b128 a[236:239], v3 offset:17152
  v_and_b32 v5, 0xf0, v3
  v_mfma_f32_16x16x32_bf16 v[44:47], a[212:215], a[180:183], v[44:47]
  ds_read_b128 a[240:243], v3 offset:17408
  v_mfma_f32_16x16x32_bf16 v[44:47], a[216:219], a[184:187], v[44:47]
  buffer_load_dwordx4 v[220:223], v4, s[16:19], s34 offen offset:192
  s_add_u32 s34, s34, 4096
  s_cmp_ge_u32 s34, s36
  s_cselect_b32 s18, 0, s18
  v_mfma_f32_16x16x32_bf16 v[44:47], a[220:223], a[188:191], v[44:47]
  ds_read_b128 a[244:247], v3 offset:17664
  v_mfma_f32_16x16x32_bf16 v[48:51], v[24:27], v[8:11], v[48:51]
  ds_read_b128 a[248:251], v3 offset:17920
  s_waitcnt lgkmcnt(4)
  v_mfma_f32_16x16x32_bf16 v[64:67], v[24:27], a[224:227], v[64:67]
  ds_read_b128 a[252:255], v3 offset:18176
  v_mfma_f32_16x16x32_bf16 v[68:71], v[24:27], a[228:231], v[68:71]
  ds_read_b128 a[192:195], v2 offset:24576
  v_mfma_f32_16x16x32_bf16 v[72:75], v[24:27], a[232:235], v[72:75]
  ds_read_b128 a[196:199], v2 offset:24832
  s_waitcnt lgkmcnt(5)
  v_mfma_f32_16x16x32_bf16 v[76:79], v[24:27], a[236:239], v[76:79]
  ds_read_b128 a[200:203], v2 offset:25088
  v_mfma_f32_16x16x32_bf16 v[80:83], v[24:27], a[240:243], v[80:83]
  ds_read_b128 a[204:207], v2 offset:25344
  ds_read_b128 a[208:211], v2 offset:25600
  ds_read_b128 a[212:215], v2 offset:25856
  ds_read_b128 a[216:219], v2 offset:26112
  s_waitcnt lgkmcnt(8)
  v_mfma_f32_16x16x32_bf16 v[84:87], v[24:27], a[244:247], v[84:87]
  ds_read_b128 a[220:223], v2 offset:26368
  v_mfma_f32_16x16x32_bf16 v[88:91], v[24:27], a[248:251], v[88:91]
  s_waitcnt lgkmcnt(7)
  v_exp_f32 v32, v32
  v_mfma_f32_16x16x32_bf16 v[92:95], v[24:27], a[252:255], v[92:95]
  v_exp_f32 v33, v33
  v_mfma_f32_16x16x32_bf16 v[52:55], v[28:31], v[8:11], v[52:55]
  v_exp_f32 v34, v34
  v_mfma_f32_16x16x32_bf16 v[96:99], v[28:31], a[224:227], v[96:99]
  v_exp_f32 v35, v35
  v_mfma_f32_16x16x32_bf16 v[100:103], v[28:31], a[228:231], v[100:103]
  v_exp_f32 v40, v40
  v_mfma_f32_16x16x32_bf16 v[104:107], v[28:31], a[232:235], v[104:107]
  v_exp_f32 v41, v41
  v_mfma_f32_16x16x32_bf16 v[108:111], v[28:31], a[236:239], v[108:111]
  v_exp_f32 v42, v42
  v_mfma_f32_16x16x32_bf16 v[112:115], v[28:31], a[240:243], v[112:115]
  v_exp_f32 v43, v43
  v_mfma_f32_16x16x32_bf16 v[116:119], v[28:31], a[244:247], v[116:119]
  v_cvt_pk_bf16_f32 v32, v32, v33
  v_cvt_pk_bf16_f32 v33, v34, v35
  v_mfma_f32_16x16x32_bf16 v[120:123], v[28:31], a[248:251], v[120:123]
  v_cvt_pk_bf16_f32 v34, v40, v41
  v_cvt_pk_bf16_f32 v35, v42, v43
  v_mfma_f32_16x16x32_bf16 v[124:127], v[28:31], a[252:255], v[124:127]
  v_exp_f32 v36, v36
  v_mfma_f32_16x16x32_bf16 v[24:27], a[192:195], a[128:131], -4.0
  s_waitcnt lgkmcnt(0)
  v_exp_f32 v37, v37
  v_mfma_f32_16x16x32_bf16 v[24:27], a[196:199], a[132:135], v[24:27]
  v_exp_f32 v38, v38
  v_mfma_f32_16x16x32_bf16 v[24:27], a[200:203], a[136:139], v[24:27]
  v_exp_f32 v39, v39
  v_mfma_f32_16x16x32_bf16 v[24:27], a[204:207], a[140:143], v[24:27]
  v_exp_f32 v44, v44
  v_mfma_f32_16x16x32_bf16 v[40:43], a[208:211], a[128:131], -4.0
  v_exp_f32 v45, v45
  v_mfma_f32_16x16x32_bf16 v[40:43], a[212:215], a[132:135], v[40:43]
  v_exp_f32 v46, v46
  v_mfma_f32_16x16x32_bf16 v[40:43], a[216:219], a[136:139], v[40:43]
  v_exp_f32 v47, v47
  v_mfma_f32_16x16x32_bf16 v[40:43], a[220:223], a[140:143], v[40:43]
  v_cvt_pk_bf16_f32 v36, v36, v37
  v_cvt_pk_bf16_f32 v37, v38, v39
  v_mfma_f32_16x16x32_bf16 v[28:31], a[192:195], a[144:147], -4.0
  v_cvt_pk_bf16_f32 v38, v44, v45
  v_cvt_pk_bf16_f32 v39, v46, v47
  v_mfma_f32_16x16x32_bf16 v[28:31], a[196:199], a[148:151], v[28:31]
  s_waitcnt vmcnt(8)
  ds_read2st64_b32 v[16:17], v7 offset0:96 offset1:98
  s_waitcnt vmcnt(7)
  v_accvgpr_write_b32 a128, v192
  v_mfma_f32_16x16x32_bf16 v[28:31], a[200:203], a[152:155], v[28:31]
  ds_read2st64_b32 v[20:21], v7 offset0:97 offset1:99
  v_accvgpr_write_b32 a129, v193
  v_mfma_f32_16x16x32_bf16 v[28:31], a[204:207], a[156:159], v[28:31]
  ds_read2st64_b32 v[18:19], v7 offset0:100 offset1:102
  v_accvgpr_write_b32 a130, v194
  v_mfma_f32_16x16x32_bf16 v[44:47], a[208:211], a[144:147], -4.0
  ds_read2st64_b32 v[22:23], v7 offset0:101 offset1:103
  v_accvgpr_write_b32 a131, v195
  buffer_load_dwordx4 v[192:195], v4, s[16:19], s34 offen offset:0
  v_mfma_f32_16x16x32_bf16 v[44:47], a[212:215], a[148:151], v[44:47]
  v_exp_f32 v24, v24
  v_mfma_f32_16x16x32_bf16 v[44:47], a[216:219], a[152:155], v[44:47]
  v_exp_f32 v25, v25
  v_mfma_f32_16x16x32_bf16 v[44:47], a[220:223], a[156:159], v[44:47]
  v_exp_f32 v26, v26
  v_mfma_f32_16x16x32_bf16 v[56:59], v[32:35], v[8:11], v[56:59]
  v_exp_f32 v27, v27
  v_mfma_f32_16x16x32_bf16 v[128:131], v[32:35], a[224:227], v[128:131]
  s_waitcnt lgkmcnt(1)
  v_perm_b32 v14, v20, v16, s38
  v_perm_b32 v15, v21, v17, s38
  v_mfma_f32_16x16x32_bf16 v[132:135], v[32:35], a[228:231], v[132:135]
  v_perm_b32 v20, v20, v16, s39
  v_perm_b32 v21, v21, v17, s39
  v_mfma_f32_16x16x32_bf16 v[136:139], v[32:35], a[232:235], v[136:139]
  s_waitcnt lgkmcnt(0)
  v_perm_b32 v16, v22, v18, s38
  v_perm_b32 v17, v23, v19, s38
  v_mfma_f32_16x16x32_bf16 v[140:143], v[32:35], a[236:239], v[140:143]
  v_perm_b32 v22, v22, v18, s39
  v_perm_b32 v23, v23, v19, s39
  v_mfma_f32_16x16x32_bf16 v[144:147], v[32:35], a[240:243], v[144:147]
  ds_write_b128 v6, v[14:17] offset:24576
  v_mfma_f32_16x16x32_bf16 v[148:151], v[32:35], a[244:247], v[148:151]
  ds_write_b128 v6, v[20:23] offset:24832
  v_mfma_f32_16x16x32_bf16 v[152:155], v[32:35], a[248:251], v[152:155]
  v_exp_f32 v40, v40
  v_mfma_f32_16x16x32_bf16 v[156:159], v[32:35], a[252:255], v[156:159]
  v_exp_f32 v41, v41
  v_mfma_f32_16x16x32_bf16 v[60:63], v[36:39], v[8:11], v[60:63]
  v_exp_f32 v42, v42
  v_mfma_f32_16x16x32_bf16 v[160:163], v[36:39], a[224:227], v[160:163]
  v_exp_f32 v43, v43
  v_mfma_f32_16x16x32_bf16 v[164:167], v[36:39], a[228:231], v[164:167]
  v_cvt_pk_bf16_f32 v24, v24, v25
  v_cvt_pk_bf16_f32 v25, v26, v27
  v_mfma_f32_16x16x32_bf16 v[168:171], v[36:39], a[232:235], v[168:171]
  v_cvt_pk_bf16_f32 v26, v40, v41
  v_cvt_pk_bf16_f32 v27, v42, v43
  v_mfma_f32_16x16x32_bf16 v[172:175], v[36:39], a[236:239], v[172:175]
  s_waitcnt lgkmcnt(0)
  s_barrier
  v_mfma_f32_16x16x32_bf16 v[176:179], v[36:39], a[240:243], v[176:179]
  ds_read_b128 a[224:227], v3 offset:24576
  s_waitcnt vmcnt(7)
  v_accvgpr_write_b32 a132, v196
  v_mfma_f32_16x16x32_bf16 v[180:183], v[36:39], a[244:247], v[180:183]
  ds_read_b128 a[228:231], v3 offset:24832
  v_accvgpr_write_b32 a133, v197
  v_mfma_f32_16x16x32_bf16 v[184:187], v[36:39], a[248:251], v[184:187]
  v_exp_f32 v28, v28
  v_mfma_f32_16x16x32_bf16 v[188:191], v[36:39], a[252:255], v[188:191]
  v_exp_f32 v29, v29
  v_mfma_f32_16x16x32_bf16 v[32:35], a[192:195], a[160:163], -4.0
  v_exp_f32 v30, v30
  v_mfma_f32_16x16x32_bf16 v[32:35], a[196:199], a[164:167], v[32:35]
  v_exp_f32 v31, v31
  v_mfma_f32_16x16x32_bf16 v[32:35], a[200:203], a[168:171], v[32:35]
  ds_read_b128 a[232:235], v3 offset:25088
  v_cvt_pk_bf16_f32 v28, v28, v29
  v_mfma_f32_16x16x32_bf16 v[32:35], a[204:207], a[172:175], v[32:35]
  v_exp_f32 v44, v44
  v_mfma_f32_16x16x32_bf16 v[40:43], a[208:211], a[160:163], -4.0
  v_exp_f32 v45, v45
  v_mfma_f32_16x16x32_bf16 v[40:43], a[212:215], a[164:167], v[40:43]
  v_exp_f32 v46, v46
  v_mfma_f32_16x16x32_bf16 v[40:43], a[216:219], a[168:171], v[40:43]
  v_exp_f32 v47, v47
  v_mfma_f32_16x16x32_bf16 v[40:43], a[220:223], a[172:175], v[40:43]
  v_cvt_pk_bf16_f32 v29, v30, v31
  v_cvt_pk_bf16_f32 v30, v44, v45
  v_mfma_f32_16x16x32_bf16 v[36:39], a[192:195], a[176:179], -4.0
  v_cvt_pk_bf16_f32 v31, v46, v47
  v_accvgpr_write_b32 a134, v198
  v_mfma_f32_16x16x32_bf16 v[36:39], a[196:199], a[180:183], v[36:39]
  ds_read_b128 a[236:239], v3 offset:25344
  v_accvgpr_write_b32 a135, v199
  buffer_load_dwordx4 v[196:199], v4, s[16:19], s34 offen offset:64
  v_mfma_f32_16x16x32_bf16 v[36:39], a[200:203], a[184:187], v[36:39]
  ds_read_b128 a[240:243], v3 offset:25600
  v_lshrrev_b32 v14, 1, v3
  v_mfma_f32_16x16x32_bf16 v[36:39], a[204:207], a[188:191], v[36:39]
  ds_read_b128 a[244:247], v3 offset:25856
  v_and_b32 v14, 0xc00, v14
  v_mfma_f32_16x16x32_bf16 v[44:47], a[208:211], a[176:179], -4.0
  ds_read_b128 a[248:251], v3 offset:26112
  s_waitcnt vmcnt(7)
  v_accvgpr_write_b32 a136, v200
  v_mfma_f32_16x16x32_bf16 v[44:47], a[212:215], a[180:183], v[44:47]
  ds_read_b128 a[252:255], v3 offset:26368
  v_accvgpr_write_b32 a137, v201
  v_mfma_f32_16x16x32_bf16 v[44:47], a[216:219], a[184:187], v[44:47]
  v_exp_f32 v32, v32
  v_mfma_f32_16x16x32_bf16 v[44:47], a[220:223], a[188:191], v[44:47]
  v_exp_f32 v33, v33
  v_mfma_f32_16x16x32_bf16 v[16:19], v[24:27], v[8:11], v[48:51]
  s_waitcnt lgkmcnt(3)
  v_exp_f32 v36, v36
  v_mfma_f32_16x16x32_bf16 v[224:227], v[24:27], a[224:227], v[64:67]
  v_exp_f32 v37, v37
  v_mfma_f32_16x16x32_bf16 v[228:231], v[24:27], a[228:231], v[68:71]
  v_exp_f32 v34, v34
  v_mfma_f32_16x16x32_bf16 v[232:235], v[24:27], a[232:235], v[72:75]
  v_exp_f32 v35, v35
  v_mfma_f32_16x16x32_bf16 v[236:239], v[24:27], a[236:239], v[76:79]
  v_exp_f32 v38, v38
  v_mfma_f32_16x16x32_bf16 v[240:243], v[24:27], a[240:243], v[80:83]
  s_waitcnt lgkmcnt(0)
  v_exp_f32 v39, v39
  v_mfma_f32_16x16x32_bf16 v[244:247], v[24:27], a[244:247], v[84:87]
  v_exp_f32 v40, v40
  v_mfma_f32_16x16x32_bf16 v[248:251], v[24:27], a[248:251], v[88:91]
  v_exp_f32 v41, v41
  v_mfma_f32_16x16x32_bf16 v[252:255], v[24:27], a[252:255], v[92:95]
  v_exp_f32 v42, v42
  v_mfma_f32_16x16x32_bf16 v[52:55], v[28:31], v[8:11], v[52:55]
  v_exp_f32 v43, v43
  v_mfma_f32_16x16x32_bf16 v[96:99], v[28:31], a[224:227], v[96:99]
  v_exp_f32 v44, v44
  v_mfma_f32_16x16x32_bf16 v[100:103], v[28:31], a[228:231], v[100:103]
  v_exp_f32 v45, v45
  v_mfma_f32_16x16x32_bf16 v[104:107], v[28:31], a[232:235], v[104:107]
  v_cvt_pk_bf16_f32 v32, v32, v33
  v_cvt_pk_bf16_f32 v36, v36, v37
  v_mfma_f32_16x16x32_bf16 v[108:111], v[28:31], a[236:239], v[108:111]
  v_cvt_pk_bf16_f32 v33, v34, v35
  v_cvt_pk_bf16_f32 v37, v38, v39
  v_mfma_f32_16x16x32_bf16 v[112:115], v[28:31], a[240:243], v[112:115]
  ds_read_b128 a[192:195], v1 offset:0
  v_accvgpr_write_b32 a138, v202
  v_mfma_f32_16x16x32_bf16 v[116:119], v[28:31], a[244:247], v[116:119]
  ds_read_b128 a[196:199], v1 offset:256
  v_accvgpr_write_b32 a139, v203
  v_mfma_f32_16x16x32_bf16 v[120:123], v[28:31], a[248:251], v[120:123]
  ds_read_b128 a[200:203], v1 offset:512
  s_waitcnt vmcnt(6)
  v_accvgpr_write_b32 a140, v204
  v_mfma_f32_16x16x32_bf16 v[124:127], v[28:31], a[252:255], v[124:127]
  ds_read_b128 a[204:207], v1 offset:768
  ds_read_b128 a[208:211], v1 offset:1024
  ds_read_b128 a[212:215], v1 offset:1280
  ds_read_b128 a[216:219], v1 offset:1536
  ds_read_b128 a[220:223], v1 offset:1792
  v_accvgpr_write_b32 a141, v205
  v_accvgpr_write_b32 a142, v206
  v_accvgpr_write_b32 a143, v207
  v_or_b32 v5, v5, v14
  v_mov_b32 v6, s40
  v_mov_b32 v7, s41
  v_cvt_pk_bf16_f32 v34, v40, v41
  v_cvt_pk_bf16_f32 v35, v42, v43
  v_cvt_pk_bf16_f32 v38, v44, v45
  s_waitcnt vmcnt(2)
  s_waitcnt lgkmcnt(0)
.p2align 3
L_loop:
  v_mfma_f32_16x16x32_bf16 v[24:27], a[192:195], a[128:131], -4.0
  v_exp_f32 v46, v46
  v_mfma_f32_16x16x32_bf16 v[24:27], a[196:199], a[132:135], v[24:27]
  buffer_load_dwordx4 v[200:203], v4, s[16:19], s34 offen offset:128
  v_mfma_f32_16x16x32_bf16 v[24:27], a[200:203], a[136:139], v[24:27]
  v_exp_f32 v47, v47
  v_mfma_f32_16x16x32_bf16 v[24:27], a[204:207], a[140:143], v[24:27]
  v_cvt_pk_bf16_f32 v39, v46, v47
  v_mfma_f32_16x16x32_bf16 v[40:43], a[208:211], a[128:131], -4.0
  buffer_load_dwordx4 v[204:207], v4, s[16:19], s34 offen offset:192
  v_mfma_f32_16x16x32_bf16 v[40:43], a[212:215], a[132:135], v[40:43]
  s_add_u32 s34, s34, 4096
  v_rcp_f32_dpp v16, v16 row_newbcast:0 row_mask:0xf bank_mask:0xf
  v_mfma_f32_16x16x32_bf16 v[40:43], a[216:219], a[136:139], v[40:43]
  v_exp_f32 v24, v24
  v_mfma_f32_16x16x32_bf16 v[40:43], a[220:223], a[140:143], v[40:43]
  v_rcp_f32_dpp v17, v17 row_newbcast:0 row_mask:0xf bank_mask:0xf
  v_mfma_f32_16x16x32_bf16 v[28:31], a[192:195], a[144:147], -4.0
  v_exp_f32 v25, v25
  v_mfma_f32_16x16x32_bf16 v[28:31], a[196:199], a[148:151], v[28:31]
  v_cvt_pk_bf16_f32 v24, v24, v25
  v_mfma_f32_16x16x32_bf16 v[28:31], a[200:203], a[152:155], v[28:31]
  v_exp_f32 v26, v26
  v_mfma_f32_16x16x32_bf16 v[28:31], a[204:207], a[156:159], v[28:31]
  v_rcp_f32_dpp v18, v18 row_newbcast:0 row_mask:0xf bank_mask:0xf
  v_mfma_f32_16x16x32_bf16 v[44:47], a[208:211], a[144:147], -4.0
  v_exp_f32 v27, v27
  v_mfma_f32_16x16x32_bf16 v[44:47], a[212:215], a[148:151], v[44:47]
  v_cvt_pk_bf16_f32 v25, v26, v27
  v_mfma_f32_16x16x32_bf16 v[44:47], a[216:219], a[152:155], v[44:47]
  v_exp_f32 v40, v40
  v_mfma_f32_16x16x32_bf16 v[44:47], a[220:223], a[156:159], v[44:47]
  v_rcp_f32_dpp v19, v19 row_newbcast:0 row_mask:0xf bank_mask:0xf
  v_mfma_f32_16x16x32_bf16 v[56:59], v[32:35], v[8:11], v[56:59]
  v_exp_f32 v41, v41
  v_mfma_f32_16x16x32_bf16 v[128:131], v[32:35], a[224:227], v[128:131]
  v_cvt_pk_bf16_f32 v26, v40, v41
  v_max3_u32 v6, v6, v16, v17
  v_mfma_f32_16x16x32_bf16 v[132:135], v[32:35], a[228:231], v[132:135]
  v_exp_f32 v42, v42
  v_mfma_f32_16x16x32_bf16 v[136:139], v[32:35], a[232:235], v[136:139]
  v_min3_u32 v7, v7, v16, v17
  v_max3_u32 v6, v6, v18, v19
  v_mfma_f32_16x16x32_bf16 v[140:143], v[32:35], a[236:239], v[140:143]
  v_exp_f32 v43, v43
  v_mfma_f32_16x16x32_bf16 v[144:147], v[32:35], a[240:243], v[144:147]
  v_cvt_pk_bf16_f32 v27, v42, v43
  v_min3_u32 v7, v7, v18, v19
  v_mfma_f32_16x16x32_bf16 v[148:151], v[32:35], a[244:247], v[148:151]
  v_exp_f32 v28, v28
  v_mfma_f32_16x16x32_bf16 v[152:155], v[32:35], a[248:251], v[152:155]
  v_mul_f32 v224, v224, v16
  v_mul_f32 v228, v228, v16
  v_mfma_f32_16x16x32_bf16 v[156:159], v[32:35], a[252:255], v[156:159]
  v_exp_f32 v29, v29
  v_mfma_f32_16x16x32_bf16 v[60:63], v[36:39], v[8:11], v[60:63]
  v_cvt_pk_bf16_f32 v28, v28, v29
  v_mul_f32 v225, v225, v17
  v_mfma_f32_16x16x32_bf16 v[160:163], v[36:39], a[224:227], v[160:163]
  v_exp_f32 v30, v30
  v_mfma_f32_16x16x32_bf16 v[164:167], v[36:39], a[228:231], v[164:167]
  v_mul_f32 v229, v229, v17
  v_cvt_pk_bf16_f32 v224, v224, v228
  v_mfma_f32_16x16x32_bf16 v[168:171], v[36:39], a[232:235], v[168:171]
  v_exp_f32 v31, v31
  v_mfma_f32_16x16x32_bf16 v[172:175], v[36:39], a[236:239], v[172:175]
  v_cvt_pk_bf16_f32 v29, v30, v31
  v_mul_f32 v232, v232, v16
  v_mfma_f32_16x16x32_bf16 v[176:179], v[36:39], a[240:243], v[176:179]
  v_exp_f32 v44, v44
  v_mfma_f32_16x16x32_bf16 v[180:183], v[36:39], a[244:247], v[180:183]
  v_mul_f32 v236, v236, v16
  v_cvt_pk_bf16_f32 v228, v225, v229
  v_mfma_f32_16x16x32_bf16 v[184:187], v[36:39], a[248:251], v[184:187]
  v_exp_f32 v45, v45
  v_mfma_f32_16x16x32_bf16 v[188:191], v[36:39], a[252:255], v[188:191]
  v_cvt_pk_bf16_f32 v30, v44, v45
  v_mul_f32 v226, v226, v18
  v_mfma_f32_16x16x32_bf16 v[32:35], a[192:195], a[160:163], -4.0
  v_exp_f32 v46, v46
  v_mfma_f32_16x16x32_bf16 v[32:35], a[196:199], a[164:167], v[32:35]
  v_mul_f32 v230, v230, v18
  v_cvt_pk_bf16_f32 v225, v232, v236
  v_mfma_f32_16x16x32_bf16 v[32:35], a[200:203], a[168:171], v[32:35]
  v_exp_f32 v47, v47
  v_mfma_f32_16x16x32_bf16 v[32:35], a[204:207], a[172:175], v[32:35]
  v_cvt_pk_bf16_f32 v31, v46, v47
  v_mul_f32 v227, v227, v19
  v_mfma_f32_16x16x32_bf16 v[40:43], a[208:211], a[160:163], -4.0
  v_mul_f32 v231, v231, v19
  v_cvt_pk_bf16_f32 v232, v226, v230
  v_mfma_f32_16x16x32_bf16 v[40:43], a[212:215], a[164:167], v[40:43]
  v_mul_f32 v233, v233, v17
  v_mul_f32 v237, v237, v17
  v_mfma_f32_16x16x32_bf16 v[40:43], a[216:219], a[168:171], v[40:43]
  v_exp_f32 v32, v32
  v_mfma_f32_16x16x32_bf16 v[40:43], a[220:223], a[172:175], v[40:43]
  v_cvt_pk_bf16_f32 v236, v227, v231
  v_mul_f32 v234, v234, v18
  v_mfma_f32_16x16x32_bf16 v[36:39], a[192:195], a[176:179], -4.0
  v_exp_f32 v33, v33
  v_mfma_f32_16x16x32_bf16 v[36:39], a[196:199], a[180:183], v[36:39]
  ds_read_b128 a[192:195], v1 offset:8192
  v_cvt_pk_bf16_f32 v32, v32, v33
  v_mfma_f32_16x16x32_bf16 v[36:39], a[200:203], a[184:187], v[36:39]
  v_exp_f32 v34, v34
  v_mfma_f32_16x16x32_bf16 v[36:39], a[204:207], a[188:191], v[36:39]
  ds_read_b128 a[196:199], v1 offset:8448
  v_mul_f32 v238, v238, v18
  v_mfma_f32_16x16x32_bf16 v[44:47], a[208:211], a[176:179], -4.0
  v_exp_f32 v35, v35
  v_mfma_f32_16x16x32_bf16 v[44:47], a[212:215], a[180:183], v[44:47]
  ds_read_b128 a[200:203], v1 offset:8704
  v_cvt_pk_bf16_f32 v33, v34, v35
  v_mfma_f32_16x16x32_bf16 v[44:47], a[216:219], a[184:187], v[44:47]
  v_exp_f32 v40, v40
  v_mfma_f32_16x16x32_bf16 v[44:47], a[220:223], a[188:191], v[44:47]
  ds_read_b128 a[204:207], v1 offset:8960
  v_cvt_pk_bf16_f32 v229, v233, v237
  v_mfma_f32_16x16x32_bf16 v[48:51], v[24:27], v[8:11], 0
  v_exp_f32 v41, v41
  v_mfma_f32_16x16x32_bf16 v[64:67], v[24:27], a[0:3], 0
  ds_read_b128 a[208:211], v1 offset:9216
  v_cvt_pk_bf16_f32 v34, v40, v41
  v_mfma_f32_16x16x32_bf16 v[68:71], v[24:27], a[4:7], 0
  v_exp_f32 v42, v42
  v_mfma_f32_16x16x32_bf16 v[72:75], v[24:27], a[8:11], 0
  ds_read_b128 a[212:215], v1 offset:9472
  v_mul_f32 v235, v235, v19
  v_mfma_f32_16x16x32_bf16 v[76:79], v[24:27], a[12:15], 0
  v_exp_f32 v43, v43
  v_mfma_f32_16x16x32_bf16 v[80:83], v[24:27], a[16:19], 0
  ds_read_b128 a[216:219], v1 offset:9728
  v_cvt_pk_bf16_f32 v35, v42, v43
  v_mfma_f32_16x16x32_bf16 v[84:87], v[24:27], a[20:23], 0
  v_exp_f32 v36, v36
  v_mfma_f32_16x16x32_bf16 v[88:91], v[24:27], a[24:27], 0
  ds_read_b128 a[220:223], v1 offset:9984
  v_mul_f32 v239, v239, v19
  v_mfma_f32_16x16x32_bf16 v[92:95], v[24:27], a[28:31], 0
  v_exp_f32 v37, v37
  v_mfma_f32_16x16x32_bf16 v[52:55], v[28:31], v[8:11], v[52:55]
  v_cvt_pk_bf16_f32 v36, v36, v37
  v_cvt_pk_bf16_f32 v233, v234, v238
  v_mfma_f32_16x16x32_bf16 v[96:99], v[28:31], a[0:3], v[96:99]
  v_exp_f32 v38, v38
  v_mfma_f32_16x16x32_bf16 v[100:103], v[28:31], a[4:7], v[100:103]
  v_mul_f32 v240, v240, v16
  v_mul_f32 v244, v244, v16
  v_mfma_f32_16x16x32_bf16 v[104:107], v[28:31], a[8:11], v[104:107]
  v_exp_f32 v39, v39
  v_mfma_f32_16x16x32_bf16 v[108:111], v[28:31], a[12:15], v[108:111]
  v_cvt_pk_bf16_f32 v37, v38, v39
  v_cvt_pk_bf16_f32 v237, v235, v239
  v_mfma_f32_16x16x32_bf16 v[112:115], v[28:31], a[16:19], v[112:115]
  v_exp_f32 v44, v44
  v_mfma_f32_16x16x32_bf16 v[116:119], v[28:31], a[20:23], v[116:119]
  v_mul_f32 v248, v248, v16
  v_mul_f32 v252, v252, v16
  v_mfma_f32_16x16x32_bf16 v[120:123], v[28:31], a[24:27], v[120:123]
  s_waitcnt lgkmcnt(0)
  v_exp_f32 v45, v45
  v_mfma_f32_16x16x32_bf16 v[124:127], v[28:31], a[28:31], v[124:127]
  v_cvt_pk_bf16_f32 v38, v44, v45
  v_cvt_pk_bf16_f32 v226, v240, v244
  v_mfma_f32_16x16x32_bf16 v[24:27], a[192:195], a[128:131], -4.0
  v_exp_f32 v46, v46
  v_mfma_f32_16x16x32_bf16 v[24:27], a[196:199], a[132:135], v[24:27]
  v_mul_f32 v241, v241, v17
  v_mul_f32 v245, v245, v17
  v_mfma_f32_16x16x32_bf16 v[24:27], a[200:203], a[136:139], v[24:27]
  v_exp_f32 v47, v47
  v_mfma_f32_16x16x32_bf16 v[24:27], a[204:207], a[140:143], v[24:27]
  v_cvt_pk_bf16_f32 v39, v46, v47
  v_cvt_pk_bf16_f32 v227, v248, v252
  v_mfma_f32_16x16x32_bf16 v[40:43], a[208:211], a[128:131], -4.0
  buffer_store_dwordx4 v[224:227], v5, s[28:31], s35 offen offset:0 nt
  v_mfma_f32_16x16x32_bf16 v[40:43], a[212:215], a[132:135], v[40:43]
  v_mul_f32 v249, v249, v17
  v_mul_f32 v253, v253, v17
  v_mfma_f32_16x16x32_bf16 v[40:43], a[216:219], a[136:139], v[40:43]
  v_exp_f32 v24, v24
  v_mfma_f32_16x16x32_bf16 v[40:43], a[220:223], a[140:143], v[40:43]
  v_cvt_pk_bf16_f32 v230, v241, v245
  v_mul_f32 v242, v242, v18
  v_mfma_f32_16x16x32_bf16 v[28:31], a[192:195], a[144:147], -4.0
  v_exp_f32 v25, v25
  v_mfma_f32_16x16x32_bf16 v[28:31], a[196:199], a[148:151], v[28:31]
  v_cvt_pk_bf16_f32 v24, v24, v25
  v_mul_f32 v246, v246, v18
  v_mfma_f32_16x16x32_bf16 v[28:31], a[200:203], a[152:155], v[28:31]
  v_exp_f32 v26, v26
  v_mfma_f32_16x16x32_bf16 v[28:31], a[204:207], a[156:159], v[28:31]
  v_cvt_pk_bf16_f32 v231, v249, v253
  v_mfma_f32_16x16x32_bf16 v[44:47], a[208:211], a[144:147], -4.0
  v_exp_f32 v27, v27
  v_mfma_f32_16x16x32_bf16 v[44:47], a[212:215], a[148:151], v[44:47]
  v_cvt_pk_bf16_f32 v25, v26, v27
  v_mfma_f32_16x16x32_bf16 v[44:47], a[216:219], a[152:155], v[44:47]
  v_exp_f32 v40, v40
  v_mfma_f32_16x16x32_bf16 v[44:47], a[220:223], a[156:159], v[44:47]
  buffer_store_dwordx4 v[228:231], v5, s[28:31], s35 offen offset:256 nt
  v_mfma_f32_16x16x32_bf16 v[56:59], v[32:35], v[8:11], v[56:59]
  v_exp_f32 v41, v41
  v_mfma_f32_16x16x32_bf16 v[128:131], v[32:35], a[0:3], v[128:131]
  v_cvt_pk_bf16_f32 v26, v40, v41
  v_mul_f32 v250, v250, v18
  v_mfma_f32_16x16x32_bf16 v[132:135], v[32:35], a[4:7], v[132:135]
  v_exp_f32 v42, v42
  v_mfma_f32_16x16x32_bf16 v[136:139], v[32:35], a[8:11], v[136:139]
  v_mul_f32 v254, v254, v18
  v_cvt_pk_bf16_f32 v234, v242, v246
  v_mfma_f32_16x16x32_bf16 v[140:143], v[32:35], a[12:15], v[140:143]
  v_exp_f32 v43, v43
  v_mfma_f32_16x16x32_bf16 v[144:147], v[32:35], a[16:19], v[144:147]
  v_cvt_pk_bf16_f32 v27, v42, v43
  v_mul_f32 v243, v243, v19
  v_mfma_f32_16x16x32_bf16 v[148:151], v[32:35], a[20:23], v[148:151]
  v_exp_f32 v28, v28
  v_mfma_f32_16x16x32_bf16 v[152:155], v[32:35], a[24:27], v[152:155]
  v_mul_f32 v247, v247, v19
  v_cvt_pk_bf16_f32 v235, v250, v254
  v_mfma_f32_16x16x32_bf16 v[156:159], v[32:35], a[28:31], v[156:159]
  v_exp_f32 v29, v29
  v_mfma_f32_16x16x32_bf16 v[60:63], v[36:39], v[8:11], v[60:63]
  v_cvt_pk_bf16_f32 v28, v28, v29
  v_mfma_f32_16x16x32_bf16 v[160:163], v[36:39], a[0:3], v[160:163]
  v_exp_f32 v30, v30
  v_mfma_f32_16x16x32_bf16 v[164:167], v[36:39], a[4:7], v[164:167]
  buffer_store_dwordx4 v[232:235], v5, s[28:31], s35 offen offset:512 nt
  v_mfma_f32_16x16x32_bf16 v[168:171], v[36:39], a[8:11], v[168:171]
  v_exp_f32 v31, v31
  v_mfma_f32_16x16x32_bf16 v[172:175], v[36:39], a[12:15], v[172:175]
  v_cvt_pk_bf16_f32 v29, v30, v31
  v_mul_f32 v251, v251, v19
  v_mfma_f32_16x16x32_bf16 v[176:179], v[36:39], a[16:19], v[176:179]
  v_exp_f32 v44, v44
  v_mfma_f32_16x16x32_bf16 v[180:183], v[36:39], a[20:23], v[180:183]
  v_mul_f32 v255, v255, v19
  v_cvt_pk_bf16_f32 v238, v243, v247
  v_mfma_f32_16x16x32_bf16 v[184:187], v[36:39], a[24:27], v[184:187]
  v_exp_f32 v45, v45
  v_mfma_f32_16x16x32_bf16 v[188:191], v[36:39], a[28:31], v[188:191]
  v_cvt_pk_bf16_f32 v30, v44, v45
  v_cvt_pk_bf16_f32 v239, v251, v255
  v_mfma_f32_16x16x32_bf16 v[32:35], a[192:195], a[160:163], -4.0
  v_exp_f32 v46, v46
  v_mfma_f32_16x16x32_bf16 v[32:35], a[196:199], a[164:167], v[32:35]
  buffer_store_dwordx4 v[236:239], v5, s[28:31], s35 offen offset:768 nt
  v_mfma_f32_16x16x32_bf16 v[32:35], a[200:203], a[168:171], v[32:35]
  s_add_u32 s35, s35, 4096
  v_exp_f32 v47, v47
  v_mfma_f32_16x16x32_bf16 v[32:35], a[204:207], a[172:175], v[32:35]
  s_waitcnt vmcnt(12)
  v_cvt_pk_bf16_f32 v31, v46, v47
  v_mfma_f32_16x16x32_bf16 v[40:43], a[208:211], a[160:163], -4.0
  v_accvgpr_write_b32 a160, v208
  v_accvgpr_write_b32 a161, v209
  v_mfma_f32_16x16x32_bf16 v[40:43], a[212:215], a[164:167], v[40:43]
  v_accvgpr_write_b32 a162, v210
  v_accvgpr_write_b32 a163, v211
  v_mfma_f32_16x16x32_bf16 v[40:43], a[216:219], a[168:171], v[40:43]
  v_exp_f32 v32, v32
  v_mfma_f32_16x16x32_bf16 v[40:43], a[220:223], a[172:175], v[40:43]
  v_accvgpr_write_b32 a164, v212
  v_accvgpr_write_b32 a165, v213
  v_mfma_f32_16x16x32_bf16 v[36:39], a[192:195], a[176:179], -4.0
  v_exp_f32 v33, v33
  v_mfma_f32_16x16x32_bf16 v[36:39], a[196:199], a[180:183], v[36:39]
  ds_read_b128 a[192:195], v1 offset:16384
  v_cvt_pk_bf16_f32 v32, v32, v33
  v_mfma_f32_16x16x32_bf16 v[36:39], a[200:203], a[184:187], v[36:39]
  v_exp_f32 v34, v34
  v_mfma_f32_16x16x32_bf16 v[36:39], a[204:207], a[188:191], v[36:39]
  ds_read_b128 a[196:199], v1 offset:16640
  v_accvgpr_write_b32 a166, v214
  v_mfma_f32_16x16x32_bf16 v[44:47], a[208:211], a[176:179], -4.0
  v_exp_f32 v35, v35
  v_mfma_f32_16x16x32_bf16 v[44:47], a[212:215], a[180:183], v[44:47]
  ds_read_b128 a[200:203], v1 offset:16896
  v_cvt_pk_bf16_f32 v33, v34, v35
  v_mfma_f32_16x16x32_bf16 v[44:47], a[216:219], a[184:187], v[44:47]
  v_exp_f32 v40, v40
  v_mfma_f32_16x16x32_bf16 v[44:47], a[220:223], a[188:191], v[44:47]
  ds_read_b128 a[204:207], v1 offset:17152
  v_accvgpr_write_b32 a167, v215
  v_mfma_f32_16x16x32_bf16 v[48:51], v[24:27], v[8:11], v[48:51]
  v_exp_f32 v41, v41
  v_mfma_f32_16x16x32_bf16 v[64:67], v[24:27], a[32:35], v[64:67]
  ds_read_b128 a[208:211], v1 offset:17408
  v_cvt_pk_bf16_f32 v34, v40, v41
  v_mfma_f32_16x16x32_bf16 v[68:71], v[24:27], a[36:39], v[68:71]
  v_exp_f32 v42, v42
  v_mfma_f32_16x16x32_bf16 v[72:75], v[24:27], a[40:43], v[72:75]
  ds_read_b128 a[212:215], v1 offset:17664
  v_accvgpr_write_b32 a168, v216
  v_mfma_f32_16x16x32_bf16 v[76:79], v[24:27], a[44:47], v[76:79]
  v_exp_f32 v43, v43
  v_mfma_f32_16x16x32_bf16 v[80:83], v[24:27], a[48:51], v[80:83]
  ds_read_b128 a[216:219], v1 offset:17920
  v_cvt_pk_bf16_f32 v35, v42, v43
  v_mfma_f32_16x16x32_bf16 v[84:87], v[24:27], a[52:55], v[84:87]
  v_exp_f32 v36, v36
  v_mfma_f32_16x16x32_bf16 v[88:91], v[24:27], a[56:59], v[88:91]
  ds_read_b128 a[220:223], v1 offset:18176
  v_accvgpr_write_b32 a169, v217
  v_mfma_f32_16x16x32_bf16 v[92:95], v[24:27], a[60:63], v[92:95]
  v_exp_f32 v37, v37
  v_mfma_f32_16x16x32_bf16 v[52:55], v[28:31], v[8:11], v[52:55]
  v_cvt_pk_bf16_f32 v36, v36, v37
  v_accvgpr_write_b32 a170, v218
  v_mfma_f32_16x16x32_bf16 v[96:99], v[28:31], a[32:35], v[96:99]
  v_exp_f32 v38, v38
  v_mfma_f32_16x16x32_bf16 v[100:103], v[28:31], a[36:39], v[100:103]
  v_accvgpr_write_b32 a171, v219
  v_accvgpr_write_b32 a172, v220
  v_mfma_f32_16x16x32_bf16 v[104:107], v[28:31], a[40:43], v[104:107]
  v_exp_f32 v39, v39
  v_mfma_f32_16x16x32_bf16 v[108:111], v[28:31], a[44:47], v[108:111]
  v_cvt_pk_bf16_f32 v37, v38, v39
  v_accvgpr_write_b32 a173, v221
  v_mfma_f32_16x16x32_bf16 v[112:115], v[28:31], a[48:51], v[112:115]
  v_exp_f32 v44, v44
  v_mfma_f32_16x16x32_bf16 v[116:119], v[28:31], a[52:55], v[116:119]
  v_accvgpr_write_b32 a174, v222
  v_accvgpr_write_b32 a175, v223
  v_mfma_f32_16x16x32_bf16 v[120:123], v[28:31], a[56:59], v[120:123]
  s_waitcnt lgkmcnt(0)
  v_exp_f32 v45, v45
  v_mfma_f32_16x16x32_bf16 v[124:127], v[28:31], a[60:63], v[124:127]
  v_cvt_pk_bf16_f32 v38, v44, v45
  v_mfma_f32_16x16x32_bf16 v[24:27], a[192:195], a[128:131], -4.0
  v_exp_f32 v46, v46
  v_mfma_f32_16x16x32_bf16 v[24:27], a[196:199], a[132:135], v[24:27]
  v_mfma_f32_16x16x32_bf16 v[24:27], a[200:203], a[136:139], v[24:27]
  v_exp_f32 v47, v47
  v_mfma_f32_16x16x32_bf16 v[24:27], a[204:207], a[140:143], v[24:27]
  v_cvt_pk_bf16_f32 v39, v46, v47
  v_mfma_f32_16x16x32_bf16 v[40:43], a[208:211], a[128:131], -4.0
  v_mfma_f32_16x16x32_bf16 v[40:43], a[212:215], a[132:135], v[40:43]
  v_mfma_f32_16x16x32_bf16 v[40:43], a[216:219], a[136:139], v[40:43]
  v_exp_f32 v24, v24
  v_mfma_f32_16x16x32_bf16 v[40:43], a[220:223], a[140:143], v[40:43]
  v_mfma_f32_16x16x32_bf16 v[28:31], a[192:195], a[144:147], -4.0
  v_exp_f32 v25, v25
  v_mfma_f32_16x16x32_bf16 v[28:31], a[196:199], a[148:151], v[28:31]
  v_cvt_pk_bf16_f32 v24, v24, v25
  v_mfma_f32_16x16x32_bf16 v[28:31], a[200:203], a[152:155], v[28:31]
  v_exp_f32 v26, v26
  v_mfma_f32_16x16x32_bf16 v[28:31], a[204:207], a[156:159], v[28:31]
  v_mfma_f32_16x16x32_bf16 v[44:47], a[208:211], a[144:147], -4.0
  v_exp_f32 v27, v27
  v_mfma_f32_16x16x32_bf16 v[44:47], a[212:215], a[148:151], v[44:47]
  v_cvt_pk_bf16_f32 v25, v26, v27
  v_mfma_f32_16x16x32_bf16 v[44:47], a[216:219], a[152:155], v[44:47]
  v_exp_f32 v40, v40
  v_mfma_f32_16x16x32_bf16 v[44:47], a[220:223], a[156:159], v[44:47]
  v_mfma_f32_16x16x32_bf16 v[16:19], v[32:35], v[8:11], v[56:59]
  v_exp_f32 v41, v41
  v_mfma_f32_16x16x32_bf16 v[224:227], v[32:35], a[32:35], v[128:131]
  v_cvt_pk_bf16_f32 v26, v40, v41
  v_mfma_f32_16x16x32_bf16 v[228:231], v[32:35], a[36:39], v[132:135]
  v_exp_f32 v42, v42
  v_mfma_f32_16x16x32_bf16 v[232:235], v[32:35], a[40:43], v[136:139]
  v_rcp_f32_dpp v16, v16 row_newbcast:0 row_mask:0xf bank_mask:0xf
  v_mfma_f32_16x16x32_bf16 v[236:239], v[32:35], a[44:47], v[140:143]
  v_exp_f32 v43, v43
  v_mfma_f32_16x16x32_bf16 v[240:243], v[32:35], a[48:51], v[144:147]
  v_cvt_pk_bf16_f32 v27, v42, v43
  v_mfma_f32_16x16x32_bf16 v[244:247], v[32:35], a[52:55], v[148:151]
  v_exp_f32 v28, v28
  v_mfma_f32_16x16x32_bf16 v[248:251], v[32:35], a[56:59], v[152:155]
  v_rcp_f32_dpp v17, v17 row_newbcast:0 row_mask:0xf bank_mask:0xf
  v_mfma_f32_16x16x32_bf16 v[252:255], v[32:35], a[60:63], v[156:159]
  v_exp_f32 v29, v29
  v_mfma_f32_16x16x32_bf16 v[60:63], v[36:39], v[8:11], v[60:63]
  v_cvt_pk_bf16_f32 v28, v28, v29
  v_mfma_f32_16x16x32_bf16 v[160:163], v[36:39], a[32:35], v[160:163]
  v_exp_f32 v30, v30
  v_mfma_f32_16x16x32_bf16 v[164:167], v[36:39], a[36:39], v[164:167]
  v_rcp_f32_dpp v18, v18 row_newbcast:0 row_mask:0xf bank_mask:0xf
  v_mfma_f32_16x16x32_bf16 v[168:171], v[36:39], a[40:43], v[168:171]
  v_exp_f32 v31, v31
  v_mfma_f32_16x16x32_bf16 v[172:175], v[36:39], a[44:47], v[172:175]
  v_cvt_pk_bf16_f32 v29, v30, v31
  v_mfma_f32_16x16x32_bf16 v[176:179], v[36:39], a[48:51], v[176:179]
  v_exp_f32 v44, v44
  v_mfma_f32_16x16x32_bf16 v[180:183], v[36:39], a[52:55], v[180:183]
  v_rcp_f32_dpp v19, v19 row_newbcast:0 row_mask:0xf bank_mask:0xf
  v_mfma_f32_16x16x32_bf16 v[184:187], v[36:39], a[56:59], v[184:187]
  v_exp_f32 v45, v45
  v_mfma_f32_16x16x32_bf16 v[188:191], v[36:39], a[60:63], v[188:191]
  v_cvt_pk_bf16_f32 v30, v44, v45
  v_max3_u32 v6, v6, v16, v17
  v_mfma_f32_16x16x32_bf16 v[32:35], a[192:195], a[160:163], -4.0
  v_exp_f32 v46, v46
  v_mfma_f32_16x16x32_bf16 v[32:35], a[196:199], a[164:167], v[32:35]
  v_min3_u32 v7, v7, v16, v17
  v_max3_u32 v6, v6, v18, v19
  v_mfma_f32_16x16x32_bf16 v[32:35], a[200:203], a[168:171], v[32:35]
  v_exp_f32 v47, v47
  v_mfma_f32_16x16x32_bf16 v[32:35], a[204:207], a[172:175], v[32:35]
  v_cvt_pk_bf16_f32 v31, v46, v47
  v_min3_u32 v7, v7, v18, v19
  v_mfma_f32_16x16x32_bf16 v[40:43], a[208:211], a[160:163], -4.0
  v_mul_f32 v224, v224, v16
  v_mul_f32 v228, v228, v16
  v_mfma_f32_16x16x32_bf16 v[40:43], a[212:215], a[164:167], v[40:43]
  v_mul_f32 v225, v225, v17
  v_mul_f32 v229, v229, v17
  v_mfma_f32_16x16x32_bf16 v[40:43], a[216:219], a[168:171], v[40:43]
  v_exp_f32 v32, v32
  v_mfma_f32_16x16x32_bf16 v[40:43], a[220:223], a[172:175], v[40:43]
  v_cvt_pk_bf16_f32 v224, v224, v228
  v_mul_f32 v232, v232, v16
  v_mfma_f32_16x16x32_bf16 v[36:39], a[192:195], a[176:179], -4.0
  v_exp_f32 v33, v33
  v_mfma_f32_16x16x32_bf16 v[36:39], a[196:199], a[180:183], v[36:39]
  ds_read_b128 a[192:195], v1 offset:24576
  v_cvt_pk_bf16_f32 v32, v32, v33
  v_mfma_f32_16x16x32_bf16 v[36:39], a[200:203], a[184:187], v[36:39]
  v_exp_f32 v34, v34
  v_mfma_f32_16x16x32_bf16 v[36:39], a[204:207], a[188:191], v[36:39]
  ds_read_b128 a[196:199], v1 offset:24832
  v_mul_f32 v236, v236, v16
  v_mfma_f32_16x16x32_bf16 v[44:47], a[208:211], a[176:179], -4.0
  v_exp_f32 v35, v35
  v_mfma_f32_16x16x32_bf16 v[44:47], a[212:215], a[180:183], v[44:47]
  ds_read_b128 a[200:203], v1 offset:25088
  v_cvt_pk_bf16_f32 v33, v34, v35
  v_mfma_f32_16x16x32_bf16 v[44:47], a[216:219], a[184:187], v[44:47]
  v_exp_f32 v40, v40
  v_mfma_f32_16x16x32_bf16 v[44:47], a[220:223], a[188:191], v[44:47]
  ds_read_b128 a[204:207], v1 offset:25344
  v_cvt_pk_bf16_f32 v228, v225, v229
  v_mfma_f32_16x16x32_bf16 v[48:51], v[24:27], v[8:11], v[48:51]
  v_exp_f32 v41, v41
  v_mfma_f32_16x16x32_bf16 v[64:67], v[24:27], a[64:67], v[64:67]
  ds_read_b128 a[208:211], v1 offset:25600
  v_cvt_pk_bf16_f32 v34, v40, v41
  v_mfma_f32_16x16x32_bf16 v[68:71], v[24:27], a[68:71], v[68:71]
  v_exp_f32 v42, v42
  v_mfma_f32_16x16x32_bf16 v[72:75], v[24:27], a[72:75], v[72:75]
  ds_read_b128 a[212:215], v1 offset:25856
  v_mul_f32 v226, v226, v18
  v_mfma_f32_16x16x32_bf16 v[76:79], v[24:27], a[76:79], v[76:79]
  v_exp_f32 v43, v43
  v_mfma_f32_16x16x32_bf16 v[80:83], v[24:27], a[80:83], v[80:83]
  ds_read_b128 a[216:219], v1 offset:26112
  v_cvt_pk_bf16_f32 v35, v42, v43
  v_mfma_f32_16x16x32_bf16 v[84:87], v[24:27], a[84:87], v[84:87]
  v_exp_f32 v36, v36
  v_mfma_f32_16x16x32_bf16 v[88:91], v[24:27], a[88:91], v[88:91]
  ds_read_b128 a[220:223], v1 offset:26368
  v_mul_f32 v230, v230, v18
  v_mfma_f32_16x16x32_bf16 v[92:95], v[24:27], a[92:95], v[92:95]
  v_exp_f32 v37, v37
  v_mfma_f32_16x16x32_bf16 v[52:55], v[28:31], v[8:11], v[52:55]
  v_cvt_pk_bf16_f32 v36, v36, v37
  v_cvt_pk_bf16_f32 v225, v232, v236
  v_mfma_f32_16x16x32_bf16 v[96:99], v[28:31], a[64:67], v[96:99]
  v_exp_f32 v38, v38
  v_mfma_f32_16x16x32_bf16 v[100:103], v[28:31], a[68:71], v[100:103]
  v_mul_f32 v227, v227, v19
  v_mul_f32 v231, v231, v19
  v_mfma_f32_16x16x32_bf16 v[104:107], v[28:31], a[72:75], v[104:107]
  v_exp_f32 v39, v39
  v_mfma_f32_16x16x32_bf16 v[108:111], v[28:31], a[76:79], v[108:111]
  v_cvt_pk_bf16_f32 v37, v38, v39
  v_cvt_pk_bf16_f32 v232, v226, v230
  v_mfma_f32_16x16x32_bf16 v[112:115], v[28:31], a[80:83], v[112:115]
  v_exp_f32 v44, v44
  v_mfma_f32_16x16x32_bf16 v[116:119], v[28:31], a[84:87], v[116:119]
  v_mul_f32 v233, v233, v17
  v_mul_f32 v237, v237, v17
  v_mfma_f32_16x16x32_bf16 v[120:123], v[28:31], a[88:91], v[120:123]
  s_waitcnt lgkmcnt(0)
  v_exp_f32 v45, v45
  v_mfma_f32_16x16x32_bf16 v[124:127], v[28:31], a[92:95], v[124:127]
  v_cvt_pk_bf16_f32 v38, v44, v45
  v_cvt_pk_bf16_f32 v236, v227, v231
  v_mfma_f32_16x16x32_bf16 v[24:27], a[192:195], a[128:131], -4.0
  v_exp_f32 v46, v46
  v_mfma_f32_16x16x32_bf16 v[24:27], a[196:199], a[132:135], v[24:27]
  v_mul_f32 v234, v234, v18
  v_mul_f32 v238, v238, v18
  v_mfma_f32_16x16x32_bf16 v[24:27], a[200:203], a[136:139], v[24:27]
  v_exp_f32 v47, v47
  v_mfma_f32_16x16x32_bf16 v[24:27], a[204:207], a[140:143], v[24:27]
  v_cvt_pk_bf16_f32 v39, v46, v47
  v_cvt_pk_bf16_f32 v229, v233, v237
  v_mfma_f32_16x16x32_bf16 v[40:43], a[208:211], a[128:131], -4.0
  v_mul_f32 v235, v235, v19
  v_mul_f32 v239, v239, v19
  v_mfma_f32_16x16x32_bf16 v[40:43], a[212:215], a[132:135], v[40:43]
  v_cvt_pk_bf16_f32 v233, v234, v238
  v_mul_f32 v240, v240, v16
  v_mfma_f32_16x16x32_bf16 v[40:43], a[216:219], a[136:139], v[40:43]
  v_exp_f32 v24, v24
  v_mfma_f32_16x16x32_bf16 v[40:43], a[220:223], a[140:143], v[40:43]
  v_mul_f32 v244, v244, v16
  v_cvt_pk_bf16_f32 v237, v235, v239
  v_mfma_f32_16x16x32_bf16 v[28:31], a[192:195], a[144:147], -4.0
  v_exp_f32 v25, v25
  v_mfma_f32_16x16x32_bf16 v[28:31], a[196:199], a[148:151], v[28:31]
  v_cvt_pk_bf16_f32 v24, v24, v25
  v_mul_f32 v248, v248, v16
  v_mfma_f32_16x16x32_bf16 v[28:31], a[200:203], a[152:155], v[28:31]
  v_exp_f32 v26, v26
  v_mfma_f32_16x16x32_bf16 v[28:31], a[204:207], a[156:159], v[28:31]
  v_mul_f32 v252, v252, v16
  v_cvt_pk_bf16_f32 v226, v240, v244
  v_mfma_f32_16x16x32_bf16 v[44:47], a[208:211], a[144:147], -4.0
  v_exp_f32 v27, v27
  v_mfma_f32_16x16x32_bf16 v[44:47], a[212:215], a[148:151], v[44:47]
  v_cvt_pk_bf16_f32 v25, v26, v27
  v_mul_f32 v241, v241, v17
  v_mfma_f32_16x16x32_bf16 v[44:47], a[216:219], a[152:155], v[44:47]
  v_exp_f32 v40, v40
  v_mfma_f32_16x16x32_bf16 v[44:47], a[220:223], a[156:159], v[44:47]
  v_mul_f32 v245, v245, v17
  v_cvt_pk_bf16_f32 v227, v248, v252
  v_mfma_f32_16x16x32_bf16 v[56:59], v[32:35], v[8:11], 0
  v_exp_f32 v41, v41
  v_mfma_f32_16x16x32_bf16 v[128:131], v[32:35], a[64:67], 0
  v_cvt_pk_bf16_f32 v26, v40, v41
  v_mfma_f32_16x16x32_bf16 v[132:135], v[32:35], a[68:71], 0
  v_exp_f32 v42, v42
  v_mfma_f32_16x16x32_bf16 v[136:139], v[32:35], a[72:75], 0
  buffer_store_dwordx4 v[224:227], v5, s[28:31], s35 offen offset:0 nt
  v_mfma_f32_16x16x32_bf16 v[140:143], v[32:35], a[76:79], 0
  v_exp_f32 v43, v43
  v_mfma_f32_16x16x32_bf16 v[144:147], v[32:35], a[80:83], 0
  v_cvt_pk_bf16_f32 v27, v42, v43
  v_mul_f32 v249, v249, v17
  v_mfma_f32_16x16x32_bf16 v[148:151], v[32:35], a[84:87], 0
  v_exp_f32 v28, v28
  v_mfma_f32_16x16x32_bf16 v[152:155], v[32:35], a[88:91], 0
  v_mul_f32 v253, v253, v17
  v_cvt_pk_bf16_f32 v230, v241, v245
  v_mfma_f32_16x16x32_bf16 v[156:159], v[32:35], a[92:95], 0
  v_exp_f32 v29, v29
  v_mfma_f32_16x16x32_bf16 v[60:63], v[36:39], v[8:11], v[60:63]
  v_cvt_pk_bf16_f32 v28, v28, v29
  v_mul_f32 v242, v242, v18
  v_mfma_f32_16x16x32_bf16 v[160:163], v[36:39], a[64:67], v[160:163]
  v_exp_f32 v30, v30
  v_mfma_f32_16x16x32_bf16 v[164:167], v[36:39], a[68:71], v[164:167]
  v_mul_f32 v246, v246, v18
  v_cvt_pk_bf16_f32 v231, v249, v253
  v_mfma_f32_16x16x32_bf16 v[168:171], v[36:39], a[72:75], v[168:171]
  v_exp_f32 v31, v31
  v_mfma_f32_16x16x32_bf16 v[172:175], v[36:39], a[76:79], v[172:175]
  v_cvt_pk_bf16_f32 v29, v30, v31
  v_mfma_f32_16x16x32_bf16 v[176:179], v[36:39], a[80:83], v[176:179]
  v_exp_f32 v44, v44
  v_mfma_f32_16x16x32_bf16 v[180:183], v[36:39], a[84:87], v[180:183]
  buffer_store_dwordx4 v[228:231], v5, s[28:31], s35 offen offset:256 nt
  v_mfma_f32_16x16x32_bf16 v[184:187], v[36:39], a[88:91], v[184:187]
  v_exp_f32 v45, v45
  v_mfma_f32_16x16x32_bf16 v[188:191], v[36:39], a[92:95], v[188:191]
  v_cvt_pk_bf16_f32 v30, v44, v45
  v_mul_f32 v250, v250, v18
  v_mfma_f32_16x16x32_bf16 v[32:35], a[192:195], a[160:163], -4.0
  v_exp_f32 v46, v46
  v_mfma_f32_16x16x32_bf16 v[32:35], a[196:199], a[164:167], v[32:35]
  v_mul_f32 v254, v254, v18
  v_cvt_pk_bf16_f32 v234, v242, v246
  v_mfma_f32_16x16x32_bf16 v[32:35], a[200:203], a[168:171], v[32:35]
  v_exp_f32 v47, v47
  v_mfma_f32_16x16x32_bf16 v[32:35], a[204:207], a[172:175], v[32:35]
  v_cvt_pk_bf16_f32 v31, v46, v47
  v_mul_f32 v243, v243, v19
  v_mfma_f32_16x16x32_bf16 v[40:43], a[208:211], a[160:163], -4.0
  v_mul_f32 v247, v247, v19
  v_cvt_pk_bf16_f32 v235, v250, v254
  v_mfma_f32_16x16x32_bf16 v[40:43], a[212:215], a[164:167], v[40:43]
  buffer_store_dwordx4 v[232:235], v5, s[28:31], s35 offen offset:512 nt
  v_mfma_f32_16x16x32_bf16 v[40:43], a[216:219], a[168:171], v[40:43]
  v_exp_f32 v32, v32
  v_mfma_f32_16x16x32_bf16 v[40:43], a[220:223], a[172:175], v[40:43]
  v_mul_f32 v251, v251, v19
  v_mul_f32 v255, v255, v19
  v_mfma_f32_16x16x32_bf16 v[36:39], a[192:195], a[176:179], -4.0
  v_exp_f32 v33, v33
  v_mfma_f32_16x16x32_bf16 v[36:39], a[196:199], a[180:183], v[36:39]
  ds_read_b128 a[192:195], v1 offset:32768
  v_cvt_pk_bf16_f32 v32, v32, v33
  v_mfma_f32_16x16x32_bf16 v[36:39], a[200:203], a[184:187], v[36:39]
  v_exp_f32 v34, v34
  v_mfma_f32_16x16x32_bf16 v[36:39], a[204:207], a[188:191], v[36:39]
  ds_read_b128 a[196:199], v1 offset:33024
  v_cvt_pk_bf16_f32 v238, v243, v247
  v_mfma_f32_16x16x32_bf16 v[44:47], a[208:211], a[176:179], -4.0
  v_exp_f32 v35, v35
  v_mfma_f32_16x16x32_bf16 v[44:47], a[212:215], a[180:183], v[44:47]
  ds_read_b128 a[200:203], v1 offset:33280
  v_cvt_pk_bf16_f32 v33, v34, v35
  v_mfma_f32_16x16x32_bf16 v[44:47], a[216:219], a[184:187], v[44:47]
  v_exp_f32 v40, v40
  v_mfma_f32_16x16x32_bf16 v[44:47], a[220:223], a[188:191], v[44:47]
  ds_read_b128 a[204:207], v1 offset:33536
  v_cvt_pk_bf16_f32 v239, v251, v255
  v_mfma_f32_16x16x32_bf16 v[48:51], v[24:27], v[8:11], v[48:51]
  v_exp_f32 v41, v41
  v_mfma_f32_16x16x32_bf16 v[64:67], v[24:27], a[96:99], v[64:67]
  ds_read_b128 a[208:211], v1 offset:33792
  v_cvt_pk_bf16_f32 v34, v40, v41
  v_mfma_f32_16x16x32_bf16 v[68:71], v[24:27], a[100:103], v[68:71]
  v_exp_f32 v42, v42
  v_mfma_f32_16x16x32_bf16 v[72:75], v[24:27], a[104:107], v[72:75]
  ds_read_b128 a[212:215], v1 offset:34048
  v_mfma_f32_16x16x32_bf16 v[76:79], v[24:27], a[108:111], v[76:79]
  v_exp_f32 v43, v43
  v_mfma_f32_16x16x32_bf16 v[80:83], v[24:27], a[112:115], v[80:83]
  ds_read_b128 a[216:219], v1 offset:34304
  v_cvt_pk_bf16_f32 v35, v42, v43
  v_mfma_f32_16x16x32_bf16 v[84:87], v[24:27], a[116:119], v[84:87]
  v_exp_f32 v36, v36
  v_mfma_f32_16x16x32_bf16 v[88:91], v[24:27], a[120:123], v[88:91]
  ds_read_b128 a[220:223], v1 offset:34560
  v_mfma_f32_16x16x32_bf16 v[92:95], v[24:27], a[124:127], v[92:95]
  s_cmp_ge_u32 s34, s36
  v_exp_f32 v37, v37
  v_mfma_f32_16x16x32_bf16 v[52:55], v[28:31], v[8:11], v[52:55]
  s_cselect_b32 s18, 0, s18
  v_cvt_pk_bf16_f32 v36, v36, v37
  v_mfma_f32_16x16x32_bf16 v[96:99], v[28:31], a[96:99], v[96:99]
  v_exp_f32 v38, v38
  v_mfma_f32_16x16x32_bf16 v[100:103], v[28:31], a[100:103], v[100:103]
  buffer_load_dwordx4 v[208:211], v4, s[16:19], s34 offen offset:0
  v_mfma_f32_16x16x32_bf16 v[104:107], v[28:31], a[104:107], v[104:107]
  v_exp_f32 v39, v39
  v_mfma_f32_16x16x32_bf16 v[108:111], v[28:31], a[108:111], v[108:111]
  v_cvt_pk_bf16_f32 v37, v38, v39
  v_mfma_f32_16x16x32_bf16 v[112:115], v[28:31], a[112:115], v[112:115]
  v_exp_f32 v44, v44
  v_mfma_f32_16x16x32_bf16 v[116:119], v[28:31], a[116:119], v[116:119]
  buffer_load_dwordx4 v[212:215], v4, s[16:19], s34 offen offset:64
  v_mfma_f32_16x16x32_bf16 v[120:123], v[28:31], a[120:123], v[120:123]
  s_waitcnt lgkmcnt(0)
  v_exp_f32 v45, v45
  v_mfma_f32_16x16x32_bf16 v[124:127], v[28:31], a[124:127], v[124:127]
  v_cvt_pk_bf16_f32 v38, v44, v45
  v_mfma_f32_16x16x32_bf16 v[24:27], a[192:195], a[128:131], -4.0
  v_exp_f32 v46, v46
  v_mfma_f32_16x16x32_bf16 v[24:27], a[196:199], a[132:135], v[24:27]
  buffer_load_dwordx4 v[216:219], v4, s[16:19], s34 offen offset:128
  v_mfma_f32_16x16x32_bf16 v[24:27], a[200:203], a[136:139], v[24:27]
  v_exp_f32 v47, v47
  v_mfma_f32_16x16x32_bf16 v[24:27], a[204:207], a[140:143], v[24:27]
  v_cvt_pk_bf16_f32 v39, v46, v47
  v_mfma_f32_16x16x32_bf16 v[40:43], a[208:211], a[128:131], -4.0
  buffer_load_dwordx4 v[220:223], v4, s[16:19], s34 offen offset:192
  v_mfma_f32_16x16x32_bf16 v[40:43], a[212:215], a[132:135], v[40:43]
  s_add_u32 s34, s34, 4096
  v_mfma_f32_16x16x32_bf16 v[40:43], a[216:219], a[136:139], v[40:43]
  v_exp_f32 v24, v24
  v_mfma_f32_16x16x32_bf16 v[40:43], a[220:223], a[140:143], v[40:43]
  buffer_store_dwordx4 v[236:239], v5, s[28:31], s35 offen offset:768 nt
  v_mfma_f32_16x16x32_bf16 v[28:31], a[192:195], a[144:147], -4.0
  s_add_u32 s35, s35, 4096
  v_exp_f32 v25, v25
  v_mfma_f32_16x16x32_bf16 v[28:31], a[196:199], a[148:151], v[28:31]
  v_cvt_pk_bf16_f32 v24, v24, v25
  v_mfma_f32_16x16x32_bf16 v[28:31], a[200:203], a[152:155], v[28:31]
  v_exp_f32 v26, v26
  v_mfma_f32_16x16x32_bf16 v[28:31], a[204:207], a[156:159], v[28:31]
  s_waitcnt vmcnt(12)
  v_mfma_f32_16x16x32_bf16 v[44:47], a[208:211], a[144:147], -4.0
  v_exp_f32 v27, v27
  v_mfma_f32_16x16x32_bf16 v[44:47], a[212:215], a[148:151], v[44:47]
  v_cvt_pk_bf16_f32 v25, v26, v27
  v_accvgpr_write_b32 a144, v192
  v_mfma_f32_16x16x32_bf16 v[44:47], a[216:219], a[152:155], v[44:47]
  v_exp_f32 v40, v40
  v_mfma_f32_16x16x32_bf16 v[44:47], a[220:223], a[156:159], v[44:47]
  v_accvgpr_write_b32 a145, v193
  v_accvgpr_write_b32 a146, v194
  v_mfma_f32_16x16x32_bf16 v[56:59], v[32:35], v[8:11], v[56:59]
  v_exp_f32 v41, v41
  v_mfma_f32_16x16x32_bf16 v[128:131], v[32:35], a[96:99], v[128:131]
  v_cvt_pk_bf16_f32 v26, v40, v41
  v_accvgpr_write_b32 a147, v195
  v_mfma_f32_16x16x32_bf16 v[132:135], v[32:35], a[100:103], v[132:135]
  v_exp_f32 v42, v42
  v_mfma_f32_16x16x32_bf16 v[136:139], v[32:35], a[104:107], v[136:139]
  v_accvgpr_write_b32 a148, v196
  v_accvgpr_write_b32 a149, v197
  v_mfma_f32_16x16x32_bf16 v[140:143], v[32:35], a[108:111], v[140:143]
  v_exp_f32 v43, v43
  v_mfma_f32_16x16x32_bf16 v[144:147], v[32:35], a[112:115], v[144:147]
  v_cvt_pk_bf16_f32 v27, v42, v43
  v_accvgpr_write_b32 a150, v198
  v_mfma_f32_16x16x32_bf16 v[148:151], v[32:35], a[116:119], v[148:151]
  v_exp_f32 v28, v28
  v_mfma_f32_16x16x32_bf16 v[152:155], v[32:35], a[120:123], v[152:155]
  v_accvgpr_write_b32 a151, v199
  v_accvgpr_write_b32 a152, v200
  v_mfma_f32_16x16x32_bf16 v[156:159], v[32:35], a[124:127], v[156:159]
  v_exp_f32 v29, v29
  v_mfma_f32_16x16x32_bf16 v[60:63], v[36:39], v[8:11], v[60:63]
  v_cvt_pk_bf16_f32 v28, v28, v29
  v_accvgpr_write_b32 a153, v201
  v_mfma_f32_16x16x32_bf16 v[160:163], v[36:39], a[96:99], v[160:163]
  v_exp_f32 v30, v30
  v_mfma_f32_16x16x32_bf16 v[164:167], v[36:39], a[100:103], v[164:167]
  ds_read_b128 a[224:227], v3 offset:32768
  v_accvgpr_write_b32 a154, v202
  v_mfma_f32_16x16x32_bf16 v[168:171], v[36:39], a[104:107], v[168:171]
  v_exp_f32 v31, v31
  v_mfma_f32_16x16x32_bf16 v[172:175], v[36:39], a[108:111], v[172:175]
  ds_read_b128 a[228:231], v3 offset:33024
  v_cvt_pk_bf16_f32 v29, v30, v31
  v_mfma_f32_16x16x32_bf16 v[176:179], v[36:39], a[112:115], v[176:179]
  v_exp_f32 v44, v44
  v_mfma_f32_16x16x32_bf16 v[180:183], v[36:39], a[116:119], v[180:183]
  ds_read_b128 a[232:235], v3 offset:33280
  v_accvgpr_write_b32 a155, v203
  v_mfma_f32_16x16x32_bf16 v[184:187], v[36:39], a[120:123], v[184:187]
  v_exp_f32 v45, v45
  v_mfma_f32_16x16x32_bf16 v[188:191], v[36:39], a[124:127], v[188:191]
  ds_read_b128 a[236:239], v3 offset:33536
  v_cvt_pk_bf16_f32 v30, v44, v45
  v_mfma_f32_16x16x32_bf16 v[32:35], a[192:195], a[160:163], -4.0
  v_exp_f32 v46, v46
  v_mfma_f32_16x16x32_bf16 v[32:35], a[196:199], a[164:167], v[32:35]
  ds_read_b128 a[240:243], v3 offset:33792
  v_accvgpr_write_b32 a156, v204
  v_mfma_f32_16x16x32_bf16 v[32:35], a[200:203], a[168:171], v[32:35]
  v_exp_f32 v47, v47
  v_mfma_f32_16x16x32_bf16 v[32:35], a[204:207], a[172:175], v[32:35]
  ds_read_b128 a[244:247], v3 offset:34048
  v_cvt_pk_bf16_f32 v31, v46, v47
  v_mfma_f32_16x16x32_bf16 v[40:43], a[208:211], a[160:163], -4.0
  v_accvgpr_write_b32 a157, v205
  v_accvgpr_write_b32 a158, v206
  v_mfma_f32_16x16x32_bf16 v[40:43], a[212:215], a[164:167], v[40:43]
  ds_read_b128 a[248:251], v3 offset:34304
  v_accvgpr_write_b32 a159, v207
  v_mfma_f32_16x16x32_bf16 v[40:43], a[216:219], a[168:171], v[40:43]
  v_exp_f32 v32, v32
  v_mfma_f32_16x16x32_bf16 v[40:43], a[220:223], a[172:175], v[40:43]
  ds_read_b128 a[252:255], v3 offset:34560
  v_mfma_f32_16x16x32_bf16 v[36:39], a[192:195], a[176:179], -4.0
  v_exp_f32 v33, v33
  v_mfma_f32_16x16x32_bf16 v[36:39], a[196:199], a[180:183], v[36:39]
  ds_read_b128 a[192:195], v1 offset:40960
  v_cvt_pk_bf16_f32 v32, v32, v33
  v_mfma_f32_16x16x32_bf16 v[36:39], a[200:203], a[184:187], v[36:39]
  v_exp_f32 v34, v34
  v_mfma_f32_16x16x32_bf16 v[36:39], a[204:207], a[188:191], v[36:39]
  ds_read_b128 a[196:199], v1 offset:41216
  v_mfma_f32_16x16x32_bf16 v[44:47], a[208:211], a[176:179], -4.0
  v_exp_f32 v35, v35
  v_mfma_f32_16x16x32_bf16 v[44:47], a[212:215], a[180:183], v[44:47]
  ds_read_b128 a[200:203], v1 offset:41472
  v_cvt_pk_bf16_f32 v33, v34, v35
  v_mfma_f32_16x16x32_bf16 v[44:47], a[216:219], a[184:187], v[44:47]
  s_waitcnt lgkmcnt(3)
  v_exp_f32 v40, v40
  v_mfma_f32_16x16x32_bf16 v[44:47], a[220:223], a[188:191], v[44:47]
  ds_read_b128 a[204:207], v1 offset:41728
  v_mfma_f32_16x16x32_bf16 v[48:51], v[24:27], v[8:11], v[48:51]
  v_exp_f32 v41, v41
  v_mfma_f32_16x16x32_bf16 v[64:67], v[24:27], a[224:227], v[64:67]
  ds_read_b128 a[208:211], v1 offset:41984
  v_cvt_pk_bf16_f32 v34, v40, v41
  v_mfma_f32_16x16x32_bf16 v[68:71], v[24:27], a[228:231], v[68:71]
  v_exp_f32 v42, v42
  v_mfma_f32_16x16x32_bf16 v[72:75], v[24:27], a[232:235], v[72:75]
  ds_read_b128 a[212:215], v1 offset:42240
  v_mfma_f32_16x16x32_bf16 v[76:79], v[24:27], a[236:239], v[76:79]
  v_exp_f32 v43, v43
  v_mfma_f32_16x16x32_bf16 v[80:83], v[24:27], a[240:243], v[80:83]
  ds_read_b128 a[216:219], v1 offset:42496
  v_cvt_pk_bf16_f32 v35, v42, v43
  v_mfma_f32_16x16x32_bf16 v[84:87], v[24:27], a[244:247], v[84:87]
  v_exp_f32 v36, v36
  v_mfma_f32_16x16x32_bf16 v[88:91], v[24:27], a[248:251], v[88:91]
  ds_read_b128 a[220:223], v1 offset:42752
  v_mfma_f32_16x16x32_bf16 v[92:95], v[24:27], a[252:255], v[92:95]
  v_exp_f32 v37, v37
  v_mfma_f32_16x16x32_bf16 v[16:19], v[28:31], v[8:11], v[52:55]
  v_cvt_pk_bf16_f32 v36, v36, v37
  v_mfma_f32_16x16x32_bf16 v[224:227], v[28:31], a[224:227], v[96:99]
  v_exp_f32 v38, v38
  v_mfma_f32_16x16x32_bf16 v[228:231], v[28:31], a[228:231], v[100:103]
  v_mfma_f32_16x16x32_bf16 v[232:235], v[28:31], a[232:235], v[104:107]
  v_exp_f32 v39, v39
  v_mfma_f32_16x16x32_bf16 v[236:239], v[28:31], a[236:239], v[108:111]
  v_cvt_pk_bf16_f32 v37, v38, v39
  v_mfma_f32_16x16x32_bf16 v[240:243], v[28:31], a[240:243], v[112:115]
  v_exp_f32 v44, v44
  v_mfma_f32_16x16x32_bf16 v[244:247], v[28:31], a[244:247], v[116:119]
  v_rcp_f32_dpp v16, v16 row_newbcast:0 row_mask:0xf bank_mask:0xf
  v_mfma_f32_16x16x32_bf16 v[248:251], v[28:31], a[248:251], v[120:123]
  s_waitcnt lgkmcnt(0)
  v_exp_f32 v45, v45
  v_mfma_f32_16x16x32_bf16 v[252:255], v[28:31], a[252:255], v[124:127]
  v_cvt_pk_bf16_f32 v38, v44, v45
  v_mfma_f32_16x16x32_bf16 v[24:27], a[192:195], a[128:131], -4.0
  v_exp_f32 v46, v46
  v_mfma_f32_16x16x32_bf16 v[24:27], a[196:199], a[132:135], v[24:27]
  v_rcp_f32_dpp v17, v17 row_newbcast:0 row_mask:0xf bank_mask:0xf
  v_mfma_f32_16x16x32_bf16 v[24:27], a[200:203], a[136:139], v[24:27]
  v_exp_f32 v47, v47
  v_mfma_f32_16x16x32_bf16 v[24:27], a[204:207], a[140:143], v[24:27]
  v_cvt_pk_bf16_f32 v39, v46, v47
  v_mfma_f32_16x16x32_bf16 v[40:43], a[208:211], a[128:131], -4.0
  v_rcp_f32_dpp v18, v18 row_newbcast:0 row_mask:0xf bank_mask:0xf
  v_mfma_f32_16x16x32_bf16 v[40:43], a[212:215], a[132:135], v[40:43]
  v_rcp_f32_dpp v19, v19 row_newbcast:0 row_mask:0xf bank_mask:0xf
  v_mfma_f32_16x16x32_bf16 v[40:43], a[216:219], a[136:139], v[40:43]
  v_exp_f32 v24, v24
  v_mfma_f32_16x16x32_bf16 v[40:43], a[220:223], a[140:143], v[40:43]
  v_max3_u32 v6, v6, v16, v17
  v_min3_u32 v7, v7, v16, v17
  v_mfma_f32_16x16x32_bf16 v[28:31], a[192:195], a[144:147], -4.0
  v_exp_f32 v25, v25
  v_mfma_f32_16x16x32_bf16 v[28:31], a[196:199], a[148:151], v[28:31]
  v_cvt_pk_bf16_f32 v24, v24, v25
  v_max3_u32 v6, v6, v18, v19
  v_mfma_f32_16x16x32_bf16 v[28:31], a[200:203], a[152:155], v[28:31]
  v_exp_f32 v26, v26
  v_mfma_f32_16x16x32_bf16 v[28:31], a[204:207], a[156:159], v[28:31]
  v_min3_u32 v7, v7, v18, v19
  v_mul_f32 v224, v224, v16
  v_mfma_f32_16x16x32_bf16 v[44:47], a[208:211], a[144:147], -4.0
  v_exp_f32 v27, v27
  v_mfma_f32_16x16x32_bf16 v[44:47], a[212:215], a[148:151], v[44:47]
  v_cvt_pk_bf16_f32 v25, v26, v27
  v_mul_f32 v228, v228, v16
  v_mfma_f32_16x16x32_bf16 v[44:47], a[216:219], a[152:155], v[44:47]
  v_exp_f32 v40, v40
  v_mfma_f32_16x16x32_bf16 v[44:47], a[220:223], a[156:159], v[44:47]
  v_mul_f32 v225, v225, v17
  v_mul_f32 v229, v229, v17
  v_mfma_f32_16x16x32_bf16 v[56:59], v[32:35], v[8:11], v[56:59]
  v_exp_f32 v41, v41
  v_mfma_f32_16x16x32_bf16 v[128:131], v[32:35], a[224:227], v[128:131]
  v_cvt_pk_bf16_f32 v26, v40, v41
  v_cvt_pk_bf16_f32 v224, v224, v228
  v_mfma_f32_16x16x32_bf16 v[132:135], v[32:35], a[228:231], v[132:135]
  v_exp_f32 v42, v42
  v_mfma_f32_16x16x32_bf16 v[136:139], v[32:35], a[232:235], v[136:139]
  v_mul_f32 v232, v232, v16
  v_mul_f32 v236, v236, v16
  v_mfma_f32_16x16x32_bf16 v[140:143], v[32:35], a[236:239], v[140:143]
  v_exp_f32 v43, v43
  v_mfma_f32_16x16x32_bf16 v[144:147], v[32:35], a[240:243], v[144:147]
  v_cvt_pk_bf16_f32 v27, v42, v43
  v_cvt_pk_bf16_f32 v228, v225, v229
  v_mfma_f32_16x16x32_bf16 v[148:151], v[32:35], a[244:247], v[148:151]
  v_exp_f32 v28, v28
  v_mfma_f32_16x16x32_bf16 v[152:155], v[32:35], a[248:251], v[152:155]
  v_mul_f32 v226, v226, v18
  v_mul_f32 v230, v230, v18
  v_mfma_f32_16x16x32_bf16 v[156:159], v[32:35], a[252:255], v[156:159]
  v_exp_f32 v29, v29
  v_mfma_f32_16x16x32_bf16 v[60:63], v[36:39], v[8:11], v[60:63]
  v_cvt_pk_bf16_f32 v28, v28, v29
  v_cvt_pk_bf16_f32 v225, v232, v236
  v_mfma_f32_16x16x32_bf16 v[160:163], v[36:39], a[224:227], v[160:163]
  v_exp_f32 v30, v30
  v_mfma_f32_16x16x32_bf16 v[164:167], v[36:39], a[228:231], v[164:167]
  ds_read_b128 a[224:227], v3 offset:40960
  v_mul_f32 v227, v227, v19
  v_mfma_f32_16x16x32_bf16 v[168:171], v[36:39], a[232:235], v[168:171]
  v_exp_f32 v31, v31
  v_mfma_f32_16x16x32_bf16 v[172:175], v[36:39], a[236:239], v[172:175]
  ds_read_b128 a[228:231], v3 offset:41216
  v_cvt_pk_bf16_f32 v29, v30, v31
  v_mfma_f32_16x16x32_bf16 v[176:179], v[36:39], a[240:243], v[176:179]
  v_exp_f32 v44, v44
  v_mfma_f32_16x16x32_bf16 v[180:183], v[36:39], a[244:247], v[180:183]
  ds_read_b128 a[232:235], v3 offset:41472
  v_mul_f32 v231, v231, v19
  v_mfma_f32_16x16x32_bf16 v[184:187], v[36:39], a[248:251], v[184:187]
  v_exp_f32 v45, v45
  v_mfma_f32_16x16x32_bf16 v[188:191], v[36:39], a[252:255], v[188:191]
  ds_read_b128 a[236:239], v3 offset:41728
  v_cvt_pk_bf16_f32 v30, v44, v45
  v_mfma_f32_16x16x32_bf16 v[32:35], a[192:195], a[160:163], -4.0
  v_exp_f32 v46, v46
  v_mfma_f32_16x16x32_bf16 v[32:35], a[196:199], a[164:167], v[32:35]
  ds_read_b128 a[240:243], v3 offset:41984
  v_cvt_pk_bf16_f32 v232, v226, v230
  v_mfma_f32_16x16x32_bf16 v[32:35], a[200:203], a[168:171], v[32:35]
  v_exp_f32 v47, v47
  v_mfma_f32_16x16x32_bf16 v[32:35], a[204:207], a[172:175], v[32:35]
  ds_read_b128 a[244:247], v3 offset:42240
  v_cvt_pk_bf16_f32 v31, v46, v47
  v_mfma_f32_16x16x32_bf16 v[40:43], a[208:211], a[160:163], -4.0
  v_mul_f32 v233, v233, v17
  v_mul_f32 v237, v237, v17
  v_mfma_f32_16x16x32_bf16 v[40:43], a[212:215], a[164:167], v[40:43]
  ds_read_b128 a[248:251], v3 offset:42496
  v_cvt_pk_bf16_f32 v236, v227, v231
  v_mfma_f32_16x16x32_bf16 v[40:43], a[216:219], a[168:171], v[40:43]
  v_exp_f32 v32, v32
  v_mfma_f32_16x16x32_bf16 v[40:43], a[220:223], a[172:175], v[40:43]
  ds_read_b128 a[252:255], v3 offset:42752
  v_mul_f32 v234, v234, v18
  v_mfma_f32_16x16x32_bf16 v[36:39], a[192:195], a[176:179], -4.0
  v_exp_f32 v33, v33
  v_mfma_f32_16x16x32_bf16 v[36:39], a[196:199], a[180:183], v[36:39]
  ds_read_b128 a[192:195], v1 offset:49152
  v_cvt_pk_bf16_f32 v32, v32, v33
  v_mfma_f32_16x16x32_bf16 v[36:39], a[200:203], a[184:187], v[36:39]
  v_exp_f32 v34, v34
  v_mfma_f32_16x16x32_bf16 v[36:39], a[204:207], a[188:191], v[36:39]
  ds_read_b128 a[196:199], v1 offset:49408
  v_mul_f32 v238, v238, v18
  v_mfma_f32_16x16x32_bf16 v[44:47], a[208:211], a[176:179], -4.0
  v_exp_f32 v35, v35
  v_mfma_f32_16x16x32_bf16 v[44:47], a[212:215], a[180:183], v[44:47]
  ds_read_b128 a[200:203], v1 offset:49664
  v_cvt_pk_bf16_f32 v33, v34, v35
  v_mfma_f32_16x16x32_bf16 v[44:47], a[216:219], a[184:187], v[44:47]
  s_waitcnt lgkmcnt(3)
  v_exp_f32 v40, v40
  v_mfma_f32_16x16x32_bf16 v[44:47], a[220:223], a[188:191], v[44:47]
  ds_read_b128 a[204:207], v1 offset:49920
  v_cvt_pk_bf16_f32 v229, v233, v237
  v_mfma_f32_16x16x32_bf16 v[48:51], v[24:27], v[8:11], v[48:51]
  v_exp_f32 v41, v41
  v_mfma_f32_16x16x32_bf16 v[64:67], v[24:27], a[224:227], v[64:67]
  ds_read_b128 a[208:211], v1 offset:50176
  v_cvt_pk_bf16_f32 v34, v40, v41
  v_mfma_f32_16x16x32_bf16 v[68:71], v[24:27], a[228:231], v[68:71]
  v_exp_f32 v42, v42
  v_mfma_f32_16x16x32_bf16 v[72:75], v[24:27], a[232:235], v[72:75]
  ds_read_b128 a[212:215], v1 offset:50432
  v_mul_f32 v235, v235, v19
  v_mfma_f32_16x16x32_bf16 v[76:79], v[24:27], a[236:239], v[76:79]
  v_exp_f32 v43, v43
  v_mfma_f32_16x16x32_bf16 v[80:83], v[24:27], a[240:243], v[80:83]
  ds_read_b128 a[216:219], v1 offset:50688
  v_cvt_pk_bf16_f32 v35, v42, v43
  v_mfma_f32_16x16x32_bf16 v[84:87], v[24:27], a[244:247], v[84:87]
  v_exp_f32 v36, v36
  v_mfma_f32_16x16x32_bf16 v[88:91], v[24:27], a[248:251], v[88:91]
  ds_read_b128 a[220:223], v1 offset:50944
  v_mul_f32 v239, v239, v19
  v_mfma_f32_16x16x32_bf16 v[92:95], v[24:27], a[252:255], v[92:95]
  v_exp_f32 v37, v37
  v_mfma_f32_16x16x32_bf16 v[52:55], v[28:31], v[8:11], 0
  v_cvt_pk_bf16_f32 v36, v36, v37
  v_cvt_pk_bf16_f32 v233, v234, v238
  v_mfma_f32_16x16x32_bf16 v[96:99], v[28:31], a[224:227], 0
  v_exp_f32 v38, v38
  v_mfma_f32_16x16x32_bf16 v[100:103], v[28:31], a[228:231], 0
  v_mul_f32 v240, v240, v16
  v_mul_f32 v244, v244, v16
  v_mfma_f32_16x16x32_bf16 v[104:107], v[28:31], a[232:235], 0
  v_exp_f32 v39, v39
  v_mfma_f32_16x16x32_bf16 v[108:111], v[28:31], a[236:239], 0
  v_cvt_pk_bf16_f32 v37, v38, v39
  v_cvt_pk_bf16_f32 v237, v235, v239
  v_mfma_f32_16x16x32_bf16 v[112:115], v[28:31], a[240:243], 0
  v_exp_f32 v44, v44
  v_mfma_f32_16x16x32_bf16 v[116:119], v[28:31], a[244:247], 0
  v_mul_f32 v248, v248, v16
  v_mul_f32 v252, v252, v16
  v_mfma_f32_16x16x32_bf16 v[120:123], v[28:31], a[248:251], 0
  s_waitcnt lgkmcnt(0)
  v_exp_f32 v45, v45
  v_mfma_f32_16x16x32_bf16 v[124:127], v[28:31], a[252:255], 0
  v_cvt_pk_bf16_f32 v38, v44, v45
  v_cvt_pk_bf16_f32 v226, v240, v244
  v_mfma_f32_16x16x32_bf16 v[24:27], a[192:195], a[128:131], -4.0
  v_exp_f32 v46, v46
  v_mfma_f32_16x16x32_bf16 v[24:27], a[196:199], a[132:135], v[24:27]
  v_mul_f32 v241, v241, v17
  v_mul_f32 v245, v245, v17
  v_mfma_f32_16x16x32_bf16 v[24:27], a[200:203], a[136:139], v[24:27]
  v_exp_f32 v47, v47
  v_mfma_f32_16x16x32_bf16 v[24:27], a[204:207], a[140:143], v[24:27]
  v_cvt_pk_bf16_f32 v39, v46, v47
  v_cvt_pk_bf16_f32 v227, v248, v252
  v_mfma_f32_16x16x32_bf16 v[40:43], a[208:211], a[128:131], -4.0
  buffer_store_dwordx4 v[224:227], v5, s[28:31], s35 offen offset:0 nt
  v_mfma_f32_16x16x32_bf16 v[40:43], a[212:215], a[132:135], v[40:43]
  v_mul_f32 v249, v249, v17
  v_mul_f32 v253, v253, v17
  v_mfma_f32_16x16x32_bf16 v[40:43], a[216:219], a[136:139], v[40:43]
  v_exp_f32 v24, v24
  v_mfma_f32_16x16x32_bf16 v[40:43], a[220:223], a[140:143], v[40:43]
  v_cvt_pk_bf16_f32 v230, v241, v245
  v_mul_f32 v242, v242, v18
  v_mfma_f32_16x16x32_bf16 v[28:31], a[192:195], a[144:147], -4.0
  v_exp_f32 v25, v25
  v_mfma_f32_16x16x32_bf16 v[28:31], a[196:199], a[148:151], v[28:31]
  v_cvt_pk_bf16_f32 v24, v24, v25
  v_mul_f32 v246, v246, v18
  v_mfma_f32_16x16x32_bf16 v[28:31], a[200:203], a[152:155], v[28:31]
  v_exp_f32 v26, v26
  v_mfma_f32_16x16x32_bf16 v[28:31], a[204:207], a[156:159], v[28:31]
  v_cvt_pk_bf16_f32 v231, v249, v253
  v_mfma_f32_16x16x32_bf16 v[44:47], a[208:211], a[144:147], -4.0
  v_exp_f32 v27, v27
  v_mfma_f32_16x16x32_bf16 v[44:47], a[212:215], a[148:151], v[44:47]
  v_cvt_pk_bf16_f32 v25, v26, v27
  v_mfma_f32_16x16x32_bf16 v[44:47], a[216:219], a[152:155], v[44:47]
  v_exp_f32 v40, v40
  v_mfma_f32_16x16x32_bf16 v[44:47], a[220:223], a[156:159], v[44:47]
  buffer_store_dwordx4 v[228:231], v5, s[28:31], s35 offen offset:256 nt
  v_mfma_f32_16x16x32_bf16 v[56:59], v[32:35], v[8:11], v[56:59]
  v_exp_f32 v41, v41
  v_mfma_f32_16x16x32_bf16 v[128:131], v[32:35], a[224:227], v[128:131]
  v_cvt_pk_bf16_f32 v26, v40, v41
  v_mul_f32 v250, v250, v18
  v_mfma_f32_16x16x32_bf16 v[132:135], v[32:35], a[228:231], v[132:135]
  v_exp_f32 v42, v42
  v_mfma_f32_16x16x32_bf16 v[136:139], v[32:35], a[232:235], v[136:139]
  v_mul_f32 v254, v254, v18
  v_cvt_pk_bf16_f32 v234, v242, v246
  v_mfma_f32_16x16x32_bf16 v[140:143], v[32:35], a[236:239], v[140:143]
  v_exp_f32 v43, v43
  v_mfma_f32_16x16x32_bf16 v[144:147], v[32:35], a[240:243], v[144:147]
  v_cvt_pk_bf16_f32 v27, v42, v43
  v_mul_f32 v243, v243, v19
  v_mfma_f32_16x16x32_bf16 v[148:151], v[32:35], a[244:247], v[148:151]
  v_exp_f32 v28, v28
  v_mfma_f32_16x16x32_bf16 v[152:155], v[32:35], a[248:251], v[152:155]
  v_mul_f32 v247, v247, v19
  v_cvt_pk_bf16_f32 v235, v250, v254
  v_mfma_f32_16x16x32_bf16 v[156:159], v[32:35], a[252:255], v[156:159]
  v_exp_f32 v29, v29
  v_mfma_f32_16x16x32_bf16 v[60:63], v[36:39], v[8:11], v[60:63]
  v_cvt_pk_bf16_f32 v28, v28, v29
  v_mfma_f32_16x16x32_bf16 v[160:163], v[36:39], a[224:227], v[160:163]
  v_exp_f32 v30, v30
  v_mfma_f32_16x16x32_bf16 v[164:167], v[36:39], a[228:231], v[164:167]
  ds_read_b128 a[224:227], v3 offset:49152
  v_mfma_f32_16x16x32_bf16 v[168:171], v[36:39], a[232:235], v[168:171]
  v_exp_f32 v31, v31
  v_mfma_f32_16x16x32_bf16 v[172:175], v[36:39], a[236:239], v[172:175]
  ds_read_b128 a[228:231], v3 offset:49408
  v_cvt_pk_bf16_f32 v29, v30, v31
  v_mfma_f32_16x16x32_bf16 v[176:179], v[36:39], a[240:243], v[176:179]
  v_exp_f32 v44, v44
  v_mfma_f32_16x16x32_bf16 v[180:183], v[36:39], a[244:247], v[180:183]
  ds_read_b128 a[232:235], v3 offset:49664
  v_mfma_f32_16x16x32_bf16 v[184:187], v[36:39], a[248:251], v[184:187]
  v_exp_f32 v45, v45
  v_mfma_f32_16x16x32_bf16 v[188:191], v[36:39], a[252:255], v[188:191]
  ds_read_b128 a[236:239], v3 offset:49920
  v_cvt_pk_bf16_f32 v30, v44, v45
  v_mfma_f32_16x16x32_bf16 v[32:35], a[192:195], a[160:163], -4.0
  v_exp_f32 v46, v46
  v_mfma_f32_16x16x32_bf16 v[32:35], a[196:199], a[164:167], v[32:35]
  ds_read_b128 a[240:243], v3 offset:50176
  v_mfma_f32_16x16x32_bf16 v[32:35], a[200:203], a[168:171], v[32:35]
  v_exp_f32 v47, v47
  v_mfma_f32_16x16x32_bf16 v[32:35], a[204:207], a[172:175], v[32:35]
  ds_read_b128 a[244:247], v3 offset:50432
  v_cvt_pk_bf16_f32 v31, v46, v47
  v_mfma_f32_16x16x32_bf16 v[40:43], a[208:211], a[160:163], -4.0
  buffer_store_dwordx4 v[232:235], v5, s[28:31], s35 offen offset:512 nt
  v_mfma_f32_16x16x32_bf16 v[40:43], a[212:215], a[164:167], v[40:43]
  ds_read_b128 a[248:251], v3 offset:50688
  v_mul_f32 v251, v251, v19
  v_mfma_f32_16x16x32_bf16 v[40:43], a[216:219], a[168:171], v[40:43]
  v_exp_f32 v32, v32
  v_mfma_f32_16x16x32_bf16 v[40:43], a[220:223], a[172:175], v[40:43]
  ds_read_b128 a[252:255], v3 offset:50944
  v_mul_f32 v255, v255, v19
  v_mfma_f32_16x16x32_bf16 v[36:39], a[192:195], a[176:179], -4.0
  v_exp_f32 v33, v33
  v_mfma_f32_16x16x32_bf16 v[36:39], a[196:199], a[180:183], v[36:39]
  ds_read_b128 a[192:195], v1 offset:57344
  v_cvt_pk_bf16_f32 v32, v32, v33
  v_mfma_f32_16x16x32_bf16 v[36:39], a[200:203], a[184:187], v[36:39]
  v_exp_f32 v34, v34
  v_mfma_f32_16x16x32_bf16 v[36:39], a[204:207], a[188:191], v[36:39]
  ds_read_b128 a[196:199], v1 offset:57600
  v_cvt_pk_bf16_f32 v238, v243, v247
  v_mfma_f32_16x16x32_bf16 v[44:47], a[208:211], a[176:179], -4.0
  v_exp_f32 v35, v35
  v_mfma_f32_16x16x32_bf16 v[44:47], a[212:215], a[180:183], v[44:47]
  ds_read_b128 a[200:203], v1 offset:57856
  v_cvt_pk_bf16_f32 v33, v34, v35
  v_mfma_f32_16x16x32_bf16 v[44:47], a[216:219], a[184:187], v[44:47]
  s_waitcnt lgkmcnt(3)
  v_exp_f32 v40, v40
  v_mfma_f32_16x16x32_bf16 v[44:47], a[220:223], a[188:191], v[44:47]
  ds_read_b128 a[204:207], v1 offset:58112
  v_cvt_pk_bf16_f32 v239, v251, v255
  v_mfma_f32_16x16x32_bf16 v[48:51], v[24:27], v[8:11], v[48:51]
  v_exp_f32 v41, v41
  v_mfma_f32_16x16x32_bf16 v[64:67], v[24:27], a[224:227], v[64:67]
  ds_read_b128 a[208:211], v1 offset:58368
  v_cvt_pk_bf16_f32 v34, v40, v41
  v_mfma_f32_16x16x32_bf16 v[68:71], v[24:27], a[228:231], v[68:71]
  v_exp_f32 v42, v42
  v_mfma_f32_16x16x32_bf16 v[72:75], v[24:27], a[232:235], v[72:75]
  ds_read_b128 a[212:215], v1 offset:58624
  v_mfma_f32_16x16x32_bf16 v[76:79], v[24:27], a[236:239], v[76:79]
  v_exp_f32 v43, v43
  v_mfma_f32_16x16x32_bf16 v[80:83], v[24:27], a[240:243], v[80:83]
  ds_read_b128 a[216:219], v1 offset:58880
  v_cvt_pk_bf16_f32 v35, v42, v43
  v_mfma_f32_16x16x32_bf16 v[84:87], v[24:27], a[244:247], v[84:87]
  v_exp_f32 v36, v36
  v_mfma_f32_16x16x32_bf16 v[88:91], v[24:27], a[248:251], v[88:91]
  ds_read_b128 a[220:223], v1 offset:59136
  v_mfma_f32_16x16x32_bf16 v[92:95], v[24:27], a[252:255], v[92:95]
  s_cmp_ge_u32 s34, s36
  v_exp_f32 v37, v37
  v_mfma_f32_16x16x32_bf16 v[52:55], v[28:31], v[8:11], v[52:55]
  s_cselect_b32 s18, 0, s18
  v_cvt_pk_bf16_f32 v36, v36, v37
  v_mfma_f32_16x16x32_bf16 v[96:99], v[28:31], a[224:227], v[96:99]
  v_exp_f32 v38, v38
  v_mfma_f32_16x16x32_bf16 v[100:103], v[28:31], a[228:231], v[100:103]
  buffer_load_dwordx4 v[192:195], v4, s[16:19], s34 offen offset:0
  v_mfma_f32_16x16x32_bf16 v[104:107], v[28:31], a[232:235], v[104:107]
  v_exp_f32 v39, v39
  v_mfma_f32_16x16x32_bf16 v[108:111], v[28:31], a[236:239], v[108:111]
  v_cvt_pk_bf16_f32 v37, v38, v39
  v_mfma_f32_16x16x32_bf16 v[112:115], v[28:31], a[240:243], v[112:115]
  v_exp_f32 v44, v44
  v_mfma_f32_16x16x32_bf16 v[116:119], v[28:31], a[244:247], v[116:119]
  buffer_load_dwordx4 v[196:199], v4, s[16:19], s34 offen offset:64
  v_mfma_f32_16x16x32_bf16 v[120:123], v[28:31], a[248:251], v[120:123]
  s_waitcnt lgkmcnt(0)
  v_exp_f32 v45, v45
  v_mfma_f32_16x16x32_bf16 v[124:127], v[28:31], a[252:255], v[124:127]
  v_cvt_pk_bf16_f32 v38, v44, v45
  v_mfma_f32_16x16x32_bf16 v[24:27], a[192:195], a[128:131], -4.0
  v_exp_f32 v46, v46
  v_mfma_f32_16x16x32_bf16 v[24:27], a[196:199], a[132:135], v[24:27]
  buffer_load_dwordx4 v[200:203], v4, s[16:19], s34 offen offset:128
  v_mfma_f32_16x16x32_bf16 v[24:27], a[200:203], a[136:139], v[24:27]
  v_exp_f32 v47, v47
  v_mfma_f32_16x16x32_bf16 v[24:27], a[204:207], a[140:143], v[24:27]
  v_cvt_pk_bf16_f32 v39, v46, v47
  v_mfma_f32_16x16x32_bf16 v[40:43], a[208:211], a[128:131], -4.0
  buffer_load_dwordx4 v[204:207], v4, s[16:19], s34 offen offset:192
  v_mfma_f32_16x16x32_bf16 v[40:43], a[212:215], a[132:135], v[40:43]
  s_add_u32 s34, s34, 4096
  v_mfma_f32_16x16x32_bf16 v[40:43], a[216:219], a[136:139], v[40:43]
  v_exp_f32 v24, v24
  v_mfma_f32_16x16x32_bf16 v[40:43], a[220:223], a[140:143], v[40:43]
  buffer_store_dwordx4 v[236:239], v5, s[28:31], s35 offen offset:768 nt
  v_mfma_f32_16x16x32_bf16 v[28:31], a[192:195], a[144:147], -4.0
  s_add_u32 s35, s35, 4096
  v_exp_f32 v25, v25
  v_mfma_f32_16x16x32_bf16 v[28:31], a[196:199], a[148:151], v[28:31]
  v_cvt_pk_bf16_f32 v24, v24, v25
  v_mfma_f32_16x16x32_bf16 v[28:31], a[200:203], a[152:155], v[28:31]
  v_exp_f32 v26, v26
  v_mfma_f32_16x16x32_bf16 v[28:31], a[204:207], a[156:159], v[28:31]
  v_mfma_f32_16x16x32_bf16 v[44:47], a[208:211], a[144:147], -4.0
  v_exp_f32 v27, v27
  v_mfma_f32_16x16x32_bf16 v[44:47], a[212:215], a[148:151], v[44:47]
  v_cvt_pk_bf16_f32 v25, v26, v27
  v_mfma_f32_16x16x32_bf16 v[44:47], a[216:219], a[152:155], v[44:47]
  v_exp_f32 v40, v40
  v_mfma_f32_16x16x32_bf16 v[44:47], a[220:223], a[156:159], v[44:47]
  v_mfma_f32_16x16x32_bf16 v[56:59], v[32:35], v[8:11], v[56:59]
  v_exp_f32 v41, v41
  v_mfma_f32_16x16x32_bf16 v[128:131], v[32:35], a[224:227], v[128:131]
  v_cvt_pk_bf16_f32 v26, v40, v41
  v_mfma_f32_16x16x32_bf16 v[132:135], v[32:35], a[228:231], v[132:135]
  v_exp_f32 v42, v42
  v_mfma_f32_16x16x32_bf16 v[136:139], v[32:35], a[232:235], v[136:139]
  v_mfma_f32_16x16x32_bf16 v[140:143], v[32:35], a[236:239], v[140:143]
  v_exp_f32 v43, v43
  v_mfma_f32_16x16x32_bf16 v[144:147], v[32:35], a[240:243], v[144:147]
  v_cvt_pk_bf16_f32 v27, v42, v43
  v_mfma_f32_16x16x32_bf16 v[148:151], v[32:35], a[244:247], v[148:151]
  v_exp_f32 v28, v28
  v_mfma_f32_16x16x32_bf16 v[152:155], v[32:35], a[248:251], v[152:155]
  v_mfma_f32_16x16x32_bf16 v[156:159], v[32:35], a[252:255], v[156:159]
  v_exp_f32 v29, v29
  v_mfma_f32_16x16x32_bf16 v[60:63], v[36:39], v[8:11], v[60:63]
  v_cvt_pk_bf16_f32 v28, v28, v29
  v_mfma_f32_16x16x32_bf16 v[160:163], v[36:39], a[224:227], v[160:163]
  v_exp_f32 v30, v30
  v_mfma_f32_16x16x32_bf16 v[164:167], v[36:39], a[228:231], v[164:167]
  ds_read_b128 a[224:227], v3 offset:57344
  v_mfma_f32_16x16x32_bf16 v[168:171], v[36:39], a[232:235], v[168:171]
  v_exp_f32 v31, v31
  v_mfma_f32_16x16x32_bf16 v[172:175], v[36:39], a[236:239], v[172:175]
  ds_read_b128 a[228:231], v3 offset:57600
  v_cvt_pk_bf16_f32 v29, v30, v31
  v_mfma_f32_16x16x32_bf16 v[176:179], v[36:39], a[240:243], v[176:179]
  v_exp_f32 v44, v44
  v_mfma_f32_16x16x32_bf16 v[180:183], v[36:39], a[244:247], v[180:183]
  ds_read_b128 a[232:235], v3 offset:57856
  v_mfma_f32_16x16x32_bf16 v[184:187], v[36:39], a[248:251], v[184:187]
  v_exp_f32 v45, v45
  v_mfma_f32_16x16x32_bf16 v[188:191], v[36:39], a[252:255], v[188:191]
  ds_read_b128 a[236:239], v3 offset:58112
  v_cvt_pk_bf16_f32 v30, v44, v45
  v_mfma_f32_16x16x32_bf16 v[32:35], a[192:195], a[160:163], -4.0
  v_exp_f32 v46, v46
  v_mfma_f32_16x16x32_bf16 v[32:35], a[196:199], a[164:167], v[32:35]
  ds_read_b128 a[240:243], v3 offset:58368
  v_mfma_f32_16x16x32_bf16 v[32:35], a[200:203], a[168:171], v[32:35]
  v_exp_f32 v47, v47
  v_mfma_f32_16x16x32_bf16 v[32:35], a[204:207], a[172:175], v[32:35]
  ds_read_b128 a[244:247], v3 offset:58624
  v_cvt_pk_bf16_f32 v31, v46, v47
  v_mfma_f32_16x16x32_bf16 v[40:43], a[208:211], a[160:163], -4.0
  v_mfma_f32_16x16x32_bf16 v[40:43], a[212:215], a[164:167], v[40:43]
  ds_read_b128 a[248:251], v3 offset:58880
  v_mfma_f32_16x16x32_bf16 v[40:43], a[216:219], a[168:171], v[40:43]
  v_exp_f32 v32, v32
  v_mfma_f32_16x16x32_bf16 v[40:43], a[220:223], a[172:175], v[40:43]
  ds_read_b128 a[252:255], v3 offset:59136
  v_mfma_f32_16x16x32_bf16 v[36:39], a[192:195], a[176:179], -4.0
  v_exp_f32 v33, v33
  v_mfma_f32_16x16x32_bf16 v[36:39], a[196:199], a[180:183], v[36:39]
  ds_read_b128 a[192:195], v2 offset:0
  v_cvt_pk_bf16_f32 v32, v32, v33
  v_mfma_f32_16x16x32_bf16 v[36:39], a[200:203], a[184:187], v[36:39]
  v_exp_f32 v34, v34
  v_mfma_f32_16x16x32_bf16 v[36:39], a[204:207], a[188:191], v[36:39]
  ds_read_b128 a[196:199], v2 offset:256
  s_waitcnt vmcnt(9)
  v_mfma_f32_16x16x32_bf16 v[44:47], a[208:211], a[176:179], -4.0
  v_exp_f32 v35, v35
  v_mfma_f32_16x16x32_bf16 v[44:47], a[212:215], a[180:183], v[44:47]
  ds_read_b128 a[200:203], v2 offset:512
  v_cvt_pk_bf16_f32 v33, v34, v35
  v_mfma_f32_16x16x32_bf16 v[44:47], a[216:219], a[184:187], v[44:47]
  s_waitcnt lgkmcnt(3)
  v_exp_f32 v40, v40
  v_mfma_f32_16x16x32_bf16 v[44:47], a[220:223], a[188:191], v[44:47]
  ds_read_b128 a[204:207], v2 offset:768
  v_accvgpr_write_b32 a176, v208
  v_mfma_f32_16x16x32_bf16 v[48:51], v[24:27], v[8:11], v[48:51]
  v_exp_f32 v41, v41
  v_mfma_f32_16x16x32_bf16 v[64:67], v[24:27], a[224:227], v[64:67]
  ds_read_b128 a[208:211], v2 offset:1024
  v_cvt_pk_bf16_f32 v34, v40, v41
  v_mfma_f32_16x16x32_bf16 v[68:71], v[24:27], a[228:231], v[68:71]
  v_exp_f32 v42, v42
  v_mfma_f32_16x16x32_bf16 v[72:75], v[24:27], a[232:235], v[72:75]
  ds_read_b128 a[212:215], v2 offset:1280
  v_accvgpr_write_b32 a177, v209
  v_mfma_f32_16x16x32_bf16 v[76:79], v[24:27], a[236:239], v[76:79]
  v_exp_f32 v43, v43
  v_mfma_f32_16x16x32_bf16 v[80:83], v[24:27], a[240:243], v[80:83]
  ds_read_b128 a[216:219], v2 offset:1536
  v_cvt_pk_bf16_f32 v35, v42, v43
  v_mfma_f32_16x16x32_bf16 v[84:87], v[24:27], a[244:247], v[84:87]
  v_exp_f32 v36, v36
  v_mfma_f32_16x16x32_bf16 v[88:91], v[24:27], a[248:251], v[88:91]
  ds_read_b128 a[220:223], v2 offset:1792
  v_accvgpr_write_b32 a178, v210
  v_mfma_f32_16x16x32_bf16 v[92:95], v[24:27], a[252:255], v[92:95]
  v_exp_f32 v37, v37
  v_mfma_f32_16x16x32_bf16 v[52:55], v[28:31], v[8:11], v[52:55]
  v_cvt_pk_bf16_f32 v36, v36, v37
  v_accvgpr_write_b32 a179, v211
  v_mfma_f32_16x16x32_bf16 v[96:99], v[28:31], a[224:227], v[96:99]
  v_exp_f32 v38, v38
  v_mfma_f32_16x16x32_bf16 v[100:103], v[28:31], a[228:231], v[100:103]
  v_accvgpr_write_b32 a180, v212
  v_accvgpr_write_b32 a181, v213
  v_mfma_f32_16x16x32_bf16 v[104:107], v[28:31], a[232:235], v[104:107]
  v_exp_f32 v39, v39
  v_mfma_f32_16x16x32_bf16 v[108:111], v[28:31], a[236:239], v[108:111]
  v_cvt_pk_bf16_f32 v37, v38, v39
  v_accvgpr_write_b32 a182, v214
  v_mfma_f32_16x16x32_bf16 v[112:115], v[28:31], a[240:243], v[112:115]
  v_exp_f32 v44, v44
  v_mfma_f32_16x16x32_bf16 v[116:119], v[28:31], a[244:247], v[116:119]
  v_accvgpr_write_b32 a183, v215
  v_accvgpr_write_b32 a184, v216
  v_mfma_f32_16x16x32_bf16 v[120:123], v[28:31], a[248:251], v[120:123]
  s_waitcnt lgkmcnt(0)
  v_exp_f32 v45, v45
  v_mfma_f32_16x16x32_bf16 v[124:127], v[28:31], a[252:255], v[124:127]
  v_cvt_pk_bf16_f32 v38, v44, v45
  v_accvgpr_write_b32 a185, v217
  v_mfma_f32_16x16x32_bf16 v[24:27], a[192:195], a[128:131], -4.0
  v_exp_f32 v46, v46
  v_mfma_f32_16x16x32_bf16 v[24:27], a[196:199], a[132:135], v[24:27]
  v_accvgpr_write_b32 a186, v218
  v_accvgpr_write_b32 a187, v219
  v_mfma_f32_16x16x32_bf16 v[24:27], a[200:203], a[136:139], v[24:27]
  v_exp_f32 v47, v47
  v_mfma_f32_16x16x32_bf16 v[24:27], a[204:207], a[140:143], v[24:27]
  v_cvt_pk_bf16_f32 v39, v46, v47
  v_accvgpr_write_b32 a188, v220
  v_mfma_f32_16x16x32_bf16 v[40:43], a[208:211], a[128:131], -4.0
  v_accvgpr_write_b32 a189, v221
  v_accvgpr_write_b32 a190, v222
  v_mfma_f32_16x16x32_bf16 v[40:43], a[212:215], a[132:135], v[40:43]
  v_accvgpr_write_b32 a191, v223
  v_mfma_f32_16x16x32_bf16 v[40:43], a[216:219], a[136:139], v[40:43]
  v_exp_f32 v24, v24
  v_mfma_f32_16x16x32_bf16 v[40:43], a[220:223], a[140:143], v[40:43]
  v_mfma_f32_16x16x32_bf16 v[28:31], a[192:195], a[144:147], -4.0
  v_exp_f32 v25, v25
  v_mfma_f32_16x16x32_bf16 v[28:31], a[196:199], a[148:151], v[28:31]
  v_cvt_pk_bf16_f32 v24, v24, v25
  v_mfma_f32_16x16x32_bf16 v[28:31], a[200:203], a[152:155], v[28:31]
  v_exp_f32 v26, v26
  v_mfma_f32_16x16x32_bf16 v[28:31], a[204:207], a[156:159], v[28:31]
  v_mfma_f32_16x16x32_bf16 v[44:47], a[208:211], a[144:147], -4.0
  v_exp_f32 v27, v27
  v_mfma_f32_16x16x32_bf16 v[44:47], a[212:215], a[148:151], v[44:47]
  v_cvt_pk_bf16_f32 v25, v26, v27
  v_mfma_f32_16x16x32_bf16 v[44:47], a[216:219], a[152:155], v[44:47]
  v_exp_f32 v40, v40
  v_mfma_f32_16x16x32_bf16 v[44:47], a[220:223], a[156:159], v[44:47]
  v_mfma_f32_16x16x32_bf16 v[56:59], v[32:35], v[8:11], v[56:59]
  v_exp_f32 v41, v41
  v_mfma_f32_16x16x32_bf16 v[128:131], v[32:35], a[224:227], v[128:131]
  v_cvt_pk_bf16_f32 v26, v40, v41
  v_mfma_f32_16x16x32_bf16 v[132:135], v[32:35], a[228:231], v[132:135]
  v_exp_f32 v42, v42
  v_mfma_f32_16x16x32_bf16 v[136:139], v[32:35], a[232:235], v[136:139]
  v_mfma_f32_16x16x32_bf16 v[140:143], v[32:35], a[236:239], v[140:143]
  v_exp_f32 v43, v43
  v_mfma_f32_16x16x32_bf16 v[144:147], v[32:35], a[240:243], v[144:147]
  v_cvt_pk_bf16_f32 v27, v42, v43
  v_mfma_f32_16x16x32_bf16 v[148:151], v[32:35], a[244:247], v[148:151]
  v_exp_f32 v28, v28
  v_mfma_f32_16x16x32_bf16 v[152:155], v[32:35], a[248:251], v[152:155]
  v_mfma_f32_16x16x32_bf16 v[156:159], v[32:35], a[252:255], v[156:159]
  v_exp_f32 v29, v29
  v_mfma_f32_16x16x32_bf16 v[16:19], v[36:39], v[8:11], v[60:63]
  v_cvt_pk_bf16_f32 v28, v28, v29
  v_mfma_f32_16x16x32_bf16 v[224:227], v[36:39], a[224:227], v[160:163]
  v_exp_f32 v30, v30
  v_mfma_f32_16x16x32_bf16 v[228:231], v[36:39], a[228:231], v[164:167]
  ds_read_b128 a[224:227], v3 offset:0
  v_mfma_f32_16x16x32_bf16 v[232:235], v[36:39], a[232:235], v[168:171]
  v_exp_f32 v31, v31
  v_mfma_f32_16x16x32_bf16 v[236:239], v[36:39], a[236:239], v[172:175]
  ds_read_b128 a[228:231], v3 offset:256
  v_cvt_pk_bf16_f32 v29, v30, v31
  v_mfma_f32_16x16x32_bf16 v[240:243], v[36:39], a[240:243], v[176:179]
  v_exp_f32 v44, v44
  v_mfma_f32_16x16x32_bf16 v[244:247], v[36:39], a[244:247], v[180:183]
  ds_read_b128 a[232:235], v3 offset:512
  v_mfma_f32_16x16x32_bf16 v[248:251], v[36:39], a[248:251], v[184:187]
  v_exp_f32 v45, v45
  v_mfma_f32_16x16x32_bf16 v[252:255], v[36:39], a[252:255], v[188:191]
  ds_read_b128 a[236:239], v3 offset:768
  v_cvt_pk_bf16_f32 v30, v44, v45
  v_mfma_f32_16x16x32_bf16 v[32:35], a[192:195], a[160:163], -4.0
  v_exp_f32 v46, v46
  v_mfma_f32_16x16x32_bf16 v[32:35], a[196:199], a[164:167], v[32:35]
  ds_read_b128 a[240:243], v3 offset:1024
  v_mfma_f32_16x16x32_bf16 v[32:35], a[200:203], a[168:171], v[32:35]
  v_exp_f32 v47, v47
  v_mfma_f32_16x16x32_bf16 v[32:35], a[204:207], a[172:175], v[32:35]
  ds_read_b128 a[244:247], v3 offset:1280
  v_cvt_pk_bf16_f32 v31, v46, v47
  v_mfma_f32_16x16x32_bf16 v[40:43], a[208:211], a[160:163], -4.0
  v_rcp_f32_dpp v16, v16 row_newbcast:0 row_mask:0xf bank_mask:0xf
  v_mfma_f32_16x16x32_bf16 v[40:43], a[212:215], a[164:167], v[40:43]
  ds_read_b128 a[248:251], v3 offset:1536
  v_mfma_f32_16x16x32_bf16 v[40:43], a[216:219], a[168:171], v[40:43]
  v_exp_f32 v32, v32
  v_mfma_f32_16x16x32_bf16 v[40:43], a[220:223], a[172:175], v[40:43]
  ds_read_b128 a[252:255], v3 offset:1792
  v_mfma_f32_16x16x32_bf16 v[36:39], a[192:195], a[176:179], -4.0
  v_exp_f32 v33, v33
  v_mfma_f32_16x16x32_bf16 v[36:39], a[196:199], a[180:183], v[36:39]
  ds_read_b128 a[192:195], v2 offset:8192
  v_cvt_pk_bf16_f32 v32, v32, v33
  v_mfma_f32_16x16x32_bf16 v[36:39], a[200:203], a[184:187], v[36:39]
  v_exp_f32 v34, v34
  v_mfma_f32_16x16x32_bf16 v[36:39], a[204:207], a[188:191], v[36:39]
  ds_read_b128 a[196:199], v2 offset:8448
  v_mfma_f32_16x16x32_bf16 v[44:47], a[208:211], a[176:179], -4.0
  v_exp_f32 v35, v35
  v_mfma_f32_16x16x32_bf16 v[44:47], a[212:215], a[180:183], v[44:47]
  ds_read_b128 a[200:203], v2 offset:8704
  v_cvt_pk_bf16_f32 v33, v34, v35
  v_mfma_f32_16x16x32_bf16 v[44:47], a[216:219], a[184:187], v[44:47]
  s_waitcnt lgkmcnt(3)
  v_exp_f32 v40, v40
  v_mfma_f32_16x16x32_bf16 v[44:47], a[220:223], a[188:191], v[44:47]
  ds_read_b128 a[204:207], v2 offset:8960
  v_mfma_f32_16x16x32_bf16 v[48:51], v[24:27], v[8:11], v[48:51]
  v_exp_f32 v41, v41
  v_mfma_f32_16x16x32_bf16 v[64:67], v[24:27], a[224:227], v[64:67]
  ds_read_b128 a[208:211], v2 offset:9216
  v_cvt_pk_bf16_f32 v34, v40, v41
  v_mfma_f32_16x16x32_bf16 v[68:71], v[24:27], a[228:231], v[68:71]
  v_exp_f32 v42, v42
  v_mfma_f32_16x16x32_bf16 v[72:75], v[24:27], a[232:235], v[72:75]
  ds_read_b128 a[212:215], v2 offset:9472
  v_mfma_f32_16x16x32_bf16 v[76:79], v[24:27], a[236:239], v[76:79]
  v_exp_f32 v43, v43
  v_mfma_f32_16x16x32_bf16 v[80:83], v[24:27], a[240:243], v[80:83]
  ds_read_b128 a[216:219], v2 offset:9728
  v_cvt_pk_bf16_f32 v35, v42, v43
  v_mfma_f32_16x16x32_bf16 v[84:87], v[24:27], a[244:247], v[84:87]
  v_exp_f32 v36, v36
  v_mfma_f32_16x16x32_bf16 v[88:91], v[24:27], a[248:251], v[88:91]
  ds_read_b128 a[220:223], v2 offset:9984
  v_mfma_f32_16x16x32_bf16 v[92:95], v[24:27], a[252:255], v[92:95]
  v_exp_f32 v37, v37
  v_mfma_f32_16x16x32_bf16 v[52:55], v[28:31], v[8:11], v[52:55]
  v_cvt_pk_bf16_f32 v36, v36, v37
  v_mfma_f32_16x16x32_bf16 v[96:99], v[28:31], a[224:227], v[96:99]
  v_exp_f32 v38, v38
  v_mfma_f32_16x16x32_bf16 v[100:103], v[28:31], a[228:231], v[100:103]
  v_rcp_f32_dpp v17, v17 row_newbcast:0 row_mask:0xf bank_mask:0xf
  v_mfma_f32_16x16x32_bf16 v[104:107], v[28:31], a[232:235], v[104:107]
  v_exp_f32 v39, v39
  v_mfma_f32_16x16x32_bf16 v[108:111], v[28:31], a[236:239], v[108:111]
  v_cvt_pk_bf16_f32 v37, v38, v39
  v_mfma_f32_16x16x32_bf16 v[112:115], v[28:31], a[240:243], v[112:115]
  v_exp_f32 v44, v44
  v_mfma_f32_16x16x32_bf16 v[116:119], v[28:31], a[244:247], v[116:119]
  v_rcp_f32_dpp v18, v18 row_newbcast:0 row_mask:0xf bank_mask:0xf
  v_mfma_f32_16x16x32_bf16 v[120:123], v[28:31], a[248:251], v[120:123]
  s_waitcnt lgkmcnt(0)
  v_exp_f32 v45, v45
  v_mfma_f32_16x16x32_bf16 v[124:127], v[28:31], a[252:255], v[124:127]
  v_cvt_pk_bf16_f32 v38, v44, v45
  v_mfma_f32_16x16x32_bf16 v[24:27], a[192:195], a[128:131], -4.0
  v_exp_f32 v46, v46
  v_mfma_f32_16x16x32_bf16 v[24:27], a[196:199], a[132:135], v[24:27]
  v_rcp_f32_dpp v19, v19 row_newbcast:0 row_mask:0xf bank_mask:0xf
  v_mfma_f32_16x16x32_bf16 v[24:27], a[200:203], a[136:139], v[24:27]
  v_exp_f32 v47, v47
  v_mfma_f32_16x16x32_bf16 v[24:27], a[204:207], a[140:143], v[24:27]
  v_cvt_pk_bf16_f32 v39, v46, v47
  v_max3_u32 v6, v6, v16, v17
  v_mfma_f32_16x16x32_bf16 v[40:43], a[208:211], a[128:131], -4.0
  v_min3_u32 v7, v7, v16, v17
  v_max3_u32 v6, v6, v18, v19
  v_mfma_f32_16x16x32_bf16 v[40:43], a[212:215], a[132:135], v[40:43]
  v_min3_u32 v7, v7, v18, v19
  v_mul_f32 v224, v224, v16
  v_mfma_f32_16x16x32_bf16 v[40:43], a[216:219], a[136:139], v[40:43]
  s_cmp_ge_u32 s34, s36
  v_exp_f32 v24, v24
  v_mfma_f32_16x16x32_bf16 v[40:43], a[220:223], a[140:143], v[40:43]
  s_cselect_b32 s18, 0, s18
  v_mul_f32 v228, v228, v16
  v_mul_f32 v225, v225, v17
  v_mfma_f32_16x16x32_bf16 v[28:31], a[192:195], a[144:147], -4.0
  v_exp_f32 v25, v25
  v_mfma_f32_16x16x32_bf16 v[28:31], a[196:199], a[148:151], v[28:31]
  v_cvt_pk_bf16_f32 v24, v24, v25
  v_mul_f32 v229, v229, v17
  v_mfma_f32_16x16x32_bf16 v[28:31], a[200:203], a[152:155], v[28:31]
  v_exp_f32 v26, v26
  v_mfma_f32_16x16x32_bf16 v[28:31], a[204:207], a[156:159], v[28:31]
  buffer_load_dwordx4 v[208:211], v4, s[16:19], s34 offen offset:0
  v_mfma_f32_16x16x32_bf16 v[44:47], a[208:211], a[144:147], -4.0
  v_exp_f32 v27, v27
  v_mfma_f32_16x16x32_bf16 v[44:47], a[212:215], a[148:151], v[44:47]
  v_cvt_pk_bf16_f32 v25, v26, v27
  v_cvt_pk_bf16_f32 v224, v224, v228
  v_mfma_f32_16x16x32_bf16 v[44:47], a[216:219], a[152:155], v[44:47]
  v_exp_f32 v40, v40
  v_mfma_f32_16x16x32_bf16 v[44:47], a[220:223], a[156:159], v[44:47]
  buffer_load_dwordx4 v[212:215], v4, s[16:19], s34 offen offset:64
  v_mfma_f32_16x16x32_bf16 v[56:59], v[32:35], v[8:11], v[56:59]
  v_exp_f32 v41, v41
  v_mfma_f32_16x16x32_bf16 v[128:131], v[32:35], a[224:227], v[128:131]
  v_cvt_pk_bf16_f32 v26, v40, v41
  v_mul_f32 v232, v232, v16
  v_mfma_f32_16x16x32_bf16 v[132:135], v[32:35], a[228:231], v[132:135]
  v_exp_f32 v42, v42
  v_mfma_f32_16x16x32_bf16 v[136:139], v[32:35], a[232:235], v[136:139]
  buffer_load_dwordx4 v[216:219], v4, s[16:19], s34 offen offset:128
  v_mfma_f32_16x16x32_bf16 v[140:143], v[32:35], a[236:239], v[140:143]
  v_exp_f32 v43, v43
  v_mfma_f32_16x16x32_bf16 v[144:147], v[32:35], a[240:243], v[144:147]
  v_cvt_pk_bf16_f32 v27, v42, v43
  v_mul_f32 v236, v236, v16
  v_mfma_f32_16x16x32_bf16 v[148:151], v[32:35], a[244:247], v[148:151]
  v_exp_f32 v28, v28
  v_mfma_f32_16x16x32_bf16 v[152:155], v[32:35], a[248:251], v[152:155]
  buffer_load_dwordx4 v[220:223], v4, s[16:19], s34 offen offset:192
  v_mfma_f32_16x16x32_bf16 v[156:159], v[32:35], a[252:255], v[156:159]
  s_add_u32 s34, s34, 4096
  v_exp_f32 v29, v29
  v_mfma_f32_16x16x32_bf16 v[60:63], v[36:39], v[8:11], 0
  v_cvt_pk_bf16_f32 v28, v28, v29
  v_cvt_pk_bf16_f32 v228, v225, v229
  v_mfma_f32_16x16x32_bf16 v[160:163], v[36:39], a[224:227], 0
  v_exp_f32 v30, v30
  v_mfma_f32_16x16x32_bf16 v[164:167], v[36:39], a[228:231], 0
  ds_read_b128 a[224:227], v3 offset:8192
  v_mul_f32 v226, v226, v18
  v_mfma_f32_16x16x32_bf16 v[168:171], v[36:39], a[232:235], 0
  v_exp_f32 v31, v31
  v_mfma_f32_16x16x32_bf16 v[172:175], v[36:39], a[236:239], 0
  ds_read_b128 a[228:231], v3 offset:8448
  v_cvt_pk_bf16_f32 v29, v30, v31
  v_mfma_f32_16x16x32_bf16 v[176:179], v[36:39], a[240:243], 0
  v_exp_f32 v44, v44
  v_mfma_f32_16x16x32_bf16 v[180:183], v[36:39], a[244:247], 0
  ds_read_b128 a[232:235], v3 offset:8704
  v_mul_f32 v230, v230, v18
  v_mfma_f32_16x16x32_bf16 v[184:187], v[36:39], a[248:251], 0
  v_exp_f32 v45, v45
  v_mfma_f32_16x16x32_bf16 v[188:191], v[36:39], a[252:255], 0
  ds_read_b128 a[236:239], v3 offset:8960
  v_cvt_pk_bf16_f32 v30, v44, v45
  v_mfma_f32_16x16x32_bf16 v[32:35], a[192:195], a[160:163], -4.0
  v_exp_f32 v46, v46
  v_mfma_f32_16x16x32_bf16 v[32:35], a[196:199], a[164:167], v[32:35]
  ds_read_b128 a[240:243], v3 offset:9216
  v_cvt_pk_bf16_f32 v225, v232, v236
  v_mfma_f32_16x16x32_bf16 v[32:35], a[200:203], a[168:171], v[32:35]
  v_exp_f32 v47, v47
  v_mfma_f32_16x16x32_bf16 v[32:35], a[204:207], a[172:175], v[32:35]
  ds_read_b128 a[244:247], v3 offset:9472
  v_cvt_pk_bf16_f32 v31, v46, v47
  v_mfma_f32_16x16x32_bf16 v[40:43], a[208:211], a[160:163], -4.0
  v_mul_f32 v227, v227, v19
  v_mul_f32 v231, v231, v19
  v_mfma_f32_16x16x32_bf16 v[40:43], a[212:215], a[164:167], v[40:43]
  ds_read_b128 a[248:251], v3 offset:9728
  v_cvt_pk_bf16_f32 v232, v226, v230
  v_mfma_f32_16x16x32_bf16 v[40:43], a[216:219], a[168:171], v[40:43]
  v_exp_f32 v32, v32
  v_mfma_f32_16x16x32_bf16 v[40:43], a[220:223], a[172:175], v[40:43]
  ds_read_b128 a[252:255], v3 offset:9984
  v_mul_f32 v233, v233, v17
  v_mfma_f32_16x16x32_bf16 v[36:39], a[192:195], a[176:179], -4.0
  v_exp_f32 v33, v33
  v_mfma_f32_16x16x32_bf16 v[36:39], a[196:199], a[180:183], v[36:39]
  ds_read_b128 a[192:195], v2 offset:16384
  v_cvt_pk_bf16_f32 v32, v32, v33
  v_mfma_f32_16x16x32_bf16 v[36:39], a[200:203], a[184:187], v[36:39]
  v_exp_f32 v34, v34
  v_mfma_f32_16x16x32_bf16 v[36:39], a[204:207], a[188:191], v[36:39]
  ds_read_b128 a[196:199], v2 offset:16640
  v_mul_f32 v237, v237, v17
  v_mfma_f32_16x16x32_bf16 v[44:47], a[208:211], a[176:179], -4.0
  v_exp_f32 v35, v35
  v_mfma_f32_16x16x32_bf16 v[44:47], a[212:215], a[180:183], v[44:47]
  ds_read_b128 a[200:203], v2 offset:16896
  v_cvt_pk_bf16_f32 v33, v34, v35
  v_mfma_f32_16x16x32_bf16 v[44:47], a[216:219], a[184:187], v[44:47]
  s_waitcnt lgkmcnt(3)
  v_exp_f32 v40, v40
  v_mfma_f32_16x16x32_bf16 v[44:47], a[220:223], a[188:191], v[44:47]
  ds_read_b128 a[204:207], v2 offset:17152
  v_cvt_pk_bf16_f32 v236, v227, v231
  v_mfma_f32_16x16x32_bf16 v[48:51], v[24:27], v[8:11], v[48:51]
  v_exp_f32 v41, v41
  v_mfma_f32_16x16x32_bf16 v[64:67], v[24:27], a[224:227], v[64:67]
  ds_read_b128 a[208:211], v2 offset:17408
  v_cvt_pk_bf16_f32 v34, v40, v41
  v_mfma_f32_16x16x32_bf16 v[68:71], v[24:27], a[228:231], v[68:71]
  v_exp_f32 v42, v42
  v_mfma_f32_16x16x32_bf16 v[72:75], v[24:27], a[232:235], v[72:75]
  ds_read_b128 a[212:215], v2 offset:17664
  v_mul_f32 v234, v234, v18
  v_mfma_f32_16x16x32_bf16 v[76:79], v[24:27], a[236:239], v[76:79]
  v_exp_f32 v43, v43
  v_mfma_f32_16x16x32_bf16 v[80:83], v[24:27], a[240:243], v[80:83]
  ds_read_b128 a[216:219], v2 offset:17920
  v_cvt_pk_bf16_f32 v35, v42, v43
  v_mfma_f32_16x16x32_bf16 v[84:87], v[24:27], a[244:247], v[84:87]
  v_exp_f32 v36, v36
  v_mfma_f32_16x16x32_bf16 v[88:91], v[24:27], a[248:251], v[88:91]
  ds_read_b128 a[220:223], v2 offset:18176
  v_mul_f32 v238, v238, v18
  v_mfma_f32_16x16x32_bf16 v[92:95], v[24:27], a[252:255], v[92:95]
  v_exp_f32 v37, v37
  v_mfma_f32_16x16x32_bf16 v[52:55], v[28:31], v[8:11], v[52:55]
  v_cvt_pk_bf16_f32 v36, v36, v37
  v_cvt_pk_bf16_f32 v229, v233, v237
  v_mfma_f32_16x16x32_bf16 v[96:99], v[28:31], a[224:227], v[96:99]
  v_exp_f32 v38, v38
  v_mfma_f32_16x16x32_bf16 v[100:103], v[28:31], a[228:231], v[100:103]
  v_mul_f32 v235, v235, v19
  v_mul_f32 v239, v239, v19
  v_mfma_f32_16x16x32_bf16 v[104:107], v[28:31], a[232:235], v[104:107]
  v_exp_f32 v39, v39
  v_mfma_f32_16x16x32_bf16 v[108:111], v[28:31], a[236:239], v[108:111]
  v_cvt_pk_bf16_f32 v37, v38, v39
  v_cvt_pk_bf16_f32 v233, v234, v238
  v_mfma_f32_16x16x32_bf16 v[112:115], v[28:31], a[240:243], v[112:115]
  v_exp_f32 v44, v44
  v_mfma_f32_16x16x32_bf16 v[116:119], v[28:31], a[244:247], v[116:119]
  v_mul_f32 v240, v240, v16
  v_mul_f32 v244, v244, v16
  v_mfma_f32_16x16x32_bf16 v[120:123], v[28:31], a[248:251], v[120:123]
  s_waitcnt lgkmcnt(0)
  v_exp_f32 v45, v45
  v_mfma_f32_16x16x32_bf16 v[124:127], v[28:31], a[252:255], v[124:127]
  v_cvt_pk_bf16_f32 v38, v44, v45
  v_cvt_pk_bf16_f32 v237, v235, v239
  v_mfma_f32_16x16x32_bf16 v[24:27], a[192:195], a[128:131], -4.0
  v_exp_f32 v46, v46
  v_mfma_f32_16x16x32_bf16 v[24:27], a[196:199], a[132:135], v[24:27]
  v_mul_f32 v248, v248, v16
  v_mul_f32 v252, v252, v16
  v_mfma_f32_16x16x32_bf16 v[24:27], a[200:203], a[136:139], v[24:27]
  v_exp_f32 v47, v47
  v_mfma_f32_16x16x32_bf16 v[24:27], a[204:207], a[140:143], v[24:27]
  v_cvt_pk_bf16_f32 v39, v46, v47
  v_cvt_pk_bf16_f32 v226, v240, v244
  v_mfma_f32_16x16x32_bf16 v[40:43], a[208:211], a[128:131], -4.0
  v_mul_f32 v241, v241, v17
  v_mul_f32 v245, v245, v17
  v_mfma_f32_16x16x32_bf16 v[40:43], a[212:215], a[132:135], v[40:43]
  v_cvt_pk_bf16_f32 v227, v248, v252
  v_mfma_f32_16x16x32_bf16 v[40:43], a[216:219], a[136:139], v[40:43]
  v_exp_f32 v24, v24
  v_mfma_f32_16x16x32_bf16 v[40:43], a[220:223], a[140:143], v[40:43]
  buffer_store_dwordx4 v[224:227], v5, s[28:31], s35 offen offset:0 nt
  v_mfma_f32_16x16x32_bf16 v[28:31], a[192:195], a[144:147], -4.0
  v_exp_f32 v25, v25
  v_mfma_f32_16x16x32_bf16 v[28:31], a[196:199], a[148:151], v[28:31]
  v_cvt_pk_bf16_f32 v24, v24, v25
  v_mul_f32 v249, v249, v17
  v_mfma_f32_16x16x32_bf16 v[28:31], a[200:203], a[152:155], v[28:31]
  v_exp_f32 v26, v26
  v_mfma_f32_16x16x32_bf16 v[28:31], a[204:207], a[156:159], v[28:31]
  v_mul_f32 v253, v253, v17
  v_cvt_pk_bf16_f32 v230, v241, v245
  v_mfma_f32_16x16x32_bf16 v[44:47], a[208:211], a[144:147], -4.0
  v_exp_f32 v27, v27
  v_mfma_f32_16x16x32_bf16 v[44:47], a[212:215], a[148:151], v[44:47]
  v_cvt_pk_bf16_f32 v25, v26, v27
  v_mul_f32 v242, v242, v18
  v_mfma_f32_16x16x32_bf16 v[44:47], a[216:219], a[152:155], v[44:47]
  v_exp_f32 v40, v40
  v_mfma_f32_16x16x32_bf16 v[44:47], a[220:223], a[156:159], v[44:47]
  v_mul_f32 v246, v246, v18
  v_cvt_pk_bf16_f32 v231, v249, v253
  v_mfma_f32_16x16x32_bf16 v[56:59], v[32:35], v[8:11], v[56:59]
  v_exp_f32 v41, v41
  v_mfma_f32_16x16x32_bf16 v[128:131], v[32:35], a[224:227], v[128:131]
  v_cvt_pk_bf16_f32 v26, v40, v41
  v_mfma_f32_16x16x32_bf16 v[132:135], v[32:35], a[228:231], v[132:135]
  v_exp_f32 v42, v42
  v_mfma_f32_16x16x32_bf16 v[136:139], v[32:35], a[232:235], v[136:139]
  buffer_store_dwordx4 v[228:231], v5, s[28:31], s35 offen offset:256 nt
  v_mfma_f32_16x16x32_bf16 v[140:143], v[32:35], a[236:239], v[140:143]
  v_exp_f32 v43, v43
  v_mfma_f32_16x16x32_bf16 v[144:147], v[32:35], a[240:243], v[144:147]
  v_cvt_pk_bf16_f32 v27, v42, v43
  v_mul_f32 v250, v250, v18
  v_mfma_f32_16x16x32_bf16 v[148:151], v[32:35], a[244:247], v[148:151]
  v_exp_f32 v28, v28
  v_mfma_f32_16x16x32_bf16 v[152:155], v[32:35], a[248:251], v[152:155]
  v_mul_f32 v254, v254, v18
  v_cvt_pk_bf16_f32 v234, v242, v246
  v_mfma_f32_16x16x32_bf16 v[156:159], v[32:35], a[252:255], v[156:159]
  v_exp_f32 v29, v29
  v_mfma_f32_16x16x32_bf16 v[60:63], v[36:39], v[8:11], v[60:63]
  v_cvt_pk_bf16_f32 v28, v28, v29
  v_mul_f32 v243, v243, v19
  v_mfma_f32_16x16x32_bf16 v[160:163], v[36:39], a[224:227], v[160:163]
  v_exp_f32 v30, v30
  v_mfma_f32_16x16x32_bf16 v[164:167], v[36:39], a[228:231], v[164:167]
  ds_read_b128 a[224:227], v3 offset:16384
  v_mul_f32 v247, v247, v19
  v_mfma_f32_16x16x32_bf16 v[168:171], v[36:39], a[232:235], v[168:171]
  v_exp_f32 v31, v31
  v_mfma_f32_16x16x32_bf16 v[172:175], v[36:39], a[236:239], v[172:175]
  ds_read_b128 a[228:231], v3 offset:16640
  v_cvt_pk_bf16_f32 v29, v30, v31
  v_mfma_f32_16x16x32_bf16 v[176:179], v[36:39], a[240:243], v[176:179]
  v_exp_f32 v44, v44
  v_mfma_f32_16x16x32_bf16 v[180:183], v[36:39], a[244:247], v[180:183]
  ds_read_b128 a[232:235], v3 offset:16896
  v_cvt_pk_bf16_f32 v235, v250, v254
  v_mfma_f32_16x16x32_bf16 v[184:187], v[36:39], a[248:251], v[184:187]
  v_exp_f32 v45, v45
  v_mfma_f32_16x16x32_bf16 v[188:191], v[36:39], a[252:255], v[188:191]
  ds_read_b128 a[236:239], v3 offset:17152
  v_cvt_pk_bf16_f32 v30, v44, v45
  v_mfma_f32_16x16x32_bf16 v[32:35], a[192:195], a[160:163], -4.0
  v_exp_f32 v46, v46
  v_mfma_f32_16x16x32_bf16 v[32:35], a[196:199], a[164:167], v[32:35]
  ds_read_b128 a[240:243], v3 offset:17408
  v_mfma_f32_16x16x32_bf16 v[32:35], a[200:203], a[168:171], v[32:35]
  v_exp_f32 v47, v47
  v_mfma_f32_16x16x32_bf16 v[32:35], a[204:207], a[172:175], v[32:35]
  ds_read_b128 a[244:247], v3 offset:17664
  v_cvt_pk_bf16_f32 v31, v46, v47
  v_mfma_f32_16x16x32_bf16 v[40:43], a[208:211], a[160:163], -4.0
  buffer_store_dwordx4 v[232:235], v5, s[28:31], s35 offen offset:512 nt
  v_mfma_f32_16x16x32_bf16 v[40:43], a[212:215], a[164:167], v[40:43]
  ds_read_b128 a[248:251], v3 offset:17920
  v_mul_f32 v251, v251, v19
  v_mfma_f32_16x16x32_bf16 v[40:43], a[216:219], a[168:171], v[40:43]
  v_exp_f32 v32, v32
  v_mfma_f32_16x16x32_bf16 v[40:43], a[220:223], a[172:175], v[40:43]
  ds_read_b128 a[252:255], v3 offset:18176
  v_mul_f32 v255, v255, v19
  v_mfma_f32_16x16x32_bf16 v[36:39], a[192:195], a[176:179], -4.0
  v_exp_f32 v33, v33
  v_mfma_f32_16x16x32_bf16 v[36:39], a[196:199], a[180:183], v[36:39]
  ds_read_b128 a[192:195], v2 offset:24576
  v_cvt_pk_bf16_f32 v32, v32, v33
  v_mfma_f32_16x16x32_bf16 v[36:39], a[200:203], a[184:187], v[36:39]
  v_exp_f32 v34, v34
  v_mfma_f32_16x16x32_bf16 v[36:39], a[204:207], a[188:191], v[36:39]
  ds_read_b128 a[196:199], v2 offset:24832
  v_cvt_pk_bf16_f32 v238, v243, v247
  v_mfma_f32_16x16x32_bf16 v[44:47], a[208:211], a[176:179], -4.0
  v_exp_f32 v35, v35
  v_mfma_f32_16x16x32_bf16 v[44:47], a[212:215], a[180:183], v[44:47]
  ds_read_b128 a[200:203], v2 offset:25088
  v_cvt_pk_bf16_f32 v33, v34, v35
  v_mfma_f32_16x16x32_bf16 v[44:47], a[216:219], a[184:187], v[44:47]
  s_waitcnt lgkmcnt(3)
  v_exp_f32 v40, v40
  v_mfma_f32_16x16x32_bf16 v[44:47], a[220:223], a[188:191], v[44:47]
  ds_read_b128 a[204:207], v2 offset:25344
  v_cvt_pk_bf16_f32 v239, v251, v255
  v_mfma_f32_16x16x32_bf16 v[48:51], v[24:27], v[8:11], v[48:51]
  v_exp_f32 v41, v41
  v_mfma_f32_16x16x32_bf16 v[64:67], v[24:27], a[224:227], v[64:67]
  ds_read_b128 a[208:211], v2 offset:25600
  v_cvt_pk_bf16_f32 v34, v40, v41
  v_mfma_f32_16x16x32_bf16 v[68:71], v[24:27], a[228:231], v[68:71]
  v_exp_f32 v42, v42
  v_mfma_f32_16x16x32_bf16 v[72:75], v[24:27], a[232:235], v[72:75]
  ds_read_b128 a[212:215], v2 offset:25856
  v_mfma_f32_16x16x32_bf16 v[76:79], v[24:27], a[236:239], v[76:79]
  v_exp_f32 v43, v43
  v_mfma_f32_16x16x32_bf16 v[80:83], v[24:27], a[240:243], v[80:83]
  ds_read_b128 a[216:219], v2 offset:26112
  v_cvt_pk_bf16_f32 v35, v42, v43
  v_mfma_f32_16x16x32_bf16 v[84:87], v[24:27], a[244:247], v[84:87]
  v_exp_f32 v36, v36
  v_mfma_f32_16x16x32_bf16 v[88:91], v[24:27], a[248:251], v[88:91]
  ds_read_b128 a[220:223], v2 offset:26368
  v_mfma_f32_16x16x32_bf16 v[92:95], v[24:27], a[252:255], v[92:95]
  v_exp_f32 v37, v37
  v_mfma_f32_16x16x32_bf16 v[52:55], v[28:31], v[8:11], v[52:55]
  v_cvt_pk_bf16_f32 v36, v36, v37
  v_mfma_f32_16x16x32_bf16 v[96:99], v[28:31], a[224:227], v[96:99]
  v_exp_f32 v38, v38
  v_mfma_f32_16x16x32_bf16 v[100:103], v[28:31], a[228:231], v[100:103]
  buffer_store_dwordx4 v[236:239], v5, s[28:31], s35 offen offset:768 nt
  v_mfma_f32_16x16x32_bf16 v[104:107], v[28:31], a[232:235], v[104:107]
  s_add_u32 s35, s35, 4096
  v_exp_f32 v39, v39
  v_mfma_f32_16x16x32_bf16 v[108:111], v[28:31], a[236:239], v[108:111]
  v_cvt_pk_bf16_f32 v37, v38, v39
  v_mfma_f32_16x16x32_bf16 v[112:115], v[28:31], a[240:243], v[112:115]
  v_exp_f32 v44, v44
  v_mfma_f32_16x16x32_bf16 v[116:119], v[28:31], a[244:247], v[116:119]
  v_mfma_f32_16x16x32_bf16 v[120:123], v[28:31], a[248:251], v[120:123]
  s_waitcnt lgkmcnt(0)
  v_exp_f32 v45, v45
  v_mfma_f32_16x16x32_bf16 v[124:127], v[28:31], a[252:255], v[124:127]
  v_cvt_pk_bf16_f32 v38, v44, v45
  v_mfma_f32_16x16x32_bf16 v[24:27], a[192:195], a[128:131], -4.0
  v_exp_f32 v46, v46
  v_mfma_f32_16x16x32_bf16 v[24:27], a[196:199], a[132:135], v[24:27]
  v_mfma_f32_16x16x32_bf16 v[24:27], a[200:203], a[136:139], v[24:27]
  v_exp_f32 v47, v47
  v_mfma_f32_16x16x32_bf16 v[24:27], a[204:207], a[140:143], v[24:27]
  s_waitcnt vmcnt(9)
  v_cvt_pk_bf16_f32 v39, v46, v47
  v_mfma_f32_16x16x32_bf16 v[40:43], a[208:211], a[128:131], -4.0
  v_accvgpr_write_b32 a128, v192
  v_accvgpr_write_b32 a129, v193
  v_mfma_f32_16x16x32_bf16 v[40:43], a[212:215], a[132:135], v[40:43]
  v_accvgpr_write_b32 a130, v194
  v_accvgpr_write_b32 a131, v195
  v_mfma_f32_16x16x32_bf16 v[40:43], a[216:219], a[136:139], v[40:43]
  v_exp_f32 v24, v24
  v_mfma_f32_16x16x32_bf16 v[40:43], a[220:223], a[140:143], v[40:43]
  v_accvgpr_write_b32 a132, v196
  v_accvgpr_write_b32 a133, v197
  v_mfma_f32_16x16x32_bf16 v[28:31], a[192:195], a[144:147], -4.0
  v_exp_f32 v25, v25
  v_mfma_f32_16x16x32_bf16 v[28:31], a[196:199], a[148:151], v[28:31]
  v_cvt_pk_bf16_f32 v24, v24, v25
  v_accvgpr_write_b32 a134, v198
  v_mfma_f32_16x16x32_bf16 v[28:31], a[200:203], a[152:155], v[28:31]
  v_exp_f32 v26, v26
  v_mfma_f32_16x16x32_bf16 v[28:31], a[204:207], a[156:159], v[28:31]
  v_accvgpr_write_b32 a135, v199
  v_accvgpr_write_b32 a136, v200
  v_mfma_f32_16x16x32_bf16 v[44:47], a[208:211], a[144:147], -4.0
  v_exp_f32 v27, v27
  v_mfma_f32_16x16x32_bf16 v[44:47], a[212:215], a[148:151], v[44:47]
  v_cvt_pk_bf16_f32 v25, v26, v27
  v_accvgpr_write_b32 a137, v201
  v_mfma_f32_16x16x32_bf16 v[44:47], a[216:219], a[152:155], v[44:47]
  v_exp_f32 v40, v40
  v_mfma_f32_16x16x32_bf16 v[44:47], a[220:223], a[156:159], v[44:47]
  v_accvgpr_write_b32 a138, v202
  v_accvgpr_write_b32 a139, v203
  v_mfma_f32_16x16x32_bf16 v[56:59], v[32:35], v[8:11], v[56:59]
  v_exp_f32 v41, v41
  v_mfma_f32_16x16x32_bf16 v[128:131], v[32:35], a[224:227], v[128:131]
  v_cvt_pk_bf16_f32 v26, v40, v41
  v_accvgpr_write_b32 a140, v204
  v_mfma_f32_16x16x32_bf16 v[132:135], v[32:35], a[228:231], v[132:135]
  v_exp_f32 v42, v42
  v_mfma_f32_16x16x32_bf16 v[136:139], v[32:35], a[232:235], v[136:139]
  v_accvgpr_write_b32 a141, v205
  v_accvgpr_write_b32 a142, v206
  v_mfma_f32_16x16x32_bf16 v[140:143], v[32:35], a[236:239], v[140:143]
  v_exp_f32 v43, v43
  v_mfma_f32_16x16x32_bf16 v[144:147], v[32:35], a[240:243], v[144:147]
  v_cvt_pk_bf16_f32 v27, v42, v43
  v_accvgpr_write_b32 a143, v207
  v_mfma_f32_16x16x32_bf16 v[148:151], v[32:35], a[244:247], v[148:151]
  v_exp_f32 v28, v28
  v_mfma_f32_16x16x32_bf16 v[152:155], v[32:35], a[248:251], v[152:155]
  v_mfma_f32_16x16x32_bf16 v[156:159], v[32:35], a[252:255], v[156:159]
  v_exp_f32 v29, v29
  v_mfma_f32_16x16x32_bf16 v[60:63], v[36:39], v[8:11], v[60:63]
  v_cvt_pk_bf16_f32 v28, v28, v29
  v_mfma_f32_16x16x32_bf16 v[160:163], v[36:39], a[224:227], v[160:163]
  v_exp_f32 v30, v30
  v_mfma_f32_16x16x32_bf16 v[164:167], v[36:39], a[228:231], v[164:167]
  ds_read_b128 a[224:227], v3 offset:24576
  v_mfma_f32_16x16x32_bf16 v[168:171], v[36:39], a[232:235], v[168:171]
  v_exp_f32 v31, v31
  v_mfma_f32_16x16x32_bf16 v[172:175], v[36:39], a[236:239], v[172:175]
  ds_read_b128 a[228:231], v3 offset:24832
  v_cvt_pk_bf16_f32 v29, v30, v31
  v_mfma_f32_16x16x32_bf16 v[176:179], v[36:39], a[240:243], v[176:179]
  v_exp_f32 v44, v44
  v_mfma_f32_16x16x32_bf16 v[180:183], v[36:39], a[244:247], v[180:183]
  ds_read_b128 a[232:235], v3 offset:25088
  v_mfma_f32_16x16x32_bf16 v[184:187], v[36:39], a[248:251], v[184:187]
  v_exp_f32 v45, v45
  v_mfma_f32_16x16x32_bf16 v[188:191], v[36:39], a[252:255], v[188:191]
  ds_read_b128 a[236:239], v3 offset:25344
  v_cvt_pk_bf16_f32 v30, v44, v45
  v_mfma_f32_16x16x32_bf16 v[32:35], a[192:195], a[160:163], -4.0
  v_exp_f32 v46, v46
  v_mfma_f32_16x16x32_bf16 v[32:35], a[196:199], a[164:167], v[32:35]
  ds_read_b128 a[240:243], v3 offset:25600
  v_mfma_f32_16x16x32_bf16 v[32:35], a[200:203], a[168:171], v[32:35]
  v_exp_f32 v47, v47
  v_mfma_f32_16x16x32_bf16 v[32:35], a[204:207], a[172:175], v[32:35]
  ds_read_b128 a[244:247], v3 offset:25856
  v_cvt_pk_bf16_f32 v31, v46, v47
  v_mfma_f32_16x16x32_bf16 v[40:43], a[208:211], a[160:163], -4.0
  v_mfma_f32_16x16x32_bf16 v[40:43], a[212:215], a[164:167], v[40:43]
  ds_read_b128 a[248:251], v3 offset:26112
  v_mfma_f32_16x16x32_bf16 v[40:43], a[216:219], a[168:171], v[40:43]
  v_exp_f32 v32, v32
  v_mfma_f32_16x16x32_bf16 v[40:43], a[220:223], a[172:175], v[40:43]
  ds_read_b128 a[252:255], v3 offset:26368
  v_mfma_f32_16x16x32_bf16 v[36:39], a[192:195], a[176:179], -4.0
  v_exp_f32 v33, v33
  v_mfma_f32_16x16x32_bf16 v[36:39], a[196:199], a[180:183], v[36:39]
  ds_read_b128 a[192:195], v1 offset:0
  v_cvt_pk_bf16_f32 v32, v32, v33
  v_mfma_f32_16x16x32_bf16 v[36:39], a[200:203], a[184:187], v[36:39]
  v_exp_f32 v34, v34
  v_mfma_f32_16x16x32_bf16 v[36:39], a[204:207], a[188:191], v[36:39]
  ds_read_b128 a[196:199], v1 offset:256
  v_mfma_f32_16x16x32_bf16 v[44:47], a[208:211], a[176:179], -4.0
  v_exp_f32 v35, v35
  v_mfma_f32_16x16x32_bf16 v[44:47], a[212:215], a[180:183], v[44:47]
  ds_read_b128 a[200:203], v1 offset:512
  v_cvt_pk_bf16_f32 v33, v34, v35
  v_mfma_f32_16x16x32_bf16 v[44:47], a[216:219], a[184:187], v[44:47]
  s_waitcnt lgkmcnt(3)
  v_exp_f32 v40, v40
  v_mfma_f32_16x16x32_bf16 v[44:47], a[220:223], a[188:191], v[44:47]
  ds_read_b128 a[204:207], v1 offset:768
  v_mfma_f32_16x16x32_bf16 v[16:19], v[24:27], v[8:11], v[48:51]
  v_exp_f32 v41, v41
  v_mfma_f32_16x16x32_bf16 v[224:227], v[24:27], a[224:227], v[64:67]
  ds_read_b128 a[208:211], v1 offset:1024
  v_cvt_pk_bf16_f32 v34, v40, v41
  v_mfma_f32_16x16x32_bf16 v[228:231], v[24:27], a[228:231], v[68:71]
  v_exp_f32 v42, v42
  v_mfma_f32_16x16x32_bf16 v[232:235], v[24:27], a[232:235], v[72:75]
  ds_read_b128 a[212:215], v1 offset:1280
  v_mfma_f32_16x16x32_bf16 v[236:239], v[24:27], a[236:239], v[76:79]
  v_exp_f32 v43, v43
  v_mfma_f32_16x16x32_bf16 v[240:243], v[24:27], a[240:243], v[80:83]
  ds_read_b128 a[216:219], v1 offset:1536
  v_cvt_pk_bf16_f32 v35, v42, v43
  v_mfma_f32_16x16x32_bf16 v[244:247], v[24:27], a[244:247], v[84:87]
  v_exp_f32 v36, v36
  v_mfma_f32_16x16x32_bf16 v[248:251], v[24:27], a[248:251], v[88:91]
  ds_read_b128 a[220:223], v1 offset:1792
  v_mfma_f32_16x16x32_bf16 v[252:255], v[24:27], a[252:255], v[92:95]
  s_cmp_ge_u32 s34, s36
  v_exp_f32 v37, v37
  v_mfma_f32_16x16x32_bf16 v[52:55], v[28:31], v[8:11], v[52:55]
  s_cselect_b32 s18, 0, s18
  v_cvt_pk_bf16_f32 v36, v36, v37
  v_mfma_f32_16x16x32_bf16 v[96:99], v[28:31], a[224:227], v[96:99]
  v_exp_f32 v38, v38
  v_mfma_f32_16x16x32_bf16 v[100:103], v[28:31], a[228:231], v[100:103]
  buffer_load_dwordx4 v[192:195], v4, s[16:19], s34 offen offset:0
  v_mfma_f32_16x16x32_bf16 v[104:107], v[28:31], a[232:235], v[104:107]
  v_exp_f32 v39, v39
  v_mfma_f32_16x16x32_bf16 v[108:111], v[28:31], a[236:239], v[108:111]
  v_cvt_pk_bf16_f32 v37, v38, v39
  v_mfma_f32_16x16x32_bf16 v[112:115], v[28:31], a[240:243], v[112:115]
  v_exp_f32 v44, v44
  v_mfma_f32_16x16x32_bf16 v[116:119], v[28:31], a[244:247], v[116:119]
  buffer_load_dwordx4 v[196:199], v4, s[16:19], s34 offen offset:64
  v_mfma_f32_16x16x32_bf16 v[120:123], v[28:31], a[248:251], v[120:123]
  s_waitcnt lgkmcnt(0)
  v_exp_f32 v45, v45
  v_mfma_f32_16x16x32_bf16 v[124:127], v[28:31], a[252:255], v[124:127]
  v_cvt_pk_bf16_f32 v38, v44, v45
  s_add_u32 s37, s37, 1
  s_cmp_le_u32 s37, 5
  s_cbranch_scc1 L_loop
L_tail:
  v_mfma_f32_16x16x32_bf16 v[28:31], a[192:195], a[144:147], -4.0
  v_exp_f32 v46, v46
  v_mfma_f32_16x16x32_bf16 v[28:31], a[196:199], a[148:151], v[28:31]
  v_exp_f32 v47, v47
  v_mfma_f32_16x16x32_bf16 v[28:31], a[200:203], a[152:155], v[28:31]
  v_cvt_pk_bf16_f32 v39, v46, v47
  v_mfma_f32_16x16x32_bf16 v[28:31], a[204:207], a[156:159], v[28:31]
  v_rcp_f32_dpp v16, v16 row_newbcast:0 row_mask:0xf bank_mask:0xf
  v_mfma_f32_16x16x32_bf16 v[44:47], a[208:211], a[144:147], -4.0
  v_rcp_f32_dpp v17, v17 row_newbcast:0 row_mask:0xf bank_mask:0xf
  v_mfma_f32_16x16x32_bf16 v[44:47], a[212:215], a[148:151], v[44:47]
  v_rcp_f32_dpp v18, v18 row_newbcast:0 row_mask:0xf bank_mask:0xf
  v_mfma_f32_16x16x32_bf16 v[44:47], a[216:219], a[152:155], v[44:47]
  v_exp_f32 v28, v28
  v_mfma_f32_16x16x32_bf16 v[44:47], a[220:223], a[156:159], v[44:47]
  v_exp_f32 v29, v29
  v_mfma_f32_16x16x32_bf16 v[56:59], v[32:35], v[8:11], v[56:59]
  v_exp_f32 v30, v30
  v_mfma_f32_16x16x32_bf16 v[128:131], v[32:35], a[224:227], v[128:131]
  v_exp_f32 v31, v31
  v_mfma_f32_16x16x32_bf16 v[132:135], v[32:35], a[228:231], v[132:135]
  v_exp_f32 v44, v44
  v_mfma_f32_16x16x32_bf16 v[136:139], v[32:35], a[232:235], v[136:139]
  v_exp_f32 v45, v45
  v_mfma_f32_16x16x32_bf16 v[140:143], v[32:35], a[236:239], v[140:143]
  v_exp_f32 v46, v46
  v_mfma_f32_16x16x32_bf16 v[144:147], v[32:35], a[240:243], v[144:147]
  v_exp_f32 v47, v47
  v_mfma_f32_16x16x32_bf16 v[148:151], v[32:35], a[244:247], v[148:151]
  v_cvt_pk_bf16_f32 v28, v28, v29
  v_cvt_pk_bf16_f32 v29, v30, v31
  v_mfma_f32_16x16x32_bf16 v[152:155], v[32:35], a[248:251], v[152:155]
  v_cvt_pk_bf16_f32 v30, v44, v45
  v_cvt_pk_bf16_f32 v31, v46, v47
  v_mfma_f32_16x16x32_bf16 v[156:159], v[32:35], a[252:255], v[156:159]
  v_rcp_f32_dpp v19, v19 row_newbcast:0 row_mask:0xf bank_mask:0xf
  v_mfma_f32_16x16x32_bf16 v[60:63], v[36:39], v[8:11], v[60:63]
  v_mul_f32 v224, v224, v16
  v_mul_f32 v228, v228, v16
  v_mfma_f32_16x16x32_bf16 v[160:163], v[36:39], a[224:227], v[160:163]
  v_mul_f32 v225, v225, v17
  v_mul_f32 v229, v229, v17
  v_mfma_f32_16x16x32_bf16 v[164:167], v[36:39], a[228:231], v[164:167]
  v_cvt_pk_bf16_f32 v224, v224, v228
  v_mul_f32 v232, v232, v16
  v_mfma_f32_16x16x32_bf16 v[168:171], v[36:39], a[232:235], v[168:171]
  v_mul_f32 v236, v236, v16
  v_cvt_pk_bf16_f32 v228, v225, v229
  v_mfma_f32_16x16x32_bf16 v[172:175], v[36:39], a[236:239], v[172:175]
  v_mul_f32 v226, v226, v18
  v_mul_f32 v230, v230, v18
  v_mfma_f32_16x16x32_bf16 v[176:179], v[36:39], a[240:243], v[176:179]
  v_cvt_pk_bf16_f32 v225, v232, v236
  v_mul_f32 v227, v227, v19
  v_mfma_f32_16x16x32_bf16 v[180:183], v[36:39], a[244:247], v[180:183]
  v_mul_f32 v231, v231, v19
  v_cvt_pk_bf16_f32 v232, v226, v230
  v_mfma_f32_16x16x32_bf16 v[184:187], v[36:39], a[248:251], v[184:187]
  v_cvt_pk_bf16_f32 v236, v227, v231
  v_mul_f32 v240, v240, v16
  v_mfma_f32_16x16x32_bf16 v[188:191], v[36:39], a[252:255], v[188:191]
  v_mul_f32 v244, v244, v16
  v_mul_f32 v248, v248, v16
  v_mfma_f32_16x16x32_bf16 v[32:35], a[192:195], a[160:163], -4.0
  v_mul_f32 v252, v252, v16
  v_cvt_pk_bf16_f32 v226, v240, v244
  v_mfma_f32_16x16x32_bf16 v[32:35], a[196:199], a[164:167], v[32:35]
  v_cvt_pk_bf16_f32 v227, v248, v252
  v_max3_u32 v6, v6, v16, v17
  v_mfma_f32_16x16x32_bf16 v[32:35], a[200:203], a[168:171], v[32:35]
  v_min3_u32 v7, v7, v16, v17
  v_max3_u32 v6, v6, v18, v19
  v_mfma_f32_16x16x32_bf16 v[32:35], a[204:207], a[172:175], v[32:35]
  buffer_store_dwordx4 v[224:227], v5, s[28:31], s35 offen offset:0 nt
  v_mfma_f32_16x16x32_bf16 v[40:43], a[208:211], a[160:163], -4.0
  v_min3_u32 v7, v7, v18, v19
  v_mul_f32 v233, v233, v17
  v_mfma_f32_16x16x32_bf16 v[40:43], a[212:215], a[164:167], v[40:43]
  s_nop 0
  v_exp_f32 v32, v32
  v_mfma_f32_16x16x32_bf16 v[40:43], a[216:219], a[168:171], v[40:43]
  v_exp_f32 v33, v33
  v_mfma_f32_16x16x32_bf16 v[40:43], a[220:223], a[172:175], v[40:43]
  v_exp_f32 v34, v34
  v_mfma_f32_16x16x32_bf16 v[36:39], a[192:195], a[176:179], -4.0
  ds_read_b128 a[192:195], v1 offset:8192
  v_cvt_pk_bf16_f32 v32, v32, v33
  v_mfma_f32_16x16x32_bf16 v[36:39], a[196:199], a[180:183], v[36:39]
  ds_read_b128 a[196:199], v1 offset:8448
  v_mul_f32 v237, v237, v17
  v_mfma_f32_16x16x32_bf16 v[36:39], a[200:203], a[184:187], v[36:39]
  ds_read_b128 a[200:203], v1 offset:8704
  v_mul_f32 v234, v234, v18
  v_mfma_f32_16x16x32_bf16 v[36:39], a[204:207], a[188:191], v[36:39]
  ds_read_b128 a[204:207], v1 offset:8960
  v_mul_f32 v238, v238, v18
  v_mfma_f32_16x16x32_bf16 v[44:47], a[208:211], a[176:179], -4.0
  ds_read_b128 a[208:211], v1 offset:9216
  v_mul_f32 v235, v235, v19
  v_mfma_f32_16x16x32_bf16 v[44:47], a[212:215], a[180:183], v[44:47]
  ds_read_b128 a[212:215], v1 offset:9472
  v_mul_f32 v239, v239, v19
  v_mfma_f32_16x16x32_bf16 v[44:47], a[216:219], a[184:187], v[44:47]
  ds_read_b128 a[216:219], v1 offset:9728
  v_mul_f32 v241, v241, v17
  v_mfma_f32_16x16x32_bf16 v[44:47], a[220:223], a[188:191], v[44:47]
  ds_read_b128 a[220:223], v1 offset:9984
  v_mul_f32 v245, v245, v17
  v_mfma_f32_16x16x32_bf16 v[52:55], v[28:31], v[8:11], v[52:55]
  v_exp_f32 v36, v36
  v_mfma_f32_16x16x32_bf16 v[96:99], v[28:31], a[0:3], v[96:99]
  v_exp_f32 v37, v37
  v_mfma_f32_16x16x32_bf16 v[100:103], v[28:31], a[4:7], v[100:103]
  v_exp_f32 v38, v38
  v_mfma_f32_16x16x32_bf16 v[104:107], v[28:31], a[8:11], v[104:107]
  v_exp_f32 v39, v39
  v_mfma_f32_16x16x32_bf16 v[108:111], v[28:31], a[12:15], v[108:111]
  v_exp_f32 v44, v44
  v_mfma_f32_16x16x32_bf16 v[112:115], v[28:31], a[16:19], v[112:115]
  v_exp_f32 v45, v45
  v_mfma_f32_16x16x32_bf16 v[116:119], v[28:31], a[20:23], v[116:119]
  v_exp_f32 v46, v46
  v_mfma_f32_16x16x32_bf16 v[120:123], v[28:31], a[24:27], v[120:123]
  v_exp_f32 v47, v47
  v_mfma_f32_16x16x32_bf16 v[124:127], v[28:31], a[28:31], v[124:127]
  s_waitcnt lgkmcnt(0)
  v_cvt_pk_bf16_f32 v36, v36, v37
  v_cvt_pk_bf16_f32 v37, v38, v39
  v_mfma_f32_16x16x32_bf16 v[28:31], a[192:195], a[144:147], -4.0
  v_cvt_pk_bf16_f32 v38, v44, v45
  v_cvt_pk_bf16_f32 v39, v46, v47
  v_mfma_f32_16x16x32_bf16 v[28:31], a[196:199], a[148:151], v[28:31]
  v_exp_f32 v35, v35
  v_mfma_f32_16x16x32_bf16 v[28:31], a[200:203], a[152:155], v[28:31]
  v_exp_f32 v40, v40
  v_mfma_f32_16x16x32_bf16 v[28:31], a[204:207], a[156:159], v[28:31]
  v_exp_f32 v41, v41
  v_mfma_f32_16x16x32_bf16 v[44:47], a[208:211], a[144:147], -4.0
  v_exp_f32 v42, v42
  v_mfma_f32_16x16x32_bf16 v[44:47], a[212:215], a[148:151], v[44:47]
  v_exp_f32 v43, v43
  v_mfma_f32_16x16x32_bf16 v[44:47], a[216:219], a[152:155], v[44:47]
  v_cvt_pk_bf16_f32 v33, v34, v35
  v_cvt_pk_bf16_f32 v34, v40, v41
  v_mfma_f32_16x16x32_bf16 v[44:47], a[220:223], a[156:159], v[44:47]
  ds_read_b128 a[224:227], v3 offset:32768
  v_cvt_pk_bf16_f32 v35, v42, v43
  v_exp_f32 v28, v28
  s_nop 0
  v_mfma_f32_16x16x32_bf16 v[56:59], v[32:35], v[8:11], v[56:59]
  v_exp_f32 v29, v29
  v_mfma_f32_16x16x32_bf16 v[128:131], v[32:35], a[0:3], v[128:131]
  v_exp_f32 v30, v30
  v_mfma_f32_16x16x32_bf16 v[132:135], v[32:35], a[4:7], v[132:135]
  v_exp_f32 v31, v31
  v_mfma_f32_16x16x32_bf16 v[136:139], v[32:35], a[8:11], v[136:139]
  v_exp_f32 v44, v44
  v_mfma_f32_16x16x32_bf16 v[140:143], v[32:35], a[12:15], v[140:143]
  v_exp_f32 v45, v45
  v_mfma_f32_16x16x32_bf16 v[144:147], v[32:35], a[16:19], v[144:147]
  v_exp_f32 v46, v46
  v_mfma_f32_16x16x32_bf16 v[148:151], v[32:35], a[20:23], v[148:151]
  v_exp_f32 v47, v47
  v_mfma_f32_16x16x32_bf16 v[152:155], v[32:35], a[24:27], v[152:155]
  v_cvt_pk_bf16_f32 v28, v28, v29
  v_cvt_pk_bf16_f32 v29, v30, v31
  v_mfma_f32_16x16x32_bf16 v[156:159], v[32:35], a[28:31], v[156:159]
  v_cvt_pk_bf16_f32 v30, v44, v45
  v_cvt_pk_bf16_f32 v31, v46, v47
  v_mfma_f32_16x16x32_bf16 v[60:63], v[36:39], v[8:11], v[60:63]
  v_mul_f32 v249, v249, v17
  v_mul_f32 v253, v253, v17
  v_mfma_f32_16x16x32_bf16 v[160:163], v[36:39], a[0:3], v[160:163]
  v_mul_f32 v242, v242, v18
  v_mul_f32 v246, v246, v18
  v_mfma_f32_16x16x32_bf16 v[164:167], v[36:39], a[4:7], v[164:167]
  v_mul_f32 v250, v250, v18
  v_mul_f32 v254, v254, v18
  v_mfma_f32_16x16x32_bf16 v[168:171], v[36:39], a[8:11], v[168:171]
  v_mul_f32 v243, v243, v19
  v_mul_f32 v247, v247, v19
  v_mfma_f32_16x16x32_bf16 v[172:175], v[36:39], a[12:15], v[172:175]
  v_mul_f32 v251, v251, v19
  v_mul_f32 v255, v255, v19
  v_mfma_f32_16x16x32_bf16 v[176:179], v[36:39], a[16:19], v[176:179]
  v_cvt_pk_bf16_f32 v229, v233, v237
  v_cvt_pk_bf16_f32 v230, v241, v245
  v_mfma_f32_16x16x32_bf16 v[180:183], v[36:39], a[20:23], v[180:183]
  v_cvt_pk_bf16_f32 v231, v249, v253
  v_cvt_pk_bf16_f32 v233, v234, v238
  v_mfma_f32_16x16x32_bf16 v[184:187], v[36:39], a[24:27], v[184:187]
  buffer_store_dwordx4 v[228:231], v5, s[28:31], s35 offen offset:256 nt
  v_mfma_f32_16x16x32_bf16 v[188:191], v[36:39], a[28:31], v[188:191]
  v_cvt_pk_bf16_f32 v237, v235, v239
  v_cvt_pk_bf16_f32 v234, v242, v246
  v_mfma_f32_16x16x32_bf16 v[32:35], a[192:195], a[160:163], -4.0
  v_cvt_pk_bf16_f32 v235, v250, v254
  v_cvt_pk_bf16_f32 v238, v243, v247
  v_mfma_f32_16x16x32_bf16 v[32:35], a[196:199], a[164:167], v[32:35]
  buffer_store_dwordx4 v[232:235], v5, s[28:31], s35 offen offset:512 nt
  v_mfma_f32_16x16x32_bf16 v[32:35], a[200:203], a[168:171], v[32:35]
  v_cvt_pk_bf16_f32 v239, v251, v255
  v_mfma_f32_16x16x32_bf16 v[32:35], a[204:207], a[172:175], v[32:35]
  buffer_store_dwordx4 v[236:239], v5, s[28:31], s35 offen offset:768 nt
  v_mfma_f32_16x16x32_bf16 v[40:43], a[208:211], a[160:163], -4.0
  ds_read_b128 a[228:231], v3 offset:33024
  s_add_u32 s35, s35, 4096
  v_mfma_f32_16x16x32_bf16 v[40:43], a[212:215], a[164:167], v[40:43]
  s_nop 0
  v_exp_f32 v32, v32
  v_mfma_f32_16x16x32_bf16 v[40:43], a[216:219], a[168:171], v[40:43]
  v_exp_f32 v33, v33
  v_mfma_f32_16x16x32_bf16 v[40:43], a[220:223], a[172:175], v[40:43]
  v_exp_f32 v34, v34
  v_mfma_f32_16x16x32_bf16 v[36:39], a[192:195], a[176:179], -4.0
  ds_read_b128 a[192:195], v1 offset:16384
  v_cvt_pk_bf16_f32 v32, v32, v33
  v_mfma_f32_16x16x32_bf16 v[36:39], a[196:199], a[180:183], v[36:39]
  ds_read_b128 a[196:199], v1 offset:16640
  v_mfma_f32_16x16x32_bf16 v[36:39], a[200:203], a[184:187], v[36:39]
  ds_read_b128 a[200:203], v1 offset:16896
  v_mfma_f32_16x16x32_bf16 v[36:39], a[204:207], a[188:191], v[36:39]
  ds_read_b128 a[204:207], v1 offset:17152
  v_mfma_f32_16x16x32_bf16 v[44:47], a[208:211], a[176:179], -4.0
  ds_read_b128 a[208:211], v1 offset:17408
  v_mfma_f32_16x16x32_bf16 v[44:47], a[212:215], a[180:183], v[44:47]
  ds_read_b128 a[212:215], v1 offset:17664
  v_mfma_f32_16x16x32_bf16 v[44:47], a[216:219], a[184:187], v[44:47]
  ds_read_b128 a[216:219], v1 offset:17920
  v_mfma_f32_16x16x32_bf16 v[44:47], a[220:223], a[188:191], v[44:47]
  ds_read_b128 a[220:223], v1 offset:18176
  v_mfma_f32_16x16x32_bf16 v[52:55], v[28:31], v[8:11], v[52:55]
  v_exp_f32 v36, v36
  v_mfma_f32_16x16x32_bf16 v[96:99], v[28:31], a[32:35], v[96:99]
  v_exp_f32 v37, v37
  v_mfma_f32_16x16x32_bf16 v[100:103], v[28:31], a[36:39], v[100:103]
  v_exp_f32 v38, v38
  v_mfma_f32_16x16x32_bf16 v[104:107], v[28:31], a[40:43], v[104:107]
  v_exp_f32 v39, v39
  v_mfma_f32_16x16x32_bf16 v[108:111], v[28:31], a[44:47], v[108:111]
  v_exp_f32 v44, v44
  v_mfma_f32_16x16x32_bf16 v[112:115], v[28:31], a[48:51], v[112:115]
  v_exp_f32 v45, v45
  v_mfma_f32_16x16x32_bf16 v[116:119], v[28:31], a[52:55], v[116:119]
  v_exp_f32 v46, v46
  v_mfma_f32_16x16x32_bf16 v[120:123], v[28:31], a[56:59], v[120:123]
  v_exp_f32 v47, v47
  v_mfma_f32_16x16x32_bf16 v[124:127], v[28:31], a[60:63], v[124:127]
  s_waitcnt lgkmcnt(0)
  v_cvt_pk_bf16_f32 v36, v36, v37
  v_cvt_pk_bf16_f32 v37, v38, v39
  v_mfma_f32_16x16x32_bf16 v[28:31], a[192:195], a[144:147], -4.0
  v_cvt_pk_bf16_f32 v38, v44, v45
  v_cvt_pk_bf16_f32 v39, v46, v47
  v_mfma_f32_16x16x32_bf16 v[28:31], a[196:199], a[148:151], v[28:31]
  v_exp_f32 v35, v35
  v_mfma_f32_16x16x32_bf16 v[28:31], a[200:203], a[152:155], v[28:31]
  v_exp_f32 v40, v40
  v_mfma_f32_16x16x32_bf16 v[28:31], a[204:207], a[156:159], v[28:31]
  v_exp_f32 v41, v41
  v_mfma_f32_16x16x32_bf16 v[44:47], a[208:211], a[144:147], -4.0
  v_exp_f32 v42, v42
  v_mfma_f32_16x16x32_bf16 v[44:47], a[212:215], a[148:151], v[44:47]
  v_exp_f32 v43, v43
  v_mfma_f32_16x16x32_bf16 v[44:47], a[216:219], a[152:155], v[44:47]
  v_cvt_pk_bf16_f32 v33, v34, v35
  v_cvt_pk_bf16_f32 v34, v40, v41
  v_mfma_f32_16x16x32_bf16 v[44:47], a[220:223], a[156:159], v[44:47]
  ds_read_b128 a[232:235], v3 offset:33280
  v_cvt_pk_bf16_f32 v35, v42, v43
  v_exp_f32 v28, v28
  s_nop 0
  v_mfma_f32_16x16x32_bf16 v[16:19], v[32:35], v[8:11], v[56:59]
  v_exp_f32 v29, v29
  v_mfma_f32_16x16x32_bf16 v[224:227], v[32:35], a[32:35], v[128:131]
  v_exp_f32 v30, v30
  v_mfma_f32_16x16x32_bf16 v[228:231], v[32:35], a[36:39], v[132:135]
  v_exp_f32 v31, v31
  v_mfma_f32_16x16x32_bf16 v[232:235], v[32:35], a[40:43], v[136:139]
  v_exp_f32 v44, v44
  v_mfma_f32_16x16x32_bf16 v[236:239], v[32:35], a[44:47], v[140:143]
  v_exp_f32 v45, v45
  v_mfma_f32_16x16x32_bf16 v[240:243], v[32:35], a[48:51], v[144:147]
  v_exp_f32 v46, v46
  v_mfma_f32_16x16x32_bf16 v[244:247], v[32:35], a[52:55], v[148:151]
  v_exp_f32 v47, v47
  v_mfma_f32_16x16x32_bf16 v[248:251], v[32:35], a[56:59], v[152:155]
  v_cvt_pk_bf16_f32 v28, v28, v29
  v_cvt_pk_bf16_f32 v29, v30, v31
  v_mfma_f32_16x16x32_bf16 v[252:255], v[32:35], a[60:63], v[156:159]
  v_cvt_pk_bf16_f32 v30, v44, v45
  v_cvt_pk_bf16_f32 v31, v46, v47
  v_mfma_f32_16x16x32_bf16 v[60:63], v[36:39], v[8:11], v[60:63]
  ds_read_b128 a[236:239], v3 offset:33536
  v_mfma_f32_16x16x32_bf16 v[160:163], v[36:39], a[32:35], v[160:163]
  ds_read_b128 a[240:243], v3 offset:33792
  v_mfma_f32_16x16x32_bf16 v[164:167], v[36:39], a[36:39], v[164:167]
  v_rcp_f32_dpp v16, v16 row_newbcast:0 row_mask:0xf bank_mask:0xf
  v_mfma_f32_16x16x32_bf16 v[168:171], v[36:39], a[40:43], v[168:171]
  v_rcp_f32_dpp v17, v17 row_newbcast:0 row_mask:0xf bank_mask:0xf
  v_mfma_f32_16x16x32_bf16 v[172:175], v[36:39], a[44:47], v[172:175]
  ds_read_b128 a[244:247], v3 offset:34048
  v_mul_f32 v224, v224, v16
  v_mfma_f32_16x16x32_bf16 v[176:179], v[36:39], a[48:51], v[176:179]
  v_rcp_f32_dpp v18, v18 row_newbcast:0 row_mask:0xf bank_mask:0xf
  v_mfma_f32_16x16x32_bf16 v[180:183], v[36:39], a[52:55], v[180:183]
  v_rcp_f32_dpp v19, v19 row_newbcast:0 row_mask:0xf bank_mask:0xf
  v_mfma_f32_16x16x32_bf16 v[184:187], v[36:39], a[56:59], v[184:187]
  v_mul_f32 v228, v228, v16
  v_mul_f32 v225, v225, v17
  v_mfma_f32_16x16x32_bf16 v[188:191], v[36:39], a[60:63], v[188:191]
  v_mul_f32 v229, v229, v17
  v_cvt_pk_bf16_f32 v224, v224, v228
  v_mfma_f32_16x16x32_bf16 v[36:39], a[192:195], a[176:179], -4.0
  ds_read_b128 a[192:195], v1 offset:24576
  v_mul_f32 v232, v232, v16
  v_mfma_f32_16x16x32_bf16 v[36:39], a[196:199], a[180:183], v[36:39]
  ds_read_b128 a[196:199], v1 offset:24832
  v_mul_f32 v236, v236, v16
  v_mfma_f32_16x16x32_bf16 v[36:39], a[200:203], a[184:187], v[36:39]
  ds_read_b128 a[200:203], v1 offset:25088
  v_cvt_pk_bf16_f32 v228, v225, v229
  v_mfma_f32_16x16x32_bf16 v[36:39], a[204:207], a[188:191], v[36:39]
  ds_read_b128 a[204:207], v1 offset:25344
  v_mul_f32 v226, v226, v18
  v_mfma_f32_16x16x32_bf16 v[44:47], a[208:211], a[176:179], -4.0
  ds_read_b128 a[208:211], v1 offset:25600
  v_mul_f32 v230, v230, v18
  v_mfma_f32_16x16x32_bf16 v[44:47], a[212:215], a[180:183], v[44:47]
  ds_read_b128 a[212:215], v1 offset:25856
  v_cvt_pk_bf16_f32 v225, v232, v236
  v_mfma_f32_16x16x32_bf16 v[44:47], a[216:219], a[184:187], v[44:47]
  ds_read_b128 a[216:219], v1 offset:26112
  v_mul_f32 v227, v227, v19
  v_mfma_f32_16x16x32_bf16 v[44:47], a[220:223], a[188:191], v[44:47]
  ds_read_b128 a[220:223], v1 offset:26368
  v_mul_f32 v231, v231, v19
  v_mfma_f32_16x16x32_bf16 v[52:55], v[28:31], v[8:11], v[52:55]
  v_exp_f32 v36, v36
  v_mfma_f32_16x16x32_bf16 v[96:99], v[28:31], a[64:67], v[96:99]
  v_exp_f32 v37, v37
  v_mfma_f32_16x16x32_bf16 v[100:103], v[28:31], a[68:71], v[100:103]
  v_exp_f32 v38, v38
  v_mfma_f32_16x16x32_bf16 v[104:107], v[28:31], a[72:75], v[104:107]
  v_exp_f32 v39, v39
  v_mfma_f32_16x16x32_bf16 v[108:111], v[28:31], a[76:79], v[108:111]
  v_exp_f32 v44, v44
  v_mfma_f32_16x16x32_bf16 v[112:115], v[28:31], a[80:83], v[112:115]
  v_exp_f32 v45, v45
  v_mfma_f32_16x16x32_bf16 v[116:119], v[28:31], a[84:87], v[116:119]
  v_exp_f32 v46, v46
  v_mfma_f32_16x16x32_bf16 v[120:123], v[28:31], a[88:91], v[120:123]
  v_exp_f32 v47, v47
  v_mfma_f32_16x16x32_bf16 v[124:127], v[28:31], a[92:95], v[124:127]
  s_waitcnt lgkmcnt(0)
  v_cvt_pk_bf16_f32 v36, v36, v37
  v_cvt_pk_bf16_f32 v37, v38, v39
  v_mfma_f32_16x16x32_bf16 v[28:31], a[192:195], a[144:147], -4.0
  v_cvt_pk_bf16_f32 v38, v44, v45
  v_cvt_pk_bf16_f32 v39, v46, v47
  v_mfma_f32_16x16x32_bf16 v[28:31], a[196:199], a[148:151], v[28:31]
  ds_read_b128 a[248:251], v3 offset:34304
  v_cvt_pk_bf16_f32 v232, v226, v230
  v_mfma_f32_16x16x32_bf16 v[28:31], a[200:203], a[152:155], v[28:31]
  v_cvt_pk_bf16_f32 v236, v227, v231
  v_mul_f32 v240, v240, v16
  v_mfma_f32_16x16x32_bf16 v[28:31], a[204:207], a[156:159], v[28:31]
  v_mul_f32 v244, v244, v16
  v_mul_f32 v248, v248, v16
  v_mfma_f32_16x16x32_bf16 v[44:47], a[208:211], a[144:147], -4.0
  v_mul_f32 v252, v252, v16
  v_cvt_pk_bf16_f32 v226, v240, v244
  v_mfma_f32_16x16x32_bf16 v[44:47], a[212:215], a[148:151], v[44:47]
  v_cvt_pk_bf16_f32 v227, v248, v252
  v_max3_u32 v6, v6, v16, v17
  v_mfma_f32_16x16x32_bf16 v[44:47], a[216:219], a[152:155], v[44:47]
  v_exp_f32 v28, v28
  v_mfma_f32_16x16x32_bf16 v[44:47], a[220:223], a[156:159], v[44:47]
  v_exp_f32 v29, v29
  v_mfma_f32_16x16x32_bf16 v[60:63], v[36:39], v[8:11], v[60:63]
  v_exp_f32 v30, v30
  v_mfma_f32_16x16x32_bf16 v[160:163], v[36:39], a[64:67], v[160:163]
  v_exp_f32 v31, v31
  v_mfma_f32_16x16x32_bf16 v[164:167], v[36:39], a[68:71], v[164:167]
  v_exp_f32 v44, v44
  v_mfma_f32_16x16x32_bf16 v[168:171], v[36:39], a[72:75], v[168:171]
  v_exp_f32 v45, v45
  v_mfma_f32_16x16x32_bf16 v[172:175], v[36:39], a[76:79], v[172:175]
  v_exp_f32 v46, v46
  v_mfma_f32_16x16x32_bf16 v[176:179], v[36:39], a[80:83], v[176:179]
  v_exp_f32 v47, v47
  v_mfma_f32_16x16x32_bf16 v[180:183], v[36:39], a[84:87], v[180:183]
  v_cvt_pk_bf16_f32 v28, v28, v29
  v_cvt_pk_bf16_f32 v29, v30, v31
  v_mfma_f32_16x16x32_bf16 v[184:187], v[36:39], a[88:91], v[184:187]
  v_cvt_pk_bf16_f32 v30, v44, v45
  v_cvt_pk_bf16_f32 v31, v46, v47
  v_mfma_f32_16x16x32_bf16 v[188:191], v[36:39], a[92:95], v[188:191]
  v_min3_u32 v7, v7, v16, v17
  v_max3_u32 v6, v6, v18, v19
  v_mfma_f32_16x16x32_bf16 v[36:39], a[192:195], a[176:179], -4.0
  ds_read_b128 a[192:195], v1 offset:32768
  v_min3_u32 v7, v7, v18, v19
  v_mfma_f32_16x16x32_bf16 v[36:39], a[196:199], a[180:183], v[36:39]
  ds_read_b128 a[196:199], v1 offset:33024
  v_mul_f32 v233, v233, v17
  v_mfma_f32_16x16x32_bf16 v[36:39], a[200:203], a[184:187], v[36:39]
  ds_read_b128 a[200:203], v1 offset:33280
  v_mul_f32 v237, v237, v17
  v_mfma_f32_16x16x32_bf16 v[36:39], a[204:207], a[188:191], v[36:39]
  ds_read_b128 a[204:207], v1 offset:33536
  v_mul_f32 v234, v234, v18
  v_mfma_f32_16x16x32_bf16 v[44:47], a[208:211], a[176:179], -4.0
  ds_read_b128 a[208:211], v1 offset:33792
  v_mul_f32 v238, v238, v18
  v_mfma_f32_16x16x32_bf16 v[44:47], a[212:215], a[180:183], v[44:47]
  ds_read_b128 a[212:215], v1 offset:34048
  v_mul_f32 v235, v235, v19
  v_mfma_f32_16x16x32_bf16 v[44:47], a[216:219], a[184:187], v[44:47]
  ds_read_b128 a[216:219], v1 offset:34304
  v_mul_f32 v239, v239, v19
  v_mfma_f32_16x16x32_bf16 v[44:47], a[220:223], a[188:191], v[44:47]
  ds_read_b128 a[220:223], v1 offset:34560
  v_mul_f32 v241, v241, v17
  v_mfma_f32_16x16x32_bf16 v[52:55], v[28:31], v[8:11], v[52:55]
  v_exp_f32 v36, v36
  v_mfma_f32_16x16x32_bf16 v[96:99], v[28:31], a[96:99], v[96:99]
  v_exp_f32 v37, v37
  v_mfma_f32_16x16x32_bf16 v[100:103], v[28:31], a[100:103], v[100:103]
  v_exp_f32 v38, v38
  v_mfma_f32_16x16x32_bf16 v[104:107], v[28:31], a[104:107], v[104:107]
  v_exp_f32 v39, v39
  v_mfma_f32_16x16x32_bf16 v[108:111], v[28:31], a[108:111], v[108:111]
  v_exp_f32 v44, v44
  v_mfma_f32_16x16x32_bf16 v[112:115], v[28:31], a[112:115], v[112:115]
  v_exp_f32 v45, v45
  v_mfma_f32_16x16x32_bf16 v[116:119], v[28:31], a[116:119], v[116:119]
  v_exp_f32 v46, v46
  v_mfma_f32_16x16x32_bf16 v[120:123], v[28:31], a[120:123], v[120:123]
  v_exp_f32 v47, v47
  v_mfma_f32_16x16x32_bf16 v[124:127], v[28:31], a[124:127], v[124:127]
  s_waitcnt lgkmcnt(0)
  v_cvt_pk_bf16_f32 v36, v36, v37
  v_cvt_pk_bf16_f32 v37, v38, v39
  v_mfma_f32_16x16x32_bf16 v[28:31], a[192:195], a[144:147], -4.0
  v_cvt_pk_bf16_f32 v38, v44, v45
  v_cvt_pk_bf16_f32 v39, v46, v47
  v_mfma_f32_16x16x32_bf16 v[28:31], a[196:199], a[148:151], v[28:31]
  buffer_store_dwordx4 v[224:227], v5, s[28:31], s35 offen offset:0 nt
  v_mfma_f32_16x16x32_bf16 v[28:31], a[200:203], a[152:155], v[28:31]
  v_mul_f32 v245, v245, v17
  v_mul_f32 v249, v249, v17
  v_mfma_f32_16x16x32_bf16 v[28:31], a[204:207], a[156:159], v[28:31]
  v_mul_f32 v253, v253, v17
  v_mul_f32 v242, v242, v18
  v_mfma_f32_16x16x32_bf16 v[44:47], a[208:211], a[144:147], -4.0
  v_mul_f32 v246, v246, v18
  v_mul_f32 v250, v250, v18
  v_mfma_f32_16x16x32_bf16 v[44:47], a[212:215], a[148:151], v[44:47]
  v_mul_f32 v254, v254, v18
  v_mul_f32 v243, v243, v19
  v_mfma_f32_16x16x32_bf16 v[44:47], a[216:219], a[152:155], v[44:47]
  v_exp_f32 v28, v28
  v_mfma_f32_16x16x32_bf16 v[44:47], a[220:223], a[156:159], v[44:47]
  v_exp_f32 v29, v29
  v_mfma_f32_16x16x32_bf16 v[60:63], v[36:39], v[8:11], v[60:63]
  v_exp_f32 v30, v30
  v_mfma_f32_16x16x32_bf16 v[160:163], v[36:39], a[96:99], v[160:163]
  v_exp_f32 v31, v31
  v_mfma_f32_16x16x32_bf16 v[164:167], v[36:39], a[100:103], v[164:167]
  v_exp_f32 v44, v44
  v_mfma_f32_16x16x32_bf16 v[168:171], v[36:39], a[104:107], v[168:171]
  v_exp_f32 v45, v45
  v_mfma_f32_16x16x32_bf16 v[172:175], v[36:39], a[108:111], v[172:175]
  v_exp_f32 v46, v46
  v_mfma_f32_16x16x32_bf16 v[176:179], v[36:39], a[112:115], v[176:179]
  v_exp_f32 v47, v47
  v_mfma_f32_16x16x32_bf16 v[180:183], v[36:39], a[116:119], v[180:183]
  v_cvt_pk_bf16_f32 v28, v28, v29
  v_cvt_pk_bf16_f32 v29, v30, v31
  v_mfma_f32_16x16x32_bf16 v[184:187], v[36:39], a[120:123], v[184:187]
  v_cvt_pk_bf16_f32 v30, v44, v45
  v_cvt_pk_bf16_f32 v31, v46, v47
  v_mfma_f32_16x16x32_bf16 v[188:191], v[36:39], a[124:127], v[188:191]
  v_mul_f32 v247, v247, v19
  v_mul_f32 v251, v251, v19
  v_mfma_f32_16x16x32_bf16 v[36:39], a[192:195], a[176:179], -4.0
  v_mul_f32 v255, v255, v19
  v_cvt_pk_bf16_f32 v229, v233, v237
  v_mfma_f32_16x16x32_bf16 v[36:39], a[196:199], a[180:183], v[36:39]
  ds_read_b128 a[252:255], v3 offset:34560
  v_cvt_pk_bf16_f32 v230, v241, v245
  v_mfma_f32_16x16x32_bf16 v[36:39], a[200:203], a[184:187], v[36:39]
  v_cvt_pk_bf16_f32 v231, v249, v253
  v_cvt_pk_bf16_f32 v233, v234, v238
  v_mfma_f32_16x16x32_bf16 v[36:39], a[204:207], a[188:191], v[36:39]
  buffer_store_dwordx4 v[228:231], v5, s[28:31], s35 offen offset:256 nt
  v_mfma_f32_16x16x32_bf16 v[44:47], a[208:211], a[176:179], -4.0
  ds_read_b128 a[192:195], v1 offset:40960
  v_cvt_pk_bf16_f32 v237, v235, v239
  v_mfma_f32_16x16x32_bf16 v[44:47], a[212:215], a[180:183], v[44:47]
  v_cvt_pk_bf16_f32 v234, v242, v246
  v_cvt_pk_bf16_f32 v235, v250, v254
  v_mfma_f32_16x16x32_bf16 v[44:47], a[216:219], a[184:187], v[44:47]
  ds_read_b128 a[208:211], v1 offset:41984
  v_cvt_pk_bf16_f32 v238, v243, v247
  v_mfma_f32_16x16x32_bf16 v[44:47], a[220:223], a[188:191], v[44:47]
  buffer_store_dwordx4 v[232:235], v5, s[28:31], s35 offen offset:512 nt
  v_mfma_f32_16x16x32_bf16 v[16:19], v[28:31], v[8:11], v[52:55]
  ds_read_b128 a[196:199], v1 offset:41216
  v_cvt_pk_bf16_f32 v239, v251, v255
  v_mfma_f32_16x16x32_bf16 v[224:227], v[28:31], a[224:227], v[96:99]
  ds_read_b128 a[212:215], v1 offset:42240
  v_mfma_f32_16x16x32_bf16 v[228:231], v[28:31], a[228:231], v[100:103]
  buffer_store_dwordx4 v[236:239], v5, s[28:31], s35 offen offset:768 nt
  v_mfma_f32_16x16x32_bf16 v[232:235], v[28:31], a[232:235], v[104:107]
  ds_read_b128 a[200:203], v1 offset:41472
  s_add_u32 s35, s35, 4096
  v_mfma_f32_16x16x32_bf16 v[236:239], v[28:31], a[236:239], v[108:111]
  ds_read_b128 a[216:219], v1 offset:42496
  v_mfma_f32_16x16x32_bf16 v[240:243], v[28:31], a[240:243], v[112:115]
  ds_read_b128 a[204:207], v1 offset:41728
  v_mfma_f32_16x16x32_bf16 v[244:247], v[28:31], a[244:247], v[116:119]
  ds_read_b128 a[220:223], v1 offset:42752
  v_mfma_f32_16x16x32_bf16 v[248:251], v[28:31], a[248:251], v[120:123]
  s_waitcnt lgkmcnt(4)
  v_exp_f32 v36, v36
  v_mfma_f32_16x16x32_bf16 v[252:255], v[28:31], a[252:255], v[124:127]
  v_exp_f32 v37, v37
  v_mfma_f32_16x16x32_bf16 v[24:27], a[192:195], a[176:179], -4.0
  v_exp_f32 v38, v38
  v_mfma_f32_16x16x32_bf16 v[40:43], a[208:211], a[176:179], -4.0
  v_exp_f32 v39, v39
  v_mfma_f32_16x16x32_bf16 v[24:27], a[196:199], a[180:183], v[24:27]
  v_exp_f32 v44, v44
  v_mfma_f32_16x16x32_bf16 v[40:43], a[212:215], a[180:183], v[40:43]
  s_waitcnt lgkmcnt(1)
  v_exp_f32 v45, v45
  v_mfma_f32_16x16x32_bf16 v[24:27], a[200:203], a[184:187], v[24:27]
  v_exp_f32 v46, v46
  v_mfma_f32_16x16x32_bf16 v[40:43], a[216:219], a[184:187], v[40:43]
  v_exp_f32 v47, v47
  v_mfma_f32_16x16x32_bf16 v[24:27], a[204:207], a[188:191], v[24:27]
  s_waitcnt lgkmcnt(0)
  v_cvt_pk_bf16_f32 v36, v36, v37
  v_cvt_pk_bf16_f32 v37, v38, v39
  v_cvt_pk_bf16_f32 v38, v44, v45
  v_cvt_pk_bf16_f32 v39, v46, v47
  v_mfma_f32_16x16x32_bf16 v[40:43], a[220:223], a[188:191], v[40:43]
  ds_read_b128 a[192:195], v1 offset:49152
  v_mfma_f32_16x16x32_bf16 v[160:163], v[36:39], a[224:227], v[160:163]
  ds_read_b128 a[224:227], v3 offset:40960
  v_mfma_f32_16x16x32_bf16 v[164:167], v[36:39], a[228:231], v[164:167]
  ds_read_b128 a[228:231], v3 offset:41216
  v_mfma_f32_16x16x32_bf16 v[168:171], v[36:39], a[232:235], v[168:171]
  ds_read_b128 a[208:211], v1 offset:50176
  v_mfma_f32_16x16x32_bf16 v[172:175], v[36:39], a[236:239], v[172:175]
  ds_read_b128 a[232:235], v3 offset:41472
  v_mfma_f32_16x16x32_bf16 v[176:179], v[36:39], a[240:243], v[176:179]
  ds_read_b128 a[236:239], v3 offset:41728
  v_mfma_f32_16x16x32_bf16 v[180:183], v[36:39], a[244:247], v[180:183]
  ds_read_b128 a[196:199], v1 offset:49408
  v_mfma_f32_16x16x32_bf16 v[184:187], v[36:39], a[248:251], v[184:187]
  ds_read_b128 a[240:243], v3 offset:41984
  v_mfma_f32_16x16x32_bf16 v[188:191], v[36:39], a[252:255], v[188:191]
  ds_read_b128 a[244:247], v3 offset:42240
  ds_read_b128 a[248:251], v3 offset:42496
  ds_read_b128 a[252:255], v3 offset:42752
  ds_read_b128 a[212:215], v1 offset:50432
  ds_read_b128 a[200:203], v1 offset:49664
  ds_read_b128 a[216:219], v1 offset:50688
  v_mfma_f32_16x16x32_bf16 v[60:63], v[36:39], v[8:11], v[60:63]
  ds_read_b128 a[204:207], v1 offset:49920
  s_waitcnt lgkmcnt(10)
  v_mfma_f32_16x16x32_bf16 v[36:39], a[192:195], a[176:179], -4.0
  ds_read_b128 a[220:223], v1 offset:50944
  v_mfma_f32_16x16x32_bf16 v[44:47], a[208:211], a[176:179], -4.0
  s_waitcnt lgkmcnt(8)
  v_exp_f32 v24, v24
  v_mfma_f32_16x16x32_bf16 v[36:39], a[196:199], a[180:183], v[36:39]
  s_waitcnt lgkmcnt(2)
  v_exp_f32 v25, v25
  v_exp_f32 v26, v26
  v_exp_f32 v27, v27
  v_exp_f32 v40, v40
  v_exp_f32 v41, v41
  v_exp_f32 v42, v42
  v_mfma_f32_16x16x32_bf16 v[44:47], a[212:215], a[180:183], v[44:47]
  v_exp_f32 v43, v43
  v_mfma_f32_16x16x32_bf16 v[36:39], a[200:203], a[184:187], v[36:39]
  v_cvt_pk_bf16_f32 v24, v24, v25
  v_cvt_pk_bf16_f32 v25, v26, v27
  v_mfma_f32_16x16x32_bf16 v[44:47], a[216:219], a[184:187], v[44:47]
  s_waitcnt lgkmcnt(0)
  v_cvt_pk_bf16_f32 v26, v40, v41
  v_cvt_pk_bf16_f32 v27, v42, v43
  v_mfma_f32_16x16x32_bf16 v[36:39], a[204:207], a[188:191], v[36:39]
  ds_read_b128 a[192:195], v1 offset:57344
  v_mfma_f32_16x16x32_bf16 v[160:163], v[24:27], a[224:227], v[160:163]
  ds_read_b128 a[224:227], v3 offset:49152
  v_mfma_f32_16x16x32_bf16 v[164:167], v[24:27], a[228:231], v[164:167]
  ds_read_b128 a[228:231], v3 offset:49408
  v_mfma_f32_16x16x32_bf16 v[168:171], v[24:27], a[232:235], v[168:171]
  ds_read_b128 a[208:211], v1 offset:58368
  v_mfma_f32_16x16x32_bf16 v[172:175], v[24:27], a[236:239], v[172:175]
  ds_read_b128 a[232:235], v3 offset:49664
  v_mfma_f32_16x16x32_bf16 v[176:179], v[24:27], a[240:243], v[176:179]
  ds_read_b128 a[236:239], v3 offset:49920
  v_mfma_f32_16x16x32_bf16 v[180:183], v[24:27], a[244:247], v[180:183]
  ds_read_b128 a[196:199], v1 offset:57600
  v_mfma_f32_16x16x32_bf16 v[184:187], v[24:27], a[248:251], v[184:187]
  ds_read_b128 a[240:243], v3 offset:50176
  v_mfma_f32_16x16x32_bf16 v[188:191], v[24:27], a[252:255], v[188:191]
  ds_read_b128 a[244:247], v3 offset:50432
  v_mfma_f32_16x16x32_bf16 v[44:47], a[220:223], a[188:191], v[44:47]
  ds_read_b128 a[248:251], v3 offset:50688
  ds_read_b128 a[252:255], v3 offset:50944
  ds_read_b128 a[212:215], v1 offset:58624
  ds_read_b128 a[200:203], v1 offset:57856
  ds_read_b128 a[216:219], v1 offset:58880
  v_mfma_f32_16x16x32_bf16 v[60:63], v[24:27], v[8:11], v[60:63]
  ds_read_b128 a[204:207], v1 offset:58112
  s_waitcnt lgkmcnt(9)
  v_mfma_f32_16x16x32_bf16 v[24:27], a[192:195], a[176:179], -4.0
  ds_read_b128 a[220:223], v1 offset:59136
  v_mfma_f32_16x16x32_bf16 v[40:43], a[208:211], a[176:179], -4.0
  s_waitcnt lgkmcnt(8)
  v_exp_f32 v36, v36
  v_mfma_f32_16x16x32_bf16 v[24:27], a[196:199], a[180:183], v[24:27]
  s_waitcnt lgkmcnt(2)
  v_exp_f32 v37, v37
  v_exp_f32 v38, v38
  v_exp_f32 v39, v39
  v_exp_f32 v44, v44
  v_exp_f32 v45, v45
  v_exp_f32 v46, v46
  v_mfma_f32_16x16x32_bf16 v[40:43], a[212:215], a[180:183], v[40:43]
  v_exp_f32 v47, v47
  v_mfma_f32_16x16x32_bf16 v[24:27], a[200:203], a[184:187], v[24:27]
  v_cvt_pk_bf16_f32 v36, v36, v37
  v_cvt_pk_bf16_f32 v37, v38, v39
  v_mfma_f32_16x16x32_bf16 v[40:43], a[216:219], a[184:187], v[40:43]
  s_waitcnt lgkmcnt(0)
  v_cvt_pk_bf16_f32 v38, v44, v45
  v_cvt_pk_bf16_f32 v39, v46, v47
  v_mfma_f32_16x16x32_bf16 v[24:27], a[204:207], a[188:191], v[24:27]
  v_rcp_f32_dpp v16, v16 row_newbcast:0 row_mask:0xf bank_mask:0xf
  v_mfma_f32_16x16x32_bf16 v[160:163], v[36:39], a[224:227], v[160:163]
  ds_read_b128 a[224:227], v3 offset:57344
  v_mul_f32 v224, v224, v16
  v_mfma_f32_16x16x32_bf16 v[164:167], v[36:39], a[228:231], v[164:167]
  ds_read_b128 a[228:231], v3 offset:57600
  v_mul_f32 v228, v228, v16
  v_mfma_f32_16x16x32_bf16 v[168:171], v[36:39], a[232:235], v[168:171]
  ds_read_b128 a[232:235], v3 offset:57856
  v_cvt_pk_bf16_f32 v224, v224, v228
  v_mfma_f32_16x16x32_bf16 v[172:175], v[36:39], a[236:239], v[172:175]
  ds_read_b128 a[236:239], v3 offset:58112
  v_mul_f32 v232, v232, v16
  v_mfma_f32_16x16x32_bf16 v[176:179], v[36:39], a[240:243], v[176:179]
  ds_read_b128 a[240:243], v3 offset:58368
  v_mul_f32 v236, v236, v16
  v_mfma_f32_16x16x32_bf16 v[180:183], v[36:39], a[244:247], v[180:183]
  ds_read_b128 a[244:247], v3 offset:58624
  v_mul_f32 v240, v240, v16
  v_mfma_f32_16x16x32_bf16 v[184:187], v[36:39], a[248:251], v[184:187]
  ds_read_b128 a[248:251], v3 offset:58880
  v_mul_f32 v244, v244, v16
  v_mfma_f32_16x16x32_bf16 v[188:191], v[36:39], a[252:255], v[188:191]
  ds_read_b128 a[252:255], v3 offset:59136
  v_mul_f32 v248, v248, v16
  v_mfma_f32_16x16x32_bf16 v[40:43], a[220:223], a[188:191], v[40:43]
  v_rcp_f32_dpp v17, v17 row_newbcast:0 row_mask:0xf bank_mask:0xf
  v_mfma_f32_16x16x32_bf16 v[60:63], v[36:39], v[8:11], v[60:63]
  v_rcp_f32_dpp v18, v18 row_newbcast:0 row_mask:0xf bank_mask:0xf
  v_rcp_f32_dpp v19, v19 row_newbcast:0 row_mask:0xf bank_mask:0xf
  v_mul_f32 v225, v225, v17
  v_mul_f32 v229, v229, v17
  v_cvt_pk_bf16_f32 v228, v225, v229
  v_exp_f32 v24, v24
  v_exp_f32 v25, v25
  v_mul_f32 v226, v226, v18
  v_mul_f32 v230, v230, v18
  v_cvt_pk_bf16_f32 v225, v232, v236
  v_mul_f32 v227, v227, v19
  v_mul_f32 v231, v231, v19
  v_exp_f32 v26, v26
  v_exp_f32 v27, v27
  v_cvt_pk_bf16_f32 v232, v226, v230
  v_mul_f32 v233, v233, v17
  v_mul_f32 v237, v237, v17
  v_cvt_pk_bf16_f32 v236, v227, v231
  v_mul_f32 v252, v252, v16
  v_exp_f32 v40, v40
  v_exp_f32 v41, v41
  v_exp_f32 v42, v42
  v_exp_f32 v43, v43
  v_mul_f32 v234, v234, v18
  v_mul_f32 v238, v238, v18
  v_cvt_pk_bf16_f32 v229, v233, v237
  v_mul_f32 v235, v235, v19
  v_mul_f32 v239, v239, v19
  v_cvt_pk_bf16_f32 v226, v240, v244
  v_mul_f32 v241, v241, v17
  v_mul_f32 v245, v245, v17
  v_cvt_pk_bf16_f32 v227, v248, v252
  v_mul_f32 v249, v249, v17
  v_mul_f32 v253, v253, v17
  v_cvt_pk_bf16_f32 v24, v24, v25
  v_cvt_pk_bf16_f32 v233, v234, v238
  v_cvt_pk_bf16_f32 v237, v235, v239
  buffer_store_dwordx4 v[224:227], v5, s[28:31], s35 offen offset:0 nt
  v_cvt_pk_bf16_f32 v230, v241, v245
  v_mul_f32 v242, v242, v18
  v_mul_f32 v246, v246, v18
  v_cvt_pk_bf16_f32 v231, v249, v253
  v_mul_f32 v250, v250, v18
  v_mul_f32 v254, v254, v18
  v_cvt_pk_bf16_f32 v25, v26, v27
  buffer_store_dwordx4 v[228:231], v5, s[28:31], s35 offen offset:256 nt
  v_cvt_pk_bf16_f32 v234, v242, v246
  v_mul_f32 v243, v243, v19
  v_mul_f32 v247, v247, v19
  v_cvt_pk_bf16_f32 v235, v250, v254
  v_mul_f32 v251, v251, v19
  v_mul_f32 v255, v255, v19
  v_cvt_pk_bf16_f32 v26, v40, v41
  v_cvt_pk_bf16_f32 v27, v42, v43
  v_max3_u32 v6, v6, v16, v17
  v_min3_u32 v7, v7, v16, v17
  s_waitcnt lgkmcnt(0)
  v_mfma_f32_16x16x32_bf16 v[224:227], v[24:27], a[224:227], v[160:163]
  buffer_store_dwordx4 v[232:235], v5, s[28:31], s35 offen offset:512 nt
  v_mfma_f32_16x16x32_bf16 v[228:231], v[24:27], a[228:231], v[164:167]
  v_cvt_pk_bf16_f32 v238, v243, v247
  v_cvt_pk_bf16_f32 v239, v251, v255
  v_mfma_f32_16x16x32_bf16 v[232:235], v[24:27], a[232:235], v[168:171]
  v_max3_u32 v6, v6, v18, v19
  v_min3_u32 v7, v7, v18, v19
  v_mfma_f32_16x16x32_bf16 v[16:19], v[24:27], v[8:11], v[60:63]
  buffer_store_dwordx4 v[236:239], v5, s[28:31], s35 offen offset:768 nt
  s_nop 1
  v_mfma_f32_16x16x32_bf16 v[236:239], v[24:27], a[236:239], v[172:175]
  s_add_u32 s35, s35, 4096
  v_mfma_f32_16x16x32_bf16 v[240:243], v[24:27], a[240:243], v[176:179]
  s_nop 0
  v_rcp_f32_dpp v16, v16 row_newbcast:0 row_mask:0xf bank_mask:0xf
  v_mfma_f32_16x16x32_bf16 v[244:247], v[24:27], a[244:247], v[180:183]
  v_rcp_f32_dpp v17, v17 row_newbcast:0 row_mask:0xf bank_mask:0xf
  v_mfma_f32_16x16x32_bf16 v[248:251], v[24:27], a[248:251], v[184:187]
  v_rcp_f32_dpp v18, v18 row_newbcast:0 row_mask:0xf bank_mask:0xf
  v_mfma_f32_16x16x32_bf16 v[252:255], v[24:27], a[252:255], v[188:191]
  v_rcp_f32_dpp v19, v19 row_newbcast:0 row_mask:0xf bank_mask:0xf
  v_mul_f32 v224, v224, v16
  v_mul_f32 v228, v228, v16
  v_mul_f32 v225, v225, v17
  v_mul_f32 v229, v229, v17
  v_cvt_pk_bf16_f32 v224, v224, v228
  v_mul_f32 v232, v232, v16
  v_mul_f32 v236, v236, v16
  v_cvt_pk_bf16_f32 v228, v225, v229
  v_mul_f32 v226, v226, v18
  v_mul_f32 v230, v230, v18
  v_cvt_pk_bf16_f32 v225, v232, v236
  v_mul_f32 v227, v227, v19
  v_mul_f32 v231, v231, v19
  v_cvt_pk_bf16_f32 v232, v226, v230
  v_mul_f32 v233, v233, v17
  v_mul_f32 v237, v237, v17
  v_cvt_pk_bf16_f32 v236, v227, v231
  v_mul_f32 v240, v240, v16
  v_mul_f32 v244, v244, v16
  v_mul_f32 v248, v248, v16
  v_mul_f32 v252, v252, v16
  v_mul_f32 v234, v234, v18
  v_mul_f32 v238, v238, v18
  v_cvt_pk_bf16_f32 v229, v233, v237
  v_mul_f32 v235, v235, v19
  v_mul_f32 v239, v239, v19
  v_cvt_pk_bf16_f32 v226, v240, v244
  v_mul_f32 v241, v241, v17
  v_mul_f32 v245, v245, v17
  v_cvt_pk_bf16_f32 v227, v248, v252
  v_mul_f32 v249, v249, v17
  v_mul_f32 v253, v253, v17
  v_cvt_pk_bf16_f32 v233, v234, v238
  v_cvt_pk_bf16_f32 v237, v235, v239
  buffer_store_dwordx4 v[224:227], v5, s[28:31], s35 offen offset:0 nt
  v_cvt_pk_bf16_f32 v230, v241, v245
  v_mul_f32 v242, v242, v18
  v_mul_f32 v246, v246, v18
  v_cvt_pk_bf16_f32 v231, v249, v253
  v_mul_f32 v250, v250, v18
  v_mul_f32 v254, v254, v18
  buffer_store_dwordx4 v[228:231], v5, s[28:31], s35 offen offset:256 nt
  v_cvt_pk_bf16_f32 v234, v242, v246
  v_mul_f32 v243, v243, v19
  v_mul_f32 v247, v247, v19
  v_cvt_pk_bf16_f32 v235, v250, v254
  v_mul_f32 v251, v251, v19
  v_mul_f32 v255, v255, v19
  buffer_store_dwordx4 v[232:235], v5, s[28:31], s35 offen offset:512 nt
  v_cvt_pk_bf16_f32 v238, v243, v247
  v_cvt_pk_bf16_f32 v239, v251, v255
  buffer_store_dwordx4 v[236:239], v5, s[28:31], s35 offen offset:768 nt
  v_max3_u32 v6, v6, v16, v17
  v_min3_u32 v7, v7, v16, v17
  v_max3_u32 v6, v6, v18, v19
  v_min3_u32 v7, v7, v18, v19
  s_add_u32 s35, s35, 4096
  v_cmp_lt_u32 vcc, s41, v6
  v_cmp_gt_u32 s[50:51], s40, v7
  s_nop 0
  s_or_b64 vcc, vcc, s[50:51]
  s_cbranch_scc1 L_fb
L_end:
L_fin:
  s_endpgm
L_fb:
  s_nop 7
  s_nop 7
  s_mov_b32 s18, 100663296
  s_mov_b32 s34, s47
  s_mov_b32 s35, s47
  s_mov_b32 s48, 0
  v_and_b32 v4, 0xf0, v5
  v_lshlrev_b32 v4, 4, v4
  v_lshrrev_b32 v15, 6, v5
  v_and_b32 v15, 0x30, v15
  v_or_b32 v4, v4, v15
  s_waitcnt vmcnt(0) lgkmcnt(0)
L_fb_loop:
  buffer_load_dwordx4 a[128:131], v4, s[16:19], s34 offen offset:0 nt
  buffer_load_dwordx4 a[132:135], v4, s[16:19], s34 offen offset:64 nt
  buffer_load_dwordx4 a[136:139], v4, s[16:19], s34 offen offset:128 nt
  buffer_load_dwordx4 a[140:143], v4, s[16:19], s34 offen offset:192 nt
  s_add_u32 s34, s34, 4096
  v_mov_b32 v14, 0xff800000
  ds_read_b128 a[192:195], v1 offset:0
  ds_read_b128 a[196:199], v1 offset:256
  ds_read_b128 a[200:203], v1 offset:512
  ds_read_b128 a[204:207], v1 offset:768
  ds_read_b128 a[208:211], v1 offset:1024
  ds_read_b128 a[212:215], v1 offset:1280
  ds_read_b128 a[216:219], v1 offset:1536
  ds_read_b128 a[220:223], v1 offset:1792
  s_waitcnt lgkmcnt(7) vmcnt(3)
  v_mfma_f32_16x16x32_bf16 v[24:27], a[192:195], a[128:131], 0
  s_waitcnt lgkmcnt(6) vmcnt(2)
  v_mfma_f32_16x16x32_bf16 v[24:27], a[196:199], a[132:135], v[24:27]
  s_waitcnt lgkmcnt(5) vmcnt(1)
  v_mfma_f32_16x16x32_bf16 v[24:27], a[200:203], a[136:139], v[24:27]
  s_waitcnt lgkmcnt(4) vmcnt(0)
  v_mfma_f32_16x16x32_bf16 v[24:27], a[204:207], a[140:143], v[24:27]
  s_waitcnt lgkmcnt(3)
  v_mfma_f32_16x16x32_bf16 v[40:43], a[208:211], a[128:131], 0
  s_waitcnt lgkmcnt(2)
  v_mfma_f32_16x16x32_bf16 v[40:43], a[212:215], a[132:135], v[40:43]
  s_waitcnt lgkmcnt(1)
  v_mfma_f32_16x16x32_bf16 v[40:43], a[216:219], a[136:139], v[40:43]
  s_waitcnt lgkmcnt(0)
  v_mfma_f32_16x16x32_bf16 v[40:43], a[220:223], a[140:143], v[40:43]
  v_max3_f32 v14, v14, v24, v25
  v_max3_f32 v14, v14, v26, v27
  s_nop 5
  v_max3_f32 v14, v14, v40, v41
  v_max3_f32 v14, v14, v42, v43
  ds_read_b128 a[192:195], v1 offset:8192
  ds_read_b128 a[196:199], v1 offset:8448
  ds_read_b128 a[200:203], v1 offset:8704
  ds_read_b128 a[204:207], v1 offset:8960
  ds_read_b128 a[208:211], v1 offset:9216
  ds_read_b128 a[212:215], v1 offset:9472
  ds_read_b128 a[216:219], v1 offset:9728
  ds_read_b128 a[220:223], v1 offset:9984
  s_waitcnt lgkmcnt(7)
  v_mfma_f32_16x16x32_bf16 v[24:27], a[192:195], a[128:131], 0
  s_waitcnt lgkmcnt(6)
  v_mfma_f32_16x16x32_bf16 v[24:27], a[196:199], a[132:135], v[24:27]
  s_waitcnt lgkmcnt(5)
  v_mfma_f32_16x16x32_bf16 v[24:27], a[200:203], a[136:139], v[24:27]
  s_waitcnt lgkmcnt(4)
  v_mfma_f32_16x16x32_bf16 v[24:27], a[204:207], a[140:143], v[24:27]
  s_waitcnt lgkmcnt(3)
  v_mfma_f32_16x16x32_bf16 v[40:43], a[208:211], a[128:131], 0
  s_waitcnt lgkmcnt(2)
  v_mfma_f32_16x16x32_bf16 v[40:43], a[212:215], a[132:135], v[40:43]
  s_waitcnt lgkmcnt(1)
  v_mfma_f32_16x16x32_bf16 v[40:43], a[216:219], a[136:139], v[40:43]
  s_waitcnt lgkmcnt(0)
  v_mfma_f32_16x16x32_bf16 v[40:43], a[220:223], a[140:143], v[40:43]
  v_max3_f32 v14, v14, v24, v25
  v_max3_f32 v14, v14, v26, v27
  s_nop 5
  v_max3_f32 v14, v14, v40, v41
  v_max3_f32 v14, v14, v42, v43
  ds_read_b128 a[192:195], v1 offset:16384
  ds_read_b128 a[196:199], v1 offset:16640
  ds_read_b128 a[200:203], v1 offset:16896
  ds_read_b128 a[204:207], v1 offset:17152
  ds_read_b128 a[208:211], v1 offset:17408
  ds_read_b128 a[212:215], v1 offset:17664
  ds_read_b128 a[216:219], v1 offset:17920
  ds_read_b128 a[220:223], v1 offset:18176
  s_waitcnt lgkmcnt(7)
  v_mfma_f32_16x16x32_bf16 v[24:27], a[192:195], a[128:131], 0
  s_waitcnt lgkmcnt(6)
  v_mfma_f32_16x16x32_bf16 v[24:27], a[196:199], a[132:135], v[24:27]
  s_waitcnt lgkmcnt(5)
  v_mfma_f32_16x16x32_bf16 v[24:27], a[200:203], a[136:139], v[24:27]
  s_waitcnt lgkmcnt(4)
  v_mfma_f32_16x16x32_bf16 v[24:27], a[204:207], a[140:143], v[24:27]
  s_waitcnt lgkmcnt(3)
  v_mfma_f32_16x16x32_bf16 v[40:43], a[208:211], a[128:131], 0
  s_waitcnt lgkmcnt(2)
  v_mfma_f32_16x16x32_bf16 v[40:43], a[212:215], a[132:135], v[40:43]
  s_waitcnt lgkmcnt(1)
  v_mfma_f32_16x16x32_bf16 v[40:43], a[216:219], a[136:139], v[40:43]
  s_waitcnt lgkmcnt(0)
  v_mfma_f32_16x16x32_bf16 v[40:43], a[220:223], a[140:143], v[40:43]
  v_max3_f32 v14, v14, v24, v25
  v_max3_f32 v14, v14, v26, v27
  s_nop 5
  v_max3_f32 v14, v14, v40, v41
  v_max3_f32 v14, v14, v42, v43
  ds_read_b128 a[192:195], v1 offset:24576
  ds_read_b128 a[196:199], v1 offset:24832
  ds_read_b128 a[200:203], v1 offset:25088
  ds_read_b128 a[204:207], v1 offset:25344
  ds_read_b128 a[208:211], v1 offset:25600
  ds_read_b128 a[212:215], v1 offset:25856
  ds_read_b128 a[216:219], v1 offset:26112
  ds_read_b128 a[220:223], v1 offset:26368
  s_waitcnt lgkmcnt(7)
  v_mfma_f32_16x16x32_bf16 v[24:27], a[192:195], a[128:131], 0
  s_waitcnt lgkmcnt(6)
  v_mfma_f32_16x16x32_bf16 v[24:27], a[196:199], a[132:135], v[24:27]
  s_waitcnt lgkmcnt(5)
  v_mfma_f32_16x16x32_bf16 v[24:27], a[200:203], a[136:139], v[24:27]
  s_waitcnt lgkmcnt(4)
  v_mfma_f32_16x16x32_bf16 v[24:27], a[204:207], a[140:143], v[24:27]
  s_waitcnt lgkmcnt(3)
  v_mfma_f32_16x16x32_bf16 v[40:43], a[208:211], a[128:131], 0
  s_waitcnt lgkmcnt(2)
  v_mfma_f32_16x16x32_bf16 v[40:43], a[212:215], a[132:135], v[40:43]
  s_waitcnt lgkmcnt(1)
  v_mfma_f32_16x16x32_bf16 v[40:43], a[216:219], a[136:139], v[40:43]
  s_waitcnt lgkmcnt(0)
  v_mfma_f32_16x16x32_bf16 v[40:43], a[220:223], a[140:143], v[40:43]
  v_max3_f32 v14, v14, v24, v25
  v_max3_f32 v14, v14, v26, v27
  s_nop 5
  v_max3_f32 v14, v14, v40, v41
  v_max3_f32 v14, v14, v42, v43
  ds_read_b128 a[192:195], v1 offset:32768
  ds_read_b128 a[196:199], v1 offset:33024
  ds_read_b128 a[200:203], v1 offset:33280
  ds_read_b128 a[204:207], v1 offset:33536
  ds_read_b128 a[208:211], v1 offset:33792
  ds_read_b128 a[212:215], v1 offset:34048
  ds_read_b128 a[216:219], v1 offset:34304
  ds_read_b128 a[220:223], v1 offset:34560
  s_waitcnt lgkmcnt(7)
  v_mfma_f32_16x16x32_bf16 v[24:27], a[192:195], a[128:131], 0
  s_waitcnt lgkmcnt(6)
  v_mfma_f32_16x16x32_bf16 v[24:27], a[196:199], a[132:135], v[24:27]
  s_waitcnt lgkmcnt(5)
  v_mfma_f32_16x16x32_bf16 v[24:27], a[200:203], a[136:139], v[24:27]
  s_waitcnt lgkmcnt(4)
  v_mfma_f32_16x16x32_bf16 v[24:27], a[204:207], a[140:143], v[24:27]
  s_waitcnt lgkmcnt(3)
  v_mfma_f32_16x16x32_bf16 v[40:43], a[208:211], a[128:131], 0
  s_waitcnt lgkmcnt(2)
  v_mfma_f32_16x16x32_bf16 v[40:43], a[212:215], a[132:135], v[40:43]
  s_waitcnt lgkmcnt(1)
  v_mfma_f32_16x16x32_bf16 v[40:43], a[216:219], a[136:139], v[40:43]
  s_waitcnt lgkmcnt(0)
  v_mfma_f32_16x16x32_bf16 v[40:43], a[220:223], a[140:143], v[40:43]
  v_max3_f32 v14, v14, v24, v25
  v_max3_f32 v14, v14, v26, v27
  s_nop 5
  v_max3_f32 v14, v14, v40, v41
  v_max3_f32 v14, v14, v42, v43
  ds_read_b128 a[192:195], v1 offset:40960
  ds_read_b128 a[196:199], v1 offset:41216
  ds_read_b128 a[200:203], v1 offset:41472
  ds_read_b128 a[204:207], v1 offset:41728
  ds_read_b128 a[208:211], v1 offset:41984
  ds_read_b128 a[212:215], v1 offset:42240
  ds_read_b128 a[216:219], v1 offset:42496
  ds_read_b128 a[220:223], v1 offset:42752
  s_waitcnt lgkmcnt(7)
  v_mfma_f32_16x16x32_bf16 v[24:27], a[192:195], a[128:131], 0
  s_waitcnt lgkmcnt(6)
  v_mfma_f32_16x16x32_bf16 v[24:27], a[196:199], a[132:135], v[24:27]
  s_waitcnt lgkmcnt(5)
  v_mfma_f32_16x16x32_bf16 v[24:27], a[200:203], a[136:139], v[24:27]
  s_waitcnt lgkmcnt(4)
  v_mfma_f32_16x16x32_bf16 v[24:27], a[204:207], a[140:143], v[24:27]
  s_waitcnt lgkmcnt(3)
  v_mfma_f32_16x16x32_bf16 v[40:43], a[208:211], a[128:131], 0
  s_waitcnt lgkmcnt(2)
  v_mfma_f32_16x16x32_bf16 v[40:43], a[212:215], a[132:135], v[40:43]
  s_waitcnt lgkmcnt(1)
  v_mfma_f32_16x16x32_bf16 v[40:43], a[216:219], a[136:139], v[40:43]
  s_waitcnt lgkmcnt(0)
  v_mfma_f32_16x16x32_bf16 v[40:43], a[220:223], a[140:143], v[40:43]
  v_max3_f32 v14, v14, v24, v25
  v_max3_f32 v14, v14, v26, v27
  s_nop 5
  v_max3_f32 v14, v14, v40, v41
  v_max3_f32 v14, v14, v42, v43
  ds_read_b128 a[192:195], v1 offset:49152
  ds_read_b128 a[196:199], v1 offset:49408
  ds_read_b128 a[200:203], v1 offset:49664
  ds_read_b128 a[204:207], v1 offset:49920
  ds_read_b128 a[208:211], v1 offset:50176
  ds_read_b128 a[212:215], v1 offset:50432
  ds_read_b128 a[216:219], v1 offset:50688
  ds_read_b128 a[220:223], v1 offset:50944
  s_waitcnt lgkmcnt(7)
  v_mfma_f32_16x16x32_bf16 v[24:27], a[192:195], a[128:131], 0
  s_waitcnt lgkmcnt(6)
  v_mfma_f32_16x16x32_bf16 v[24:27], a[196:199], a[132:135], v[24:27]
  s_waitcnt lgkmcnt(5)
  v_mfma_f32_16x16x32_bf16 v[24:27], a[200:203], a[136:139], v[24:27]
  s_waitcnt lgkmcnt(4)
  v_mfma_f32_16x16x32_bf16 v[24:27], a[204:207], a[140:143], v[24:27]
  s_waitcnt lgkmcnt(3)
  v_mfma_f32_16x16x32_bf16 v[40:43], a[208:211], a[128:131], 0
  s_waitcnt lgkmcnt(2)
  v_mfma_f32_16x16x32_bf16 v[40:43], a[212:215], a[132:135], v[40:43]
  s_waitcnt lgkmcnt(1)
  v_mfma_f32_16x16x32_bf16 v[40:43], a[216:219], a[136:139], v[40:43]
  s_waitcnt lgkmcnt(0)
  v_mfma_f32_16x16x32_bf16 v[40:43], a[220:223], a[140:143], v[40:43]
  v_max3_f32 v14, v14, v24, v25
  v_max3_f32 v14, v14, v26, v27
  s_nop 5
  v_max3_f32 v14, v14, v40, v41
  v_max3_f32 v14, v14, v42, v43
  ds_read_b128 a[192:195], v1 offset:57344
  ds_read_b128 a[196:199], v1 offset:57600
  ds_read_b128 a[200:203], v1 offset:57856
  ds_read_b128 a[204:207], v1 offset:58112
  ds_read_b128 a[208:211], v1 offset:58368
  ds_read_b128 a[212:215], v1 offset:58624
  ds_read_b128 a[216:219], v1 offset:58880
  ds_read_b128 a[220:223], v1 offset:59136
  s_waitcnt lgkmcnt(7)
  v_mfma_f32_16x16x32_bf16 v[24:27], a[192:195], a[128:131], 0
  s_waitcnt lgkmcnt(6)
  v_mfma_f32_16x16x32_bf16 v[24:27], a[196:199], a[132:135], v[24:27]
  s_waitcnt lgkmcnt(5)
  v_mfma_f32_16x16x32_bf16 v[24:27], a[200:203], a[136:139], v[24:27]
  s_waitcnt lgkmcnt(4)
  v_mfma_f32_16x16x32_bf16 v[24:27], a[204:207], a[140:143], v[24:27]
  s_waitcnt lgkmcnt(3)
  v_mfma_f32_16x16x32_bf16 v[40:43], a[208:211], a[128:131], 0
  s_waitcnt lgkmcnt(2)
  v_mfma_f32_16x16x32_bf16 v[40:43], a[212:215], a[132:135], v[40:43]
  s_waitcnt lgkmcnt(1)
  v_mfma_f32_16x16x32_bf16 v[40:43], a[216:219], a[136:139], v[40:43]
  s_waitcnt lgkmcnt(0)
  v_mfma_f32_16x16x32_bf16 v[40:43], a[220:223], a[140:143], v[40:43]
  v_max3_f32 v14, v14, v24, v25
  v_max3_f32 v14, v14, v26, v27
  s_nop 5
  v_max3_f32 v14, v14, v40, v41
  v_max3_f32 v14, v14, v42, v43
  ds_read_b128 a[192:195], v2 offset:0
  ds_read_b128 a[196:199], v2 offset:256
  ds_read_b128 a[200:203], v2 offset:512
  ds_read_b128 a[204:207], v2 offset:768
  ds_read_b128 a[208:211], v2 offset:1024
  ds_read_b128 a[212:215], v2 offset:1280
  ds_read_b128 a[216:219], v2 offset:1536
  ds_read_b128 a[220:223], v2 offset:1792
  s_waitcnt lgkmcnt(7)
  v_mfma_f32_16x16x32_bf16 v[24:27], a[192:195], a[128:131], 0
  s_waitcnt lgkmcnt(6)
  v_mfma_f32_16x16x32_bf16 v[24:27], a[196:199], a[132:135], v[24:27]
  s_waitcnt lgkmcnt(5)
  v_mfma_f32_16x16x32_bf16 v[24:27], a[200:203], a[136:139], v[24:27]
  s_waitcnt lgkmcnt(4)
  v_mfma_f32_16x16x32_bf16 v[24:27], a[204:207], a[140:143], v[24:27]
  s_waitcnt lgkmcnt(3)
  v_mfma_f32_16x16x32_bf16 v[40:43], a[208:211], a[128:131], 0
  s_waitcnt lgkmcnt(2)
  v_mfma_f32_16x16x32_bf16 v[40:43], a[212:215], a[132:135], v[40:43]
  s_waitcnt lgkmcnt(1)
  v_mfma_f32_16x16x32_bf16 v[40:43], a[216:219], a[136:139], v[40:43]
  s_waitcnt lgkmcnt(0)
  v_mfma_f32_16x16x32_bf16 v[40:43], a[220:223], a[140:143], v[40:43]
  v_max3_f32 v14, v14, v24, v25
  v_max3_f32 v14, v14, v26, v27
  s_nop 5
  v_max3_f32 v14, v14, v40, v41
  v_max3_f32 v14, v14, v42, v43
  ds_read_b128 a[192:195], v2 offset:8192
  ds_read_b128 a[196:199], v2 offset:8448
  ds_read_b128 a[200:203], v2 offset:8704
  ds_read_b128 a[204:207], v2 offset:8960
  ds_read_b128 a[208:211], v2 offset:9216
  ds_read_b128 a[212:215], v2 offset:9472
  ds_read_b128 a[216:219], v2 offset:9728
  ds_read_b128 a[220:223], v2 offset:9984
  s_waitcnt lgkmcnt(7)
  v_mfma_f32_16x16x32_bf16 v[24:27], a[192:195], a[128:131], 0
  s_waitcnt lgkmcnt(6)
  v_mfma_f32_16x16x32_bf16 v[24:27], a[196:199], a[132:135], v[24:27]
  s_waitcnt lgkmcnt(5)
  v_mfma_f32_16x16x32_bf16 v[24:27], a[200:203], a[136:139], v[24:27]
  s_waitcnt lgkmcnt(4)
  v_mfma_f32_16x16x32_bf16 v[24:27], a[204:207], a[140:143], v[24:27]
  s_waitcnt lgkmcnt(3)
  v_mfma_f32_16x16x32_bf16 v[40:43], a[208:211], a[128:131], 0
  s_waitcnt lgkmcnt(2)
  v_mfma_f32_16x16x32_bf16 v[40:43], a[212:215], a[132:135], v[40:43]
  s_waitcnt lgkmcnt(1)
  v_mfma_f32_16x16x32_bf16 v[40:43], a[216:219], a[136:139], v[40:43]
  s_waitcnt lgkmcnt(0)
  v_mfma_f32_16x16x32_bf16 v[40:43], a[220:223], a[140:143], v[40:43]
  v_max3_f32 v14, v14, v24, v25
  v_max3_f32 v14, v14, v26, v27
  s_nop 5
  v_max3_f32 v14, v14, v40, v41
  v_max3_f32 v14, v14, v42, v43
  ds_read_b128 a[192:195], v2 offset:16384
  ds_read_b128 a[196:199], v2 offset:16640
  ds_read_b128 a[200:203], v2 offset:16896
  ds_read_b128 a[204:207], v2 offset:17152
  ds_read_b128 a[208:211], v2 offset:17408
  ds_read_b128 a[212:215], v2 offset:17664
  ds_read_b128 a[216:219], v2 offset:17920
  ds_read_b128 a[220:223], v2 offset:18176
  s_waitcnt lgkmcnt(7)
  v_mfma_f32_16x16x32_bf16 v[24:27], a[192:195], a[128:131], 0
  s_waitcnt lgkmcnt(6)
  v_mfma_f32_16x16x32_bf16 v[24:27], a[196:199], a[132:135], v[24:27]
  s_waitcnt lgkmcnt(5)
  v_mfma_f32_16x16x32_bf16 v[24:27], a[200:203], a[136:139], v[24:27]
  s_waitcnt lgkmcnt(4)
  v_mfma_f32_16x16x32_bf16 v[24:27], a[204:207], a[140:143], v[24:27]
  s_waitcnt lgkmcnt(3)
  v_mfma_f32_16x16x32_bf16 v[40:43], a[208:211], a[128:131], 0
  s_waitcnt lgkmcnt(2)
  v_mfma_f32_16x16x32_bf16 v[40:43], a[212:215], a[132:135], v[40:43]
  s_waitcnt lgkmcnt(1)
  v_mfma_f32_16x16x32_bf16 v[40:43], a[216:219], a[136:139], v[40:43]
  s_waitcnt lgkmcnt(0)
  v_mfma_f32_16x16x32_bf16 v[40:43], a[220:223], a[140:143], v[40:43]
  v_max3_f32 v14, v14, v24, v25
  v_max3_f32 v14, v14, v26, v27
  s_nop 5
  v_max3_f32 v14, v14, v40, v41
  v_max3_f32 v14, v14, v42, v43
  ds_read_b128 a[192:195], v2 offset:24576
  ds_read_b128 a[196:199], v2 offset:24832
  ds_read_b128 a[200:203], v2 offset:25088
  ds_read_b128 a[204:207], v2 offset:25344
  ds_read_b128 a[208:211], v2 offset:25600
  ds_read_b128 a[212:215], v2 offset:25856
  ds_read_b128 a[216:219], v2 offset:26112
  ds_read_b128 a[220:223], v2 offset:26368
  s_waitcnt lgkmcnt(7)
  v_mfma_f32_16x16x32_bf16 v[24:27], a[192:195], a[128:131], 0
  s_waitcnt lgkmcnt(6)
  v_mfma_f32_16x16x32_bf16 v[24:27], a[196:199], a[132:135], v[24:27]
  s_waitcnt lgkmcnt(5)
  v_mfma_f32_16x16x32_bf16 v[24:27], a[200:203], a[136:139], v[24:27]
  s_waitcnt lgkmcnt(4)
  v_mfma_f32_16x16x32_bf16 v[24:27], a[204:207], a[140:143], v[24:27]
  s_waitcnt lgkmcnt(3)
  v_mfma_f32_16x16x32_bf16 v[40:43], a[208:211], a[128:131], 0
  s_waitcnt lgkmcnt(2)
  v_mfma_f32_16x16x32_bf16 v[40:43], a[212:215], a[132:135], v[40:43]
  s_waitcnt lgkmcnt(1)
  v_mfma_f32_16x16x32_bf16 v[40:43], a[216:219], a[136:139], v[40:43]
  s_waitcnt lgkmcnt(0)
  v_mfma_f32_16x16x32_bf16 v[40:43], a[220:223], a[140:143], v[40:43]
  v_max3_f32 v14, v14, v24, v25
  v_max3_f32 v14, v14, v26, v27
  s_nop 5
  v_max3_f32 v14, v14, v40, v41
  v_max3_f32 v14, v14, v42, v43
  v_mov_b32 v15, v14
  s_nop 1
  v_permlane16_swap_b32 v14, v15
  v_max_f32 v14, v14, v15
  v_mov_b32 v15, v14
  s_nop 1
  v_permlane32_swap_b32 v14, v15
  v_max_f32 v14, v14, v15
  ds_read_b128 a[192:195], v1 offset:0
  ds_read_b128 a[196:199], v1 offset:256
  ds_read_b128 a[200:203], v1 offset:512
  ds_read_b128 a[204:207], v1 offset:768
  ds_read_b128 a[208:211], v1 offset:1024
  ds_read_b128 a[212:215], v1 offset:1280
  ds_read_b128 a[216:219], v1 offset:1536
  ds_read_b128 a[220:223], v1 offset:1792
  s_waitcnt lgkmcnt(7)
  v_mfma_f32_16x16x32_bf16 v[24:27], a[192:195], a[128:131], 0
  s_waitcnt lgkmcnt(6)
  v_mfma_f32_16x16x32_bf16 v[24:27], a[196:199], a[132:135], v[24:27]
  s_waitcnt lgkmcnt(5)
  v_mfma_f32_16x16x32_bf16 v[24:27], a[200:203], a[136:139], v[24:27]
  s_waitcnt lgkmcnt(4)
  v_mfma_f32_16x16x32_bf16 v[24:27], a[204:207], a[140:143], v[24:27]
  s_waitcnt lgkmcnt(3)
  v_mfma_f32_16x16x32_bf16 v[40:43], a[208:211], a[128:131], 0
  s_waitcnt lgkmcnt(2)
  v_mfma_f32_16x16x32_bf16 v[40:43], a[212:215], a[132:135], v[40:43]
  s_waitcnt lgkmcnt(1)
  v_mfma_f32_16x16x32_bf16 v[40:43], a[216:219], a[136:139], v[40:43]
  s_waitcnt lgkmcnt(0)
  v_mfma_f32_16x16x32_bf16 v[40:43], a[220:223], a[140:143], v[40:43]
  v_sub_f32 v24, v24, v14
  v_sub_f32 v25, v25, v14
  v_sub_f32 v26, v26, v14
  v_sub_f32 v27, v27, v14
  s_nop 3
  v_sub_f32 v40, v40, v14
  v_sub_f32 v41, v41, v14
  v_sub_f32 v42, v42, v14
  v_sub_f32 v43, v43, v14
  v_exp_f32 v24, v24
  v_exp_f32 v25, v25
  v_exp_f32 v26, v26
  v_exp_f32 v27, v27
  v_exp_f32 v40, v40
  v_exp_f32 v41, v41
  v_exp_f32 v42, v42
  v_exp_f32 v43, v43
  v_cvt_pk_bf16_f32 v24, v24, v25
  v_cvt_pk_bf16_f32 v25, v26, v27
  v_cvt_pk_bf16_f32 v26, v40, v41
  v_cvt_pk_bf16_f32 v27, v42, v43
  s_nop 1
  v_mfma_f32_16x16x32_bf16 v[48:51], v[24:27], v[8:11], 0
  v_mfma_f32_16x16x32_bf16 v[64:67], v[24:27], a[0:3], 0
  v_mfma_f32_16x16x32_bf16 v[68:71], v[24:27], a[4:7], 0
  v_mfma_f32_16x16x32_bf16 v[72:75], v[24:27], a[8:11], 0
  v_mfma_f32_16x16x32_bf16 v[76:79], v[24:27], a[12:15], 0
  v_mfma_f32_16x16x32_bf16 v[80:83], v[24:27], a[16:19], 0
  v_mfma_f32_16x16x32_bf16 v[84:87], v[24:27], a[20:23], 0
  v_mfma_f32_16x16x32_bf16 v[88:91], v[24:27], a[24:27], 0
  v_mfma_f32_16x16x32_bf16 v[92:95], v[24:27], a[28:31], 0
  ds_read_b128 a[192:195], v1 offset:8192
  ds_read_b128 a[196:199], v1 offset:8448
  ds_read_b128 a[200:203], v1 offset:8704
  ds_read_b128 a[204:207], v1 offset:8960
  ds_read_b128 a[208:211], v1 offset:9216
  ds_read_b128 a[212:215], v1 offset:9472
  ds_read_b128 a[216:219], v1 offset:9728
  ds_read_b128 a[220:223], v1 offset:9984
  s_waitcnt lgkmcnt(7)
  v_mfma_f32_16x16x32_bf16 v[24:27], a[192:195], a[128:131], 0
  s_waitcnt lgkmcnt(6)
  v_mfma_f32_16x16x32_bf16 v[24:27], a[196:199], a[132:135], v[24:27]
  s_waitcnt lgkmcnt(5)
  v_mfma_f32_16x16x32_bf16 v[24:27], a[200:203], a[136:139], v[24:27]
  s_waitcnt lgkmcnt(4)
  v_mfma_f32_16x16x32_bf16 v[24:27], a[204:207], a[140:143], v[24:27]
  s_waitcnt lgkmcnt(3)
  v_mfma_f32_16x16x32_bf16 v[40:43], a[208:211], a[128:131], 0
  s_waitcnt lgkmcnt(2)
  v_mfma_f32_16x16x32_bf16 v[40:43], a[212:215], a[132:135], v[40:43]
  s_waitcnt lgkmcnt(1)
  v_mfma_f32_16x16x32_bf16 v[40:43], a[216:219], a[136:139], v[40:43]
  s_waitcnt lgkmcnt(0)
  v_mfma_f32_16x16x32_bf16 v[40:43], a[220:223], a[140:143], v[40:43]
  v_sub_f32 v24, v24, v14
  v_sub_f32 v25, v25, v14
  v_sub_f32 v26, v26, v14
  v_sub_f32 v27, v27, v14
  s_nop 3
  v_sub_f32 v40, v40, v14
  v_sub_f32 v41, v41, v14
  v_sub_f32 v42, v42, v14
  v_sub_f32 v43, v43, v14
  v_exp_f32 v24, v24
  v_exp_f32 v25, v25
  v_exp_f32 v26, v26
  v_exp_f32 v27, v27
  v_exp_f32 v40, v40
  v_exp_f32 v41, v41
  v_exp_f32 v42, v42
  v_exp_f32 v43, v43
  v_cvt_pk_bf16_f32 v24, v24, v25
  v_cvt_pk_bf16_f32 v25, v26, v27
  v_cvt_pk_bf16_f32 v26, v40, v41
  v_cvt_pk_bf16_f32 v27, v42, v43
  s_nop 1
  v_mfma_f32_16x16x32_bf16 v[48:51], v[24:27], v[8:11], v[48:51]
  v_mfma_f32_16x16x32_bf16 v[64:67], v[24:27], a[32:35], v[64:67]
  v_mfma_f32_16x16x32_bf16 v[68:71], v[24:27], a[36:39], v[68:71]
  v_mfma_f32_16x16x32_bf16 v[72:75], v[24:27], a[40:43], v[72:75]
  v_mfma_f32_16x16x32_bf16 v[76:79], v[24:27], a[44:47], v[76:79]
  v_mfma_f32_16x16x32_bf16 v[80:83], v[24:27], a[48:51], v[80:83]
  v_mfma_f32_16x16x32_bf16 v[84:87], v[24:27], a[52:55], v[84:87]
  v_mfma_f32_16x16x32_bf16 v[88:91], v[24:27], a[56:59], v[88:91]
  v_mfma_f32_16x16x32_bf16 v[92:95], v[24:27], a[60:63], v[92:95]
  ds_read_b128 a[192:195], v1 offset:16384
  ds_read_b128 a[196:199], v1 offset:16640
  ds_read_b128 a[200:203], v1 offset:16896
  ds_read_b128 a[204:207], v1 offset:17152
  ds_read_b128 a[208:211], v1 offset:17408
  ds_read_b128 a[212:215], v1 offset:17664
  ds_read_b128 a[216:219], v1 offset:17920
  ds_read_b128 a[220:223], v1 offset:18176
  s_waitcnt lgkmcnt(7)
  v_mfma_f32_16x16x32_bf16 v[24:27], a[192:195], a[128:131], 0
  s_waitcnt lgkmcnt(6)
  v_mfma_f32_16x16x32_bf16 v[24:27], a[196:199], a[132:135], v[24:27]
  s_waitcnt lgkmcnt(5)
  v_mfma_f32_16x16x32_bf16 v[24:27], a[200:203], a[136:139], v[24:27]
  s_waitcnt lgkmcnt(4)
  v_mfma_f32_16x16x32_bf16 v[24:27], a[204:207], a[140:143], v[24:27]
  s_waitcnt lgkmcnt(3)
  v_mfma_f32_16x16x32_bf16 v[40:43], a[208:211], a[128:131], 0
  s_waitcnt lgkmcnt(2)
  v_mfma_f32_16x16x32_bf16 v[40:43], a[212:215], a[132:135], v[40:43]
  s_waitcnt lgkmcnt(1)
  v_mfma_f32_16x16x32_bf16 v[40:43], a[216:219], a[136:139], v[40:43]
  s_waitcnt lgkmcnt(0)
  v_mfma_f32_16x16x32_bf16 v[40:43], a[220:223], a[140:143], v[40:43]
  v_sub_f32 v24, v24, v14
  v_sub_f32 v25, v25, v14
  v_sub_f32 v26, v26, v14
  v_sub_f32 v27, v27, v14
  s_nop 3
  v_sub_f32 v40, v40, v14
  v_sub_f32 v41, v41, v14
  v_sub_f32 v42, v42, v14
  v_sub_f32 v43, v43, v14
  v_exp_f32 v24, v24
  v_exp_f32 v25, v25
  v_exp_f32 v26, v26
  v_exp_f32 v27, v27
  v_exp_f32 v40, v40
  v_exp_f32 v41, v41
  v_exp_f32 v42, v42
  v_exp_f32 v43, v43
  v_cvt_pk_bf16_f32 v24, v24, v25
  v_cvt_pk_bf16_f32 v25, v26, v27
  v_cvt_pk_bf16_f32 v26, v40, v41
  v_cvt_pk_bf16_f32 v27, v42, v43
  s_nop 1
  v_mfma_f32_16x16x32_bf16 v[48:51], v[24:27], v[8:11], v[48:51]
  v_mfma_f32_16x16x32_bf16 v[64:67], v[24:27], a[64:67], v[64:67]
  v_mfma_f32_16x16x32_bf16 v[68:71], v[24:27], a[68:71], v[68:71]
  v_mfma_f32_16x16x32_bf16 v[72:75], v[24:27], a[72:75], v[72:75]
  v_mfma_f32_16x16x32_bf16 v[76:79], v[24:27], a[76:79], v[76:79]
  v_mfma_f32_16x16x32_bf16 v[80:83], v[24:27], a[80:83], v[80:83]
  v_mfma_f32_16x16x32_bf16 v[84:87], v[24:27], a[84:87], v[84:87]
  v_mfma_f32_16x16x32_bf16 v[88:91], v[24:27], a[88:91], v[88:91]
  v_mfma_f32_16x16x32_bf16 v[92:95], v[24:27], a[92:95], v[92:95]
  ds_read_b128 a[192:195], v1 offset:24576
  ds_read_b128 a[196:199], v1 offset:24832
  ds_read_b128 a[200:203], v1 offset:25088
  ds_read_b128 a[204:207], v1 offset:25344
  ds_read_b128 a[208:211], v1 offset:25600
  ds_read_b128 a[212:215], v1 offset:25856
  ds_read_b128 a[216:219], v1 offset:26112
  ds_read_b128 a[220:223], v1 offset:26368
  s_waitcnt lgkmcnt(7)
  v_mfma_f32_16x16x32_bf16 v[24:27], a[192:195], a[128:131], 0
  s_waitcnt lgkmcnt(6)
  v_mfma_f32_16x16x32_bf16 v[24:27], a[196:199], a[132:135], v[24:27]
  s_waitcnt lgkmcnt(5)
  v_mfma_f32_16x16x32_bf16 v[24:27], a[200:203], a[136:139], v[24:27]
  s_waitcnt lgkmcnt(4)
  v_mfma_f32_16x16x32_bf16 v[24:27], a[204:207], a[140:143], v[24:27]
  s_waitcnt lgkmcnt(3)
  v_mfma_f32_16x16x32_bf16 v[40:43], a[208:211], a[128:131], 0
  s_waitcnt lgkmcnt(2)
  v_mfma_f32_16x16x32_bf16 v[40:43], a[212:215], a[132:135], v[40:43]
  s_waitcnt lgkmcnt(1)
  v_mfma_f32_16x16x32_bf16 v[40:43], a[216:219], a[136:139], v[40:43]
  s_waitcnt lgkmcnt(0)
  v_mfma_f32_16x16x32_bf16 v[40:43], a[220:223], a[140:143], v[40:43]
  v_sub_f32 v24, v24, v14
  v_sub_f32 v25, v25, v14
  v_sub_f32 v26, v26, v14
  v_sub_f32 v27, v27, v14
  s_nop 3
  v_sub_f32 v40, v40, v14
  v_sub_f32 v41, v41, v14
  v_sub_f32 v42, v42, v14
  v_sub_f32 v43, v43, v14
  v_exp_f32 v24, v24
  v_exp_f32 v25, v25
  v_exp_f32 v26, v26
  v_exp_f32 v27, v27
  v_exp_f32 v40, v40
  v_exp_f32 v41, v41
  v_exp_f32 v42, v42
  v_exp_f32 v43, v43
  v_cvt_pk_bf16_f32 v24, v24, v25
  v_cvt_pk_bf16_f32 v25, v26, v27
  v_cvt_pk_bf16_f32 v26, v40, v41
  v_cvt_pk_bf16_f32 v27, v42, v43
  s_nop 1
  v_mfma_f32_16x16x32_bf16 v[48:51], v[24:27], v[8:11], v[48:51]
  v_mfma_f32_16x16x32_bf16 v[64:67], v[24:27], a[96:99], v[64:67]
  v_mfma_f32_16x16x32_bf16 v[68:71], v[24:27], a[100:103], v[68:71]
  v_mfma_f32_16x16x32_bf16 v[72:75], v[24:27], a[104:107], v[72:75]
  v_mfma_f32_16x16x32_bf16 v[76:79], v[24:27], a[108:111], v[76:79]
  v_mfma_f32_16x16x32_bf16 v[80:83], v[24:27], a[112:115], v[80:83]
  v_mfma_f32_16x16x32_bf16 v[84:87], v[24:27], a[116:119], v[84:87]
  v_mfma_f32_16x16x32_bf16 v[88:91], v[24:27], a[120:123], v[88:91]
  v_mfma_f32_16x16x32_bf16 v[92:95], v[24:27], a[124:127], v[92:95]
  ds_read_b128 a[192:195], v1 offset:32768
  ds_read_b128 a[196:199], v1 offset:33024
  ds_read_b128 a[200:203], v1 offset:33280
  ds_read_b128 a[204:207], v1 offset:33536
  ds_read_b128 a[208:211], v1 offset:33792
  ds_read_b128 a[212:215], v1 offset:34048
  ds_read_b128 a[216:219], v1 offset:34304
  ds_read_b128 a[220:223], v1 offset:34560
  s_waitcnt lgkmcnt(7)
  v_mfma_f32_16x16x32_bf16 v[24:27], a[192:195], a[128:131], 0
  s_waitcnt lgkmcnt(6)
  v_mfma_f32_16x16x32_bf16 v[24:27], a[196:199], a[132:135], v[24:27]
  s_waitcnt lgkmcnt(5)
  v_mfma_f32_16x16x32_bf16 v[24:27], a[200:203], a[136:139], v[24:27]
  s_waitcnt lgkmcnt(4)
  v_mfma_f32_16x16x32_bf16 v[24:27], a[204:207], a[140:143], v[24:27]
  s_waitcnt lgkmcnt(3)
  v_mfma_f32_16x16x32_bf16 v[40:43], a[208:211], a[128:131], 0
  s_waitcnt lgkmcnt(2)
  v_mfma_f32_16x16x32_bf16 v[40:43], a[212:215], a[132:135], v[40:43]
  s_waitcnt lgkmcnt(1)
  v_mfma_f32_16x16x32_bf16 v[40:43], a[216:219], a[136:139], v[40:43]
  s_waitcnt lgkmcnt(0)
  v_mfma_f32_16x16x32_bf16 v[40:43], a[220:223], a[140:143], v[40:43]
  ds_read_b128 a[224:227], v3 offset:32768
  ds_read_b128 a[228:231], v3 offset:33024
  ds_read_b128 a[232:235], v3 offset:33280
  ds_read_b128 a[236:239], v3 offset:33536
  ds_read_b128 a[240:243], v3 offset:33792
  ds_read_b128 a[244:247], v3 offset:34048
  ds_read_b128 a[248:251], v3 offset:34304
  ds_read_b128 a[252:255], v3 offset:34560
  v_sub_f32 v24, v24, v14
  v_sub_f32 v25, v25, v14
  v_sub_f32 v26, v26, v14
  v_sub_f32 v27, v27, v14
  v_sub_f32 v40, v40, v14
  v_sub_f32 v41, v41, v14
  v_sub_f32 v42, v42, v14
  v_sub_f32 v43, v43, v14
  v_exp_f32 v24, v24
  v_exp_f32 v25, v25
  v_exp_f32 v26, v26
  v_exp_f32 v27, v27
  v_exp_f32 v40, v40
  v_exp_f32 v41, v41
  v_exp_f32 v42, v42
  v_exp_f32 v43, v43
  v_cvt_pk_bf16_f32 v24, v24, v25
  v_cvt_pk_bf16_f32 v25, v26, v27
  v_cvt_pk_bf16_f32 v26, v40, v41
  v_cvt_pk_bf16_f32 v27, v42, v43
  s_nop 1
  v_mfma_f32_16x16x32_bf16 v[48:51], v[24:27], v[8:11], v[48:51]
  s_waitcnt lgkmcnt(0)
  v_mfma_f32_16x16x32_bf16 v[64:67], v[24:27], a[224:227], v[64:67]
  v_mfma_f32_16x16x32_bf16 v[68:71], v[24:27], a[228:231], v[68:71]
  v_mfma_f32_16x16x32_bf16 v[72:75], v[24:27], a[232:235], v[72:75]
  v_mfma_f32_16x16x32_bf16 v[76:79], v[24:27], a[236:239], v[76:79]
  v_mfma_f32_16x16x32_bf16 v[80:83], v[24:27], a[240:243], v[80:83]
  v_mfma_f32_16x16x32_bf16 v[84:87], v[24:27], a[244:247], v[84:87]
  v_mfma_f32_16x16x32_bf16 v[88:91], v[24:27], a[248:251], v[88:91]
  v_mfma_f32_16x16x32_bf16 v[92:95], v[24:27], a[252:255], v[92:95]
  ds_read_b128 a[192:195], v1 offset:40960
  ds_read_b128 a[196:199], v1 offset:41216
  ds_read_b128 a[200:203], v1 offset:41472
  ds_read_b128 a[204:207], v1 offset:41728
  ds_read_b128 a[208:211], v1 offset:41984
  ds_read_b128 a[212:215], v1 offset:42240
  ds_read_b128 a[216:219], v1 offset:42496
  ds_read_b128 a[220:223], v1 offset:42752
  s_waitcnt lgkmcnt(7)
  v_mfma_f32_16x16x32_bf16 v[24:27], a[192:195], a[128:131], 0
  s_waitcnt lgkmcnt(6)
  v_mfma_f32_16x16x32_bf16 v[24:27], a[196:199], a[132:135], v[24:27]
  s_waitcnt lgkmcnt(5)
  v_mfma_f32_16x16x32_bf16 v[24:27], a[200:203], a[136:139], v[24:27]
  s_waitcnt lgkmcnt(4)
  v_mfma_f32_16x16x32_bf16 v[24:27], a[204:207], a[140:143], v[24:27]
  s_waitcnt lgkmcnt(3)
  v_mfma_f32_16x16x32_bf16 v[40:43], a[208:211], a[128:131], 0
  s_waitcnt lgkmcnt(2)
  v_mfma_f32_16x16x32_bf16 v[40:43], a[212:215], a[132:135], v[40:43]
  s_waitcnt lgkmcnt(1)
  v_mfma_f32_16x16x32_bf16 v[40:43], a[216:219], a[136:139], v[40:43]
  s_waitcnt lgkmcnt(0)
  v_mfma_f32_16x16x32_bf16 v[40:43], a[220:223], a[140:143], v[40:43]
  ds_read_b128 a[224:227], v3 offset:40960
  ds_read_b128 a[228:231], v3 offset:41216
  ds_read_b128 a[232:235], v3 offset:41472
  ds_read_b128 a[236:239], v3 offset:41728
  ds_read_b128 a[240:243], v3 offset:41984
  ds_read_b128 a[244:247], v3 offset:42240
  ds_read_b128 a[248:251], v3 offset:42496
  ds_read_b128 a[252:255], v3 offset:42752
  v_sub_f32 v24, v24, v14
  v_sub_f32 v25, v25, v14
  v_sub_f32 v26, v26, v14
  v_sub_f32 v27, v27, v14
  v_sub_f32 v40, v40, v14
  v_sub_f32 v41, v41, v14
  v_sub_f32 v42, v42, v14
  v_sub_f32 v43, v43, v14
  v_exp_f32 v24, v24
  v_exp_f32 v25, v25
  v_exp_f32 v26, v26
  v_exp_f32 v27, v27
  v_exp_f32 v40, v40
  v_exp_f32 v41, v41
  v_exp_f32 v42, v42
  v_exp_f32 v43, v43
  v_cvt_pk_bf16_f32 v24, v24, v25
  v_cvt_pk_bf16_f32 v25, v26, v27
  v_cvt_pk_bf16_f32 v26, v40, v41
  v_cvt_pk_bf16_f32 v27, v42, v43
  s_nop 1
  v_mfma_f32_16x16x32_bf16 v[48:51], v[24:27], v[8:11], v[48:51]
  s_waitcnt lgkmcnt(0)
  v_mfma_f32_16x16x32_bf16 v[64:67], v[24:27], a[224:227], v[64:67]
  v_mfma_f32_16x16x32_bf16 v[68:71], v[24:27], a[228:231], v[68:71]
  v_mfma_f32_16x16x32_bf16 v[72:75], v[24:27], a[232:235], v[72:75]
  v_mfma_f32_16x16x32_bf16 v[76:79], v[24:27], a[236:239], v[76:79]
  v_mfma_f32_16x16x32_bf16 v[80:83], v[24:27], a[240:243], v[80:83]
  v_mfma_f32_16x16x32_bf16 v[84:87], v[24:27], a[244:247], v[84:87]
  v_mfma_f32_16x16x32_bf16 v[88:91], v[24:27], a[248:251], v[88:91]
  v_mfma_f32_16x16x32_bf16 v[92:95], v[24:27], a[252:255], v[92:95]
  ds_read_b128 a[192:195], v1 offset:49152
  ds_read_b128 a[196:199], v1 offset:49408
  ds_read_b128 a[200:203], v1 offset:49664
  ds_read_b128 a[204:207], v1 offset:49920
  ds_read_b128 a[208:211], v1 offset:50176
  ds_read_b128 a[212:215], v1 offset:50432
  ds_read_b128 a[216:219], v1 offset:50688
  ds_read_b128 a[220:223], v1 offset:50944
  s_waitcnt lgkmcnt(7)
  v_mfma_f32_16x16x32_bf16 v[24:27], a[192:195], a[128:131], 0
  s_waitcnt lgkmcnt(6)
  v_mfma_f32_16x16x32_bf16 v[24:27], a[196:199], a[132:135], v[24:27]
  s_waitcnt lgkmcnt(5)
  v_mfma_f32_16x16x32_bf16 v[24:27], a[200:203], a[136:139], v[24:27]
  s_waitcnt lgkmcnt(4)
  v_mfma_f32_16x16x32_bf16 v[24:27], a[204:207], a[140:143], v[24:27]
  s_waitcnt lgkmcnt(3)
  v_mfma_f32_16x16x32_bf16 v[40:43], a[208:211], a[128:131], 0
  s_waitcnt lgkmcnt(2)
  v_mfma_f32_16x16x32_bf16 v[40:43], a[212:215], a[132:135], v[40:43]
  s_waitcnt lgkmcnt(1)
  v_mfma_f32_16x16x32_bf16 v[40:43], a[216:219], a[136:139], v[40:43]
  s_waitcnt lgkmcnt(0)
  v_mfma_f32_16x16x32_bf16 v[40:43], a[220:223], a[140:143], v[40:43]
  ds_read_b128 a[224:227], v3 offset:49152
  ds_read_b128 a[228:231], v3 offset:49408
  ds_read_b128 a[232:235], v3 offset:49664
  ds_read_b128 a[236:239], v3 offset:49920
  ds_read_b128 a[240:243], v3 offset:50176
  ds_read_b128 a[244:247], v3 offset:50432
  ds_read_b128 a[248:251], v3 offset:50688
  ds_read_b128 a[252:255], v3 offset:50944
  v_sub_f32 v24, v24, v14
  v_sub_f32 v25, v25, v14
  v_sub_f32 v26, v26, v14
  v_sub_f32 v27, v27, v14
  v_sub_f32 v40, v40, v14
  v_sub_f32 v41, v41, v14
  v_sub_f32 v42, v42, v14
  v_sub_f32 v43, v43, v14
  v_exp_f32 v24, v24
  v_exp_f32 v25, v25
  v_exp_f32 v26, v26
  v_exp_f32 v27, v27
  v_exp_f32 v40, v40
  v_exp_f32 v41, v41
  v_exp_f32 v42, v42
  v_exp_f32 v43, v43
  v_cvt_pk_bf16_f32 v24, v24, v25
  v_cvt_pk_bf16_f32 v25, v26, v27
  v_cvt_pk_bf16_f32 v26, v40, v41
  v_cvt_pk_bf16_f32 v27, v42, v43
  s_nop 1
  v_mfma_f32_16x16x32_bf16 v[48:51], v[24:27], v[8:11], v[48:51]
  s_waitcnt lgkmcnt(0)
  v_mfma_f32_16x16x32_bf16 v[64:67], v[24:27], a[224:227], v[64:67]
  v_mfma_f32_16x16x32_bf16 v[68:71], v[24:27], a[228:231], v[68:71]
  v_mfma_f32_16x16x32_bf16 v[72:75], v[24:27], a[232:235], v[72:75]
  v_mfma_f32_16x16x32_bf16 v[76:79], v[24:27], a[236:239], v[76:79]
  v_mfma_f32_16x16x32_bf16 v[80:83], v[24:27], a[240:243], v[80:83]
  v_mfma_f32_16x16x32_bf16 v[84:87], v[24:27], a[244:247], v[84:87]
  v_mfma_f32_16x16x32_bf16 v[88:91], v[24:27], a[248:251], v[88:91]
  v_mfma_f32_16x16x32_bf16 v[92:95], v[24:27], a[252:255], v[92:95]
  ds_read_b128 a[192:195], v1 offset:57344
  ds_read_b128 a[196:199], v1 offset:57600
  ds_read_b128 a[200:203], v1 offset:57856
  ds_read_b128 a[204:207], v1 offset:58112
  ds_read_b128 a[208:211], v1 offset:58368
  ds_read_b128 a[212:215], v1 offset:58624
  ds_read_b128 a[216:219], v1 offset:58880
  ds_read_b128 a[220:223], v1 offset:59136
  s_waitcnt lgkmcnt(7)
  v_mfma_f32_16x16x32_bf16 v[24:27], a[192:195], a[128:131], 0
  s_waitcnt lgkmcnt(6)
  v_mfma_f32_16x16x32_bf16 v[24:27], a[196:199], a[132:135], v[24:27]
  s_waitcnt lgkmcnt(5)
  v_mfma_f32_16x16x32_bf16 v[24:27], a[200:203], a[136:139], v[24:27]
  s_waitcnt lgkmcnt(4)
  v_mfma_f32_16x16x32_bf16 v[24:27], a[204:207], a[140:143], v[24:27]
  s_waitcnt lgkmcnt(3)
  v_mfma_f32_16x16x32_bf16 v[40:43], a[208:211], a[128:131], 0
  s_waitcnt lgkmcnt(2)
  v_mfma_f32_16x16x32_bf16 v[40:43], a[212:215], a[132:135], v[40:43]
  s_waitcnt lgkmcnt(1)
  v_mfma_f32_16x16x32_bf16 v[40:43], a[216:219], a[136:139], v[40:43]
  s_waitcnt lgkmcnt(0)
  v_mfma_f32_16x16x32_bf16 v[40:43], a[220:223], a[140:143], v[40:43]
  ds_read_b128 a[224:227], v3 offset:57344
  ds_read_b128 a[228:231], v3 offset:57600
  ds_read_b128 a[232:235], v3 offset:57856
  ds_read_b128 a[236:239], v3 offset:58112
  ds_read_b128 a[240:243], v3 offset:58368
  ds_read_b128 a[244:247], v3 offset:58624
  ds_read_b128 a[248:251], v3 offset:58880
  ds_read_b128 a[252:255], v3 offset:59136
  v_sub_f32 v24, v24, v14
  v_sub_f32 v25, v25, v14
  v_sub_f32 v26, v26, v14
  v_sub_f32 v27, v27, v14
  v_sub_f32 v40, v40, v14
  v_sub_f32 v41, v41, v14
  v_sub_f32 v42, v42, v14
  v_sub_f32 v43, v43, v14
  v_exp_f32 v24, v24
  v_exp_f32 v25, v25
  v_exp_f32 v26, v26
  v_exp_f32 v27, v27
  v_exp_f32 v40, v40
  v_exp_f32 v41, v41
  v_exp_f32 v42, v42
  v_exp_f32 v43, v43
  v_cvt_pk_bf16_f32 v24, v24, v25
  v_cvt_pk_bf16_f32 v25, v26, v27
  v_cvt_pk_bf16_f32 v26, v40, v41
  v_cvt_pk_bf16_f32 v27, v42, v43
  s_nop 1
  v_mfma_f32_16x16x32_bf16 v[48:51], v[24:27], v[8:11], v[48:51]
  s_waitcnt lgkmcnt(0)
  v_mfma_f32_16x16x32_bf16 v[64:67], v[24:27], a[224:227], v[64:67]
  v_mfma_f32_16x16x32_bf16 v[68:71], v[24:27], a[228:231], v[68:71]
  v_mfma_f32_16x16x32_bf16 v[72:75], v[24:27], a[232:235], v[72:75]
  v_mfma_f32_16x16x32_bf16 v[76:79], v[24:27], a[236:239], v[76:79]
  v_mfma_f32_16x16x32_bf16 v[80:83], v[24:27], a[240:243], v[80:83]
  v_mfma_f32_16x16x32_bf16 v[84:87], v[24:27], a[244:247], v[84:87]
  v_mfma_f32_16x16x32_bf16 v[88:91], v[24:27], a[248:251], v[88:91]
  v_mfma_f32_16x16x32_bf16 v[92:95], v[24:27], a[252:255], v[92:95]
  ds_read_b128 a[192:195], v2 offset:0
  ds_read_b128 a[196:199], v2 offset:256
  ds_read_b128 a[200:203], v2 offset:512
  ds_read_b128 a[204:207], v2 offset:768
  ds_read_b128 a[208:211], v2 offset:1024
  ds_read_b128 a[212:215], v2 offset:1280
  ds_read_b128 a[216:219], v2 offset:1536
  ds_read_b128 a[220:223], v2 offset:1792
  s_waitcnt lgkmcnt(7)
  v_mfma_f32_16x16x32_bf16 v[24:27], a[192:195], a[128:131], 0
  s_waitcnt lgkmcnt(6)
  v_mfma_f32_16x16x32_bf16 v[24:27], a[196:199], a[132:135], v[24:27]
  s_waitcnt lgkmcnt(5)
  v_mfma_f32_16x16x32_bf16 v[24:27], a[200:203], a[136:139], v[24:27]
  s_waitcnt lgkmcnt(4)
  v_mfma_f32_16x16x32_bf16 v[24:27], a[204:207], a[140:143], v[24:27]
  s_waitcnt lgkmcnt(3)
  v_mfma_f32_16x16x32_bf16 v[40:43], a[208:211], a[128:131], 0
  s_waitcnt lgkmcnt(2)
  v_mfma_f32_16x16x32_bf16 v[40:43], a[212:215], a[132:135], v[40:43]
  s_waitcnt lgkmcnt(1)
  v_mfma_f32_16x16x32_bf16 v[40:43], a[216:219], a[136:139], v[40:43]
  s_waitcnt lgkmcnt(0)
  v_mfma_f32_16x16x32_bf16 v[40:43], a[220:223], a[140:143], v[40:43]
  ds_read_b128 a[224:227], v3 offset:0
  ds_read_b128 a[228:231], v3 offset:256
  ds_read_b128 a[232:235], v3 offset:512
  ds_read_b128 a[236:239], v3 offset:768
  ds_read_b128 a[240:243], v3 offset:1024
  ds_read_b128 a[244:247], v3 offset:1280
  ds_read_b128 a[248:251], v3 offset:1536
  ds_read_b128 a[252:255], v3 offset:1792
  v_sub_f32 v24, v24, v14
  v_sub_f32 v25, v25, v14
  v_sub_f32 v26, v26, v14
  v_sub_f32 v27, v27, v14
  v_sub_f32 v40, v40, v14
  v_sub_f32 v41, v41, v14
  v_sub_f32 v42, v42, v14
  v_sub_f32 v43, v43, v14
  v_exp_f32 v24, v24
  v_exp_f32 v25, v25
  v_exp_f32 v26, v26
  v_exp_f32 v27, v27
  v_exp_f32 v40, v40
  v_exp_f32 v41, v41
  v_exp_f32 v42, v42
  v_exp_f32 v43, v43
  v_cvt_pk_bf16_f32 v24, v24, v25
  v_cvt_pk_bf16_f32 v25, v26, v27
  v_cvt_pk_bf16_f32 v26, v40, v41
  v_cvt_pk_bf16_f32 v27, v42, v43
  s_nop 1
  v_mfma_f32_16x16x32_bf16 v[48:51], v[24:27], v[8:11], v[48:51]
  s_waitcnt lgkmcnt(0)
  v_mfma_f32_16x16x32_bf16 v[64:67], v[24:27], a[224:227], v[64:67]
  v_mfma_f32_16x16x32_bf16 v[68:71], v[24:27], a[228:231], v[68:71]
  v_mfma_f32_16x16x32_bf16 v[72:75], v[24:27], a[232:235], v[72:75]
  v_mfma_f32_16x16x32_bf16 v[76:79], v[24:27], a[236:239], v[76:79]
  v_mfma_f32_16x16x32_bf16 v[80:83], v[24:27], a[240:243], v[80:83]
  v_mfma_f32_16x16x32_bf16 v[84:87], v[24:27], a[244:247], v[84:87]
  v_mfma_f32_16x16x32_bf16 v[88:91], v[24:27], a[248:251], v[88:91]
  v_mfma_f32_16x16x32_bf16 v[92:95], v[24:27], a[252:255], v[92:95]
  ds_read_b128 a[192:195], v2 offset:8192
  ds_read_b128 a[196:199], v2 offset:8448
  ds_read_b128 a[200:203], v2 offset:8704
  ds_read_b128 a[204:207], v2 offset:8960
  ds_read_b128 a[208:211], v2 offset:9216
  ds_read_b128 a[212:215], v2 offset:9472
  ds_read_b128 a[216:219], v2 offset:9728
  ds_read_b128 a[220:223], v2 offset:9984
  s_waitcnt lgkmcnt(7)
  v_mfma_f32_16x16x32_bf16 v[24:27], a[192:195], a[128:131], 0
  s_waitcnt lgkmcnt(6)
  v_mfma_f32_16x16x32_bf16 v[24:27], a[196:199], a[132:135], v[24:27]
  s_waitcnt lgkmcnt(5)
  v_mfma_f32_16x16x32_bf16 v[24:27], a[200:203], a[136:139], v[24:27]
  s_waitcnt lgkmcnt(4)
  v_mfma_f32_16x16x32_bf16 v[24:27], a[204:207], a[140:143], v[24:27]
  s_waitcnt lgkmcnt(3)
  v_mfma_f32_16x16x32_bf16 v[40:43], a[208:211], a[128:131], 0
  s_waitcnt lgkmcnt(2)
  v_mfma_f32_16x16x32_bf16 v[40:43], a[212:215], a[132:135], v[40:43]
  s_waitcnt lgkmcnt(1)
  v_mfma_f32_16x16x32_bf16 v[40:43], a[216:219], a[136:139], v[40:43]
  s_waitcnt lgkmcnt(0)
  v_mfma_f32_16x16x32_bf16 v[40:43], a[220:223], a[140:143], v[40:43]
  ds_read_b128 a[224:227], v3 offset:8192
  ds_read_b128 a[228:231], v3 offset:8448
  ds_read_b128 a[232:235], v3 offset:8704
  ds_read_b128 a[236:239], v3 offset:8960
  ds_read_b128 a[240:243], v3 offset:9216
  ds_read_b128 a[244:247], v3 offset:9472
  ds_read_b128 a[248:251], v3 offset:9728
  ds_read_b128 a[252:255], v3 offset:9984
  v_sub_f32 v24, v24, v14
  v_sub_f32 v25, v25, v14
  v_sub_f32 v26, v26, v14
  v_sub_f32 v27, v27, v14
  v_sub_f32 v40, v40, v14
  v_sub_f32 v41, v41, v14
  v_sub_f32 v42, v42, v14
  v_sub_f32 v43, v43, v14
  v_exp_f32 v24, v24
  v_exp_f32 v25, v25
  v_exp_f32 v26, v26
  v_exp_f32 v27, v27
  v_exp_f32 v40, v40
  v_exp_f32 v41, v41
  v_exp_f32 v42, v42
  v_exp_f32 v43, v43
  v_cvt_pk_bf16_f32 v24, v24, v25
  v_cvt_pk_bf16_f32 v25, v26, v27
  v_cvt_pk_bf16_f32 v26, v40, v41
  v_cvt_pk_bf16_f32 v27, v42, v43
  s_nop 1
  v_mfma_f32_16x16x32_bf16 v[48:51], v[24:27], v[8:11], v[48:51]
  s_waitcnt lgkmcnt(0)
  v_mfma_f32_16x16x32_bf16 v[64:67], v[24:27], a[224:227], v[64:67]
  v_mfma_f32_16x16x32_bf16 v[68:71], v[24:27], a[228:231], v[68:71]
  v_mfma_f32_16x16x32_bf16 v[72:75], v[24:27], a[232:235], v[72:75]
  v_mfma_f32_16x16x32_bf16 v[76:79], v[24:27], a[236:239], v[76:79]
  v_mfma_f32_16x16x32_bf16 v[80:83], v[24:27], a[240:243], v[80:83]
  v_mfma_f32_16x16x32_bf16 v[84:87], v[24:27], a[244:247], v[84:87]
  v_mfma_f32_16x16x32_bf16 v[88:91], v[24:27], a[248:251], v[88:91]
  v_mfma_f32_16x16x32_bf16 v[92:95], v[24:27], a[252:255], v[92:95]
  ds_read_b128 a[192:195], v2 offset:16384
  ds_read_b128 a[196:199], v2 offset:16640
  ds_read_b128 a[200:203], v2 offset:16896
  ds_read_b128 a[204:207], v2 offset:17152
  ds_read_b128 a[208:211], v2 offset:17408
  ds_read_b128 a[212:215], v2 offset:17664
  ds_read_b128 a[216:219], v2 offset:17920
  ds_read_b128 a[220:223], v2 offset:18176
  s_waitcnt lgkmcnt(7)
  v_mfma_f32_16x16x32_bf16 v[24:27], a[192:195], a[128:131], 0
  s_waitcnt lgkmcnt(6)
  v_mfma_f32_16x16x32_bf16 v[24:27], a[196:199], a[132:135], v[24:27]
  s_waitcnt lgkmcnt(5)
  v_mfma_f32_16x16x32_bf16 v[24:27], a[200:203], a[136:139], v[24:27]
  s_waitcnt lgkmcnt(4)
  v_mfma_f32_16x16x32_bf16 v[24:27], a[204:207], a[140:143], v[24:27]
  s_waitcnt lgkmcnt(3)
  v_mfma_f32_16x16x32_bf16 v[40:43], a[208:211], a[128:131], 0
  s_waitcnt lgkmcnt(2)
  v_mfma_f32_16x16x32_bf16 v[40:43], a[212:215], a[132:135], v[40:43]
  s_waitcnt lgkmcnt(1)
  v_mfma_f32_16x16x32_bf16 v[40:43], a[216:219], a[136:139], v[40:43]
  s_waitcnt lgkmcnt(0)
  v_mfma_f32_16x16x32_bf16 v[40:43], a[220:223], a[140:143], v[40:43]
  ds_read_b128 a[224:227], v3 offset:16384
  ds_read_b128 a[228:231], v3 offset:16640
  ds_read_b128 a[232:235], v3 offset:16896
  ds_read_b128 a[236:239], v3 offset:17152
  ds_read_b128 a[240:243], v3 offset:17408
  ds_read_b128 a[244:247], v3 offset:17664
  ds_read_b128 a[248:251], v3 offset:17920
  ds_read_b128 a[252:255], v3 offset:18176
  v_sub_f32 v24, v24, v14
  v_sub_f32 v25, v25, v14
  v_sub_f32 v26, v26, v14
  v_sub_f32 v27, v27, v14
  v_sub_f32 v40, v40, v14
  v_sub_f32 v41, v41, v14
  v_sub_f32 v42, v42, v14
  v_sub_f32 v43, v43, v14
  v_exp_f32 v24, v24
  v_exp_f32 v25, v25
  v_exp_f32 v26, v26
  v_exp_f32 v27, v27
  v_exp_f32 v40, v40
  v_exp_f32 v41, v41
  v_exp_f32 v42, v42
  v_exp_f32 v43, v43
  v_cvt_pk_bf16_f32 v24, v24, v25
  v_cvt_pk_bf16_f32 v25, v26, v27
  v_cvt_pk_bf16_f32 v26, v40, v41
  v_cvt_pk_bf16_f32 v27, v42, v43
  s_nop 1
  v_mfma_f32_16x16x32_bf16 v[48:51], v[24:27], v[8:11], v[48:51]
  s_waitcnt lgkmcnt(0)
  v_mfma_f32_16x16x32_bf16 v[64:67], v[24:27], a[224:227], v[64:67]
  v_mfma_f32_16x16x32_bf16 v[68:71], v[24:27], a[228:231], v[68:71]
  v_mfma_f32_16x16x32_bf16 v[72:75], v[24:27], a[232:235], v[72:75]
  v_mfma_f32_16x16x32_bf16 v[76:79], v[24:27], a[236:239], v[76:79]
  v_mfma_f32_16x16x32_bf16 v[80:83], v[24:27], a[240:243], v[80:83]
  v_mfma_f32_16x16x32_bf16 v[84:87], v[24:27], a[244:247], v[84:87]
  v_mfma_f32_16x16x32_bf16 v[88:91], v[24:27], a[248:251], v[88:91]
  v_mfma_f32_16x16x32_bf16 v[92:95], v[24:27], a[252:255], v[92:95]
  ds_read_b128 a[192:195], v2 offset:24576
  ds_read_b128 a[196:199], v2 offset:24832
  ds_read_b128 a[200:203], v2 offset:25088
  ds_read_b128 a[204:207], v2 offset:25344
  ds_read_b128 a[208:211], v2 offset:25600
  ds_read_b128 a[212:215], v2 offset:25856
  ds_read_b128 a[216:219], v2 offset:26112
  ds_read_b128 a[220:223], v2 offset:26368
  s_waitcnt lgkmcnt(7)
  v_mfma_f32_16x16x32_bf16 v[24:27], a[192:195], a[128:131], 0
  s_waitcnt lgkmcnt(6)
  v_mfma_f32_16x16x32_bf16 v[24:27], a[196:199], a[132:135], v[24:27]
  s_waitcnt lgkmcnt(5)
  v_mfma_f32_16x16x32_bf16 v[24:27], a[200:203], a[136:139], v[24:27]
  s_waitcnt lgkmcnt(4)
  v_mfma_f32_16x16x32_bf16 v[24:27], a[204:207], a[140:143], v[24:27]
  s_waitcnt lgkmcnt(3)
  v_mfma_f32_16x16x32_bf16 v[40:43], a[208:211], a[128:131], 0
  s_waitcnt lgkmcnt(2)
  v_mfma_f32_16x16x32_bf16 v[40:43], a[212:215], a[132:135], v[40:43]
  s_waitcnt lgkmcnt(1)
  v_mfma_f32_16x16x32_bf16 v[40:43], a[216:219], a[136:139], v[40:43]
  s_waitcnt lgkmcnt(0)
  v_mfma_f32_16x16x32_bf16 v[40:43], a[220:223], a[140:143], v[40:43]
  ds_read_b128 a[224:227], v3 offset:24576
  ds_read_b128 a[228:231], v3 offset:24832
  ds_read_b128 a[232:235], v3 offset:25088
  ds_read_b128 a[236:239], v3 offset:25344
  ds_read_b128 a[240:243], v3 offset:25600
  ds_read_b128 a[244:247], v3 offset:25856
  ds_read_b128 a[248:251], v3 offset:26112
  ds_read_b128 a[252:255], v3 offset:26368
  v_sub_f32 v24, v24, v14
  v_sub_f32 v25, v25, v14
  v_sub_f32 v26, v26, v14
  v_sub_f32 v27, v27, v14
  v_sub_f32 v40, v40, v14
  v_sub_f32 v41, v41, v14
  v_sub_f32 v42, v42, v14
  v_sub_f32 v43, v43, v14
  v_exp_f32 v24, v24
  v_exp_f32 v25, v25
  v_exp_f32 v26, v26
  v_exp_f32 v27, v27
  v_exp_f32 v40, v40
  v_exp_f32 v41, v41
  v_exp_f32 v42, v42
  v_exp_f32 v43, v43
  v_cvt_pk_bf16_f32 v24, v24, v25
  v_cvt_pk_bf16_f32 v25, v26, v27
  v_cvt_pk_bf16_f32 v26, v40, v41
  v_cvt_pk_bf16_f32 v27, v42, v43
  s_nop 1
  v_mfma_f32_16x16x32_bf16 v[48:51], v[24:27], v[8:11], v[48:51]
  s_waitcnt lgkmcnt(0)
  v_mfma_f32_16x16x32_bf16 v[64:67], v[24:27], a[224:227], v[64:67]
  v_mfma_f32_16x16x32_bf16 v[68:71], v[24:27], a[228:231], v[68:71]
  v_mfma_f32_16x16x32_bf16 v[72:75], v[24:27], a[232:235], v[72:75]
  v_mfma_f32_16x16x32_bf16 v[76:79], v[24:27], a[236:239], v[76:79]
  v_mfma_f32_16x16x32_bf16 v[80:83], v[24:27], a[240:243], v[80:83]
  v_mfma_f32_16x16x32_bf16 v[84:87], v[24:27], a[244:247], v[84:87]
  v_mfma_f32_16x16x32_bf16 v[88:91], v[24:27], a[248:251], v[88:91]
  v_mfma_f32_16x16x32_bf16 v[92:95], v[24:27], a[252:255], v[92:95]
  v_rcp_f32_dpp v48, v48 row_newbcast:0 row_mask:0xf bank_mask:0xf
  v_rcp_f32_dpp v49, v49 row_newbcast:0 row_mask:0xf bank_mask:0xf
  v_rcp_f32_dpp v50, v50 row_newbcast:0 row_mask:0xf bank_mask:0xf
  v_rcp_f32_dpp v51, v51 row_newbcast:0 row_mask:0xf bank_mask:0xf
  v_mul_f32 v64, v64, v48
  v_mul_f32 v68, v68, v48
  v_mul_f32 v65, v65, v49
  v_mul_f32 v69, v69, v49
  v_cvt_pk_bf16_f32 v64, v64, v68
  v_mul_f32 v72, v72, v48
  v_mul_f32 v76, v76, v48
  v_cvt_pk_bf16_f32 v68, v65, v69
  v_mul_f32 v66, v66, v50
  v_mul_f32 v70, v70, v50
  v_cvt_pk_bf16_f32 v65, v72, v76
  v_mul_f32 v67, v67, v51
  v_mul_f32 v71, v71, v51
  v_cvt_pk_bf16_f32 v72, v66, v70
  v_mul_f32 v73, v73, v49
  v_mul_f32 v77, v77, v49
  v_cvt_pk_bf16_f32 v76, v67, v71
  v_mul_f32 v74, v74, v50
  v_mul_f32 v78, v78, v50
  v_cvt_pk_bf16_f32 v69, v73, v77
  v_mul_f32 v75, v75, v51
  v_mul_f32 v79, v79, v51
  v_cvt_pk_bf16_f32 v73, v74, v78
  v_mul_f32 v80, v80, v48
  v_mul_f32 v84, v84, v48
  v_cvt_pk_bf16_f32 v77, v75, v79
  v_mul_f32 v88, v88, v48
  v_mul_f32 v92, v92, v48
  v_cvt_pk_bf16_f32 v66, v80, v84
  v_mul_f32 v81, v81, v49
  v_mul_f32 v85, v85, v49
  v_cvt_pk_bf16_f32 v67, v88, v92
  buffer_store_dwordx4 v[64:67], v5, s[28:31], s35 offen offset:0 nt
  v_mul_f32 v89, v89, v49
  v_mul_f32 v93, v93, v49
  v_cvt_pk_bf16_f32 v70, v81, v85
  v_mul_f32 v82, v82, v50
  v_mul_f32 v86, v86, v50
  v_cvt_pk_bf16_f32 v71, v89, v93
  buffer_store_dwordx4 v[68:71], v5, s[28:31], s35 offen offset:256 nt
  v_mul_f32 v90, v90, v50
  v_mul_f32 v94, v94, v50
  v_cvt_pk_bf16_f32 v74, v82, v86
  v_mul_f32 v83, v83, v51
  v_mul_f32 v87, v87, v51
  v_cvt_pk_bf16_f32 v75, v90, v94
  buffer_store_dwordx4 v[72:75], v5, s[28:31], s35 offen offset:512 nt
  v_mul_f32 v91, v91, v51
  v_mul_f32 v95, v95, v51
  v_cvt_pk_bf16_f32 v78, v83, v87
  v_cvt_pk_bf16_f32 v79, v91, v95
  buffer_store_dwordx4 v[76:79], v5, s[28:31], s35 offen offset:768 nt
  s_add_u32 s35, s35, 4096
  s_waitcnt vmcnt(0) lgkmcnt(0)
  s_add_u32 s48, s48, 1
  s_cmp_lt_u32 s48, 24
  s_cbranch_scc1 L_fb_loop
  s_endpgm

.section .rodata,"a"
.p2align 6
.amdhsa_kernel standalone__gqa_softmax__near_ridge_kernel
  .amdhsa_next_free_vgpr 512
  .amdhsa_next_free_sgpr 102
  .amdhsa_accum_offset 256
  .amdhsa_group_segment_fixed_size 0
  .amdhsa_kernarg_size 48
  .amdhsa_user_sgpr_count 2
  .amdhsa_user_sgpr_kernarg_segment_ptr 1
  .amdhsa_system_sgpr_workgroup_id_x 1
.end_amdhsa_kernel
```
